```python
import torch

def _softmax(x, axis=-1):
    return torch.softmax(x, dim=axis)

def _gelu(x):
    return torch.nn.functional.gelu(x, approximate='tanh')

def _silu(x):
    return torch.nn.functional.silu(x)

def _sigmoid(x):
    return torch.sigmoid(x)

def _layernorm(x, axis=-1, eps=1e-05):
    m = x.mean(dim=axis, keepdim=True)
    v = x.var(dim=axis, keepdim=True, unbiased=False)
    return (x - m) / torch.sqrt(v + eps)

def _scatter_add(tgt, idx, src, axis=0):
    return tgt.clone().index_add_(axis, idx, src)

def _segment_sum(src, seg, n):
    out = torch.zeros((n,) + src.shape[1:], dtype=src.dtype)
    return out.index_add_(0, seg, src)

def _pad(x, pw):
    flat = tuple((v for pair in reversed(pw) for v in pair))
    return torch.nn.functional.pad(x, flat)
kernel_name = 'recurrent_scan__grouped_kv_mqa__mixer_gmlp__prompt'

def setup_inputs():

    _w = lambda a: (lambda t: t.to(torch.bfloat16) if t.is_floating_point() else t)(torch.as_tensor(a))

    def _A_setup():
        B, S, D, H = (1, 2048, 640, 32)
        Dh = D // H
        return {'x': _w((lambda *s: torch.randn(*s, dtype=torch.bfloat16) * 0.05)(B, S, D)), 'wq': _w((lambda *s: torch.randn(*s, dtype=torch.bfloat16) * 0.05)(D, H * Dh)), 'wk': _w((lambda *s: torch.randn(*s, dtype=torch.bfloat16) * 0.05)(D, Dh)), 'wv': _w((lambda *s: torch.randn(*s, dtype=torch.bfloat16) * 0.05)(D, Dh)), 'wo': _w((lambda *s: torch.randn(*s, dtype=torch.bfloat16) * 0.05)(H * Dh, D))}
    _A_in = _A_setup()

    def _B_setup():
        B, S, D, F = (1, 2048, 640, 1728)
        Fh = F // 2
        return {'x': _w((lambda *s: torch.randn(*s, dtype=torch.bfloat16) * 0.05)(B, S, D)), 'w_in': _w((lambda *s: torch.randn(*s, dtype=torch.bfloat16) * 1.6)(D, 2 * Fh)), 'w_sp': _w(0.01 * (lambda *s: torch.randn(*s, dtype=torch.bfloat16) * 1.6)(S, S)), 'b_sp': _w(1.0 + 0.01 * (lambda *s: torch.randn(*s, dtype=torch.bfloat16) * 0.05)(S)), 'w_out': _w((lambda *s: torch.randn(*s, dtype=torch.bfloat16) * 0.05)(Fh, D))}
    _B_in = _B_setup()
    return {'A_x': _A_in['x'], 'A_wq': _A_in['wq'], 'A_wk': _A_in['wk'], 'A_wv': _A_in['wv'], 'A_wo': _A_in['wo'], 'B_x': _B_in['x'], 'B_w_in': _B_in['w_in'], 'B_w_sp': _B_in['w_sp'], 'B_b_sp': _B_in['b_sp'], 'B_w_out': _B_in['w_out']}

def reference(A_x, A_wq, A_wk, A_wv, A_wo, B_x, B_w_in, B_w_sp, B_b_sp, B_w_out):

    def _A_ref(x, wq, wk, wv, wo):
        B, S, D = x.shape
        H = 32
        Dh = D // H
        q = (lambda x, *d: x.permute(*d))((x @ wq).reshape(B, S, H, Dh), 0, 2, 1, 3)
        k = x @ wk
        v = x @ wv
        scores = torch.einsum('bhqd,bkd->bhqk', q, k) * Dh ** (-0.5)
        p = _softmax(scores, axis=-1)
        o = torch.einsum('bhqk,bkd->bhqd', p, v)
        return (lambda x, *d: x.permute(*d))(o, 0, 2, 1, 3).reshape(B, S, H * Dh) @ wo

    def _B_ref(x, w_in, w_sp, b_sp, w_out):
        B, S, D = x.shape
        F = w_in.shape[-1]
        Fh = F // 2
        z = _gelu(torch.einsum('bsd,df->bsf', x, w_in))
        z1 = z[..., :Fh].clone()
        z2 = _layernorm(z[..., Fh:], axis=-1)
        g = torch.einsum('ts,bsf->btf', w_sp, z2) + b_sp[None, :, None]
        return torch.einsum('bsf,fd->bsd', z1 * g, w_out)
    x = A_x
    xn = _layernorm(x, axis=-1)
    s = _A_ref(xn, A_wq, A_wk, A_wv, A_wo)
    g = _silu(_B_ref(xn, B_w_in, B_w_sp, B_b_sp, B_w_out))
    return x + s * g
```

```asm
; @launch kernel=kg_kernel grid=(256,1,1) block=(512,1,1) lds=161536
.amdgcn_target "amdgcn-amd-amdhsa--gfx950"
.text
.globl kg_kernel
.p2align 8
.type kg_kernel,@function
kg_kernel:
  s_load_dwordx16 s[8:23], s[0:1], 0
  s_load_dwordx8 s[24:31], s[0:1], 64
  s_load_dwordx2 s[32:33], s[0:1], 96
  s_cmp_ge_u32 s2, 256
  s_cbranch_scc1 L_kg_end
  v_lshrrev_b32 v1, 6, v0
  s_bfe_u32 s34, s2, 0x20001
  s_lshl_b32 s34, s34, 3
  s_bfe_u32 s39, s2, 0x30003
  s_add_u32 s34, s34, s39
  s_and_b32 s35, s2, 1
  s_lshr_b32 s39, s2, 6
  s_lshl_b32 s35, s35, 2
  s_add_u32 s35, s35, s39
  s_xor_b32 s35, s35, 0
  s_cmp_ge_u32 s35, 4
  s_cselect_b32 s39, 3, 0
  s_xor_b32 s35, s35, s39
  v_readfirstlane_b32 s36, v1
  s_min_u32 s39, s35, 3
  s_mul_i32 s37, s35, 3
  s_sub_u32 s76, s37, s39
  s_add_u32 s37, s37, s39
  s_cmp_lt_u32 s35, 3
  s_cselect_b32 s38, 4, 3
  s_sub_u32 s39, s35, 3
  s_cmp_lt_u32 s39, 4
  s_cselect_b32 s77, 3, 2
  v_and_b32 v0, 63, v0
  v_mov_b32 v120, 161280
  v_mov_b32 v123, v0
  v_lshrrev_b32 v1, 3, v0
  v_and_b32 v2, 7, v0
  s_lshl_b32 s58, s36, 3
  v_add_u32 v3, s58, v1
  v_mul_u32_u24 v124, 1280, v3
  v_lshl_add_u32 v124, v2, 4, v124
  s_mul_i32 s59, s34, 81920
  s_and_b32 s56, s36, 3
  s_lshr_b32 s57, s36, 2
  s_mov_b32 s70, 0x01050400
  s_mov_b32 s71, 0x07060302
  s_lshl_b32 s58, s35, 3
  s_lshr_b64 s[70:71], s[70:71], s58
  s_and_b32 s81, s70, 0xff
  s_waitcnt lgkmcnt(0)
  s_mov_b32 s52, s8
  s_and_b32 s53, s9, 0xffff
  s_mov_b32 s54, 2621440
  s_mov_b32 s55, 0x20000
  buffer_load_dwordx4 v[80:83], v124, s[52:55], s59 offen offset:0
  buffer_load_dwordx4 v[84:87], v124, s[52:55], s59 offen offset:128
  buffer_load_dwordx4 v[88:91], v124, s[52:55], s59 offen offset:256
  buffer_load_dwordx4 v[92:95], v124, s[52:55], s59 offen offset:384
  buffer_load_dwordx4 v[96:99], v124, s[52:55], s59 offen offset:512
  buffer_load_dwordx4 v[100:103], v124, s[52:55], s59 offen offset:640
  buffer_load_dwordx4 v[104:107], v124, s[52:55], s59 offen offset:768
  buffer_load_dwordx4 v[108:111], v124, s[52:55], s59 offen offset:896
  buffer_load_dwordx4 v[112:115], v124, s[52:55], s59 offen offset:1024
  buffer_load_dwordx4 v[116:119], v124, s[52:55], s59 offen offset:1152
  s_mov_b32 s40, s32
  s_and_b32 s41, s33, 0xffff
  s_mov_b32 s42, 22405120
  s_mov_b32 s43, 0x20000
  s_mov_b32 s70, 0x0b070300
  s_mov_b32 s71, 0x1815120f
  s_lshl_b32 s58, s81, 3
  s_lshr_b64 s[70:71], s[70:71], s58
  s_and_b32 s70, s70, 0xff
  s_lshl_b32 s58, s70, 6
  s_add_u32 s58, s58, 1728
  s_mul_i32 s59, s35, 160
  s_movk_i32 s60, 3456
  s_cmp_eq_u32 s57, 0
  s_cselect_b32 s58, s59, s58
  s_cselect_b32 s60, 1280, s60
  s_cselect_b32 s44, s10, s20
  s_cselect_b32 s45, s11, s21
  s_and_b32 s67, s58, 127
  s_sub_u32 s58, s58, s67
  s_add_u32 s44, s44, s58
  s_addc_u32 s45, s45, 0
  s_and_b32 s45, s45, 0xffff
  s_mul_i32 s46, s60, 640
  s_sub_u32 s46, s46, s58
  s_mov_b32 s47, 0x20000
  v_lshrrev_b32 v4, 4, v0
  v_and_b32 v5, 15, v0
  v_lshlrev_b32 v6, 2, v4
  v_xor_b32 v5, v5, v6
  s_lshl_b32 s58, s56, 3
  v_add_u32 v4, s58, v4
  v_mul_lo_u32 v4, v4, s60
  v_lshl_add_u32 v125, v5, 4, v4
  s_lshl_b32 s58, s60, 2
  s_sub_u32 s58, s58, 1024
  v_add_u32 v126, s58, v125
  s_lshl_b32 s69, s60, 5
  s_lshl_b32 s63, s57, 13
  s_lshl_b32 s58, s56, 11
  s_add_u32 s63, s63, s58
  s_add_u32 s63, s63, 81920
  s_and_b32 s74, s34, 3
  s_mul_i32 s61, s74, s69
  s_lshl_b32 s61, s61, 2
  s_mul_i32 s39, s69, 20
  v_lshlrev_b32 v124, 4, v0
  s_cmp_eq_u32 s35, 6
  s_cselect_b32 s48, s12, s14
  s_cselect_b32 s49, s13, s15
  s_and_b32 s49, s49, 0xffff
  s_mov_b32 s50, 25600
  s_mov_b32 s51, 0x20000
  s_mul_i32 s62, s74, 5120
  v_lshrrev_b32 v4, 1, v3
  v_and_b32 v4, 7, v4
  v_xor_b32 v4, v4, v2
  v_lshlrev_b32 v4, 4, v4
  v_lshl_add_u32 v121, v3, 7, v4
  v_add_u32 v122, 40960, v121
  s_mov_b32 s75, 0xffff0000
  s_waitcnt vmcnt(9)
  v_lshlrev_b32 v0, 16, v80
  v_and_b32 v1, s75, v80
  v_lshlrev_b32 v2, 16, v81
  v_and_b32 v3, s75, v81
  v_lshlrev_b32 v4, 16, v82
  v_and_b32 v5, s75, v82
  v_lshlrev_b32 v6, 16, v83
  v_and_b32 v7, s75, v83
  s_waitcnt vmcnt(8)
  v_lshlrev_b32 v8, 16, v84
  v_and_b32 v9, s75, v84
  v_lshlrev_b32 v10, 16, v85
  v_and_b32 v11, s75, v85
  v_lshlrev_b32 v12, 16, v86
  v_and_b32 v13, s75, v86
  v_lshlrev_b32 v14, 16, v87
  v_and_b32 v15, s75, v87
  v_pk_add_f32 v[80:81], v[0:1], v[8:9]
  v_pk_mul_f32 v[84:85], v[0:1], v[0:1]
  v_pk_fma_f32 v[84:85], v[8:9], v[8:9], v[84:85]
  v_pk_add_f32 v[82:83], v[2:3], v[10:11]
  v_pk_mul_f32 v[86:87], v[2:3], v[2:3]
  v_pk_fma_f32 v[86:87], v[10:11], v[10:11], v[86:87]
  v_pk_add_f32 v[80:81], v[80:81], v[4:5]
  v_pk_fma_f32 v[84:85], v[4:5], v[4:5], v[84:85]
  v_pk_add_f32 v[80:81], v[80:81], v[12:13]
  v_pk_fma_f32 v[84:85], v[12:13], v[12:13], v[84:85]
  v_pk_add_f32 v[82:83], v[82:83], v[6:7]
  v_pk_fma_f32 v[86:87], v[6:7], v[6:7], v[86:87]
  v_pk_add_f32 v[82:83], v[82:83], v[14:15]
  v_pk_fma_f32 v[86:87], v[14:15], v[14:15], v[86:87]
  s_waitcnt vmcnt(7)
  v_lshlrev_b32 v16, 16, v88
  v_and_b32 v17, s75, v88
  v_lshlrev_b32 v18, 16, v89
  v_and_b32 v19, s75, v89
  v_lshlrev_b32 v20, 16, v90
  v_and_b32 v21, s75, v90
  v_lshlrev_b32 v22, 16, v91
  v_and_b32 v23, s75, v91
  v_pk_add_f32 v[80:81], v[80:81], v[16:17]
  v_pk_fma_f32 v[84:85], v[16:17], v[16:17], v[84:85]
  v_pk_add_f32 v[82:83], v[82:83], v[18:19]
  v_pk_fma_f32 v[86:87], v[18:19], v[18:19], v[86:87]
  v_pk_add_f32 v[80:81], v[80:81], v[20:21]
  v_pk_fma_f32 v[84:85], v[20:21], v[20:21], v[84:85]
  v_pk_add_f32 v[82:83], v[82:83], v[22:23]
  v_pk_fma_f32 v[86:87], v[22:23], v[22:23], v[86:87]
  s_waitcnt vmcnt(6)
  v_lshlrev_b32 v24, 16, v92
  v_and_b32 v25, s75, v92
  v_lshlrev_b32 v26, 16, v93
  v_and_b32 v27, s75, v93
  v_lshlrev_b32 v28, 16, v94
  v_and_b32 v29, s75, v94
  v_lshlrev_b32 v30, 16, v95
  v_and_b32 v31, s75, v95
  v_pk_add_f32 v[80:81], v[80:81], v[24:25]
  v_pk_fma_f32 v[84:85], v[24:25], v[24:25], v[84:85]
  v_pk_add_f32 v[82:83], v[82:83], v[26:27]
  v_pk_fma_f32 v[86:87], v[26:27], v[26:27], v[86:87]
  v_pk_add_f32 v[80:81], v[80:81], v[28:29]
  v_pk_fma_f32 v[84:85], v[28:29], v[28:29], v[84:85]
  v_pk_add_f32 v[82:83], v[82:83], v[30:31]
  v_pk_fma_f32 v[86:87], v[30:31], v[30:31], v[86:87]
  s_waitcnt vmcnt(5)
  v_lshlrev_b32 v32, 16, v96
  v_and_b32 v33, s75, v96
  v_lshlrev_b32 v34, 16, v97
  v_and_b32 v35, s75, v97
  v_lshlrev_b32 v36, 16, v98
  v_and_b32 v37, s75, v98
  v_lshlrev_b32 v38, 16, v99
  v_and_b32 v39, s75, v99
  v_pk_add_f32 v[80:81], v[80:81], v[32:33]
  v_pk_fma_f32 v[84:85], v[32:33], v[32:33], v[84:85]
  v_pk_add_f32 v[82:83], v[82:83], v[34:35]
  v_pk_fma_f32 v[86:87], v[34:35], v[34:35], v[86:87]
  v_pk_add_f32 v[80:81], v[80:81], v[36:37]
  v_pk_fma_f32 v[84:85], v[36:37], v[36:37], v[84:85]
  v_pk_add_f32 v[82:83], v[82:83], v[38:39]
  v_pk_fma_f32 v[86:87], v[38:39], v[38:39], v[86:87]
  s_waitcnt vmcnt(4)
  v_lshlrev_b32 v40, 16, v100
  v_and_b32 v41, s75, v100
  v_lshlrev_b32 v42, 16, v101
  v_and_b32 v43, s75, v101
  v_lshlrev_b32 v44, 16, v102
  v_and_b32 v45, s75, v102
  v_lshlrev_b32 v46, 16, v103
  v_and_b32 v47, s75, v103
  v_pk_add_f32 v[80:81], v[80:81], v[40:41]
  v_pk_fma_f32 v[84:85], v[40:41], v[40:41], v[84:85]
  v_pk_add_f32 v[82:83], v[82:83], v[42:43]
  v_pk_fma_f32 v[86:87], v[42:43], v[42:43], v[86:87]
  v_pk_add_f32 v[80:81], v[80:81], v[44:45]
  v_pk_fma_f32 v[84:85], v[44:45], v[44:45], v[84:85]
  v_pk_add_f32 v[82:83], v[82:83], v[46:47]
  v_pk_fma_f32 v[86:87], v[46:47], v[46:47], v[86:87]
  s_waitcnt vmcnt(3)
  v_lshlrev_b32 v48, 16, v104
  v_and_b32 v49, s75, v104
  v_lshlrev_b32 v50, 16, v105
  v_and_b32 v51, s75, v105
  v_lshlrev_b32 v52, 16, v106
  v_and_b32 v53, s75, v106
  v_lshlrev_b32 v54, 16, v107
  v_and_b32 v55, s75, v107
  v_pk_add_f32 v[80:81], v[80:81], v[48:49]
  v_pk_fma_f32 v[84:85], v[48:49], v[48:49], v[84:85]
  v_pk_add_f32 v[82:83], v[82:83], v[50:51]
  v_pk_fma_f32 v[86:87], v[50:51], v[50:51], v[86:87]
  v_pk_add_f32 v[80:81], v[80:81], v[52:53]
  v_pk_fma_f32 v[84:85], v[52:53], v[52:53], v[84:85]
  v_pk_add_f32 v[82:83], v[82:83], v[54:55]
  v_pk_fma_f32 v[86:87], v[54:55], v[54:55], v[86:87]
  s_waitcnt vmcnt(2)
  v_lshlrev_b32 v56, 16, v108
  v_and_b32 v57, s75, v108
  v_lshlrev_b32 v58, 16, v109
  v_and_b32 v59, s75, v109
  v_lshlrev_b32 v60, 16, v110
  v_and_b32 v61, s75, v110
  v_lshlrev_b32 v62, 16, v111
  v_and_b32 v63, s75, v111
  s_add_u32 m0, s63, 0
  s_nop 0
  buffer_load_dwordx4 v125, s[44:47], s61 offen lds
  buffer_load_dwordx4 v126, s[44:47], s61 offen offset:1024 lds
  s_add_u32 s61, s61, s69
  s_add_u32 m0, s63, 18432
  s_nop 0
  buffer_load_dwordx4 v125, s[44:47], s61 offen lds
  buffer_load_dwordx4 v126, s[44:47], s61 offen offset:1024 lds
  s_add_u32 s61, s61, s69
  s_add_u32 m0, s63, 36864
  s_nop 0
  buffer_load_dwordx4 v125, s[44:47], s61 offen lds
  buffer_load_dwordx4 v126, s[44:47], s61 offen offset:1024 lds
  s_add_u32 s61, s61, s69
  s_cmp_eq_u32 s36, 3
  s_cbranch_scc0 L_kg_nok
  s_lshr_b32 s58, s35, 1
  s_cmp_eq_u32 s58, 3
  s_cbranch_scc0 L_kg_nok
  s_mov_b32 m0, 98304
  s_nop 0
  buffer_load_dwordx4 v124, s[48:51], s62 offen lds
  buffer_load_dwordx4 v124, s[48:51], s62 offen offset:1024 lds
  s_add_u32 s62, s62, 1280
  s_mov_b32 m0, 116736
  s_nop 0
  buffer_load_dwordx4 v124, s[48:51], s62 offen lds
  buffer_load_dwordx4 v124, s[48:51], s62 offen offset:1024 lds
  s_add_u32 s62, s62, 1280
  s_mov_b32 m0, 135168
  s_nop 0
  buffer_load_dwordx4 v124, s[48:51], s62 offen lds
  buffer_load_dwordx4 v124, s[48:51], s62 offen offset:1024 lds
  s_add_u32 s62, s62, 1280
L_kg_nok:
  v_pk_add_f32 v[80:81], v[80:81], v[56:57]
  v_pk_fma_f32 v[84:85], v[56:57], v[56:57], v[84:85]
  v_pk_add_f32 v[82:83], v[82:83], v[58:59]
  v_pk_fma_f32 v[86:87], v[58:59], v[58:59], v[86:87]
  v_pk_add_f32 v[80:81], v[80:81], v[60:61]
  v_pk_fma_f32 v[84:85], v[60:61], v[60:61], v[84:85]
  v_pk_add_f32 v[82:83], v[82:83], v[62:63]
  v_pk_fma_f32 v[86:87], v[62:63], v[62:63], v[86:87]
  s_waitcnt vmcnt(7)
  v_lshlrev_b32 v64, 16, v112
  v_and_b32 v65, s75, v112
  v_lshlrev_b32 v66, 16, v113
  v_and_b32 v67, s75, v113
  v_lshlrev_b32 v68, 16, v114
  v_and_b32 v69, s75, v114
  v_lshlrev_b32 v70, 16, v115
  v_and_b32 v71, s75, v115
  v_pk_add_f32 v[80:81], v[80:81], v[64:65]
  v_pk_fma_f32 v[84:85], v[64:65], v[64:65], v[84:85]
  v_pk_add_f32 v[82:83], v[82:83], v[66:67]
  v_pk_fma_f32 v[86:87], v[66:67], v[66:67], v[86:87]
  v_pk_add_f32 v[80:81], v[80:81], v[68:69]
  v_pk_fma_f32 v[84:85], v[68:69], v[68:69], v[84:85]
  v_pk_add_f32 v[82:83], v[82:83], v[70:71]
  v_pk_fma_f32 v[86:87], v[70:71], v[70:71], v[86:87]
  s_waitcnt vmcnt(6)
  v_lshlrev_b32 v72, 16, v116
  v_and_b32 v73, s75, v116
  v_lshlrev_b32 v74, 16, v117
  v_and_b32 v75, s75, v117
  v_lshlrev_b32 v76, 16, v118
  v_and_b32 v77, s75, v118
  v_lshlrev_b32 v78, 16, v119
  v_and_b32 v79, s75, v119
  v_pk_add_f32 v[80:81], v[80:81], v[72:73]
  v_pk_fma_f32 v[84:85], v[72:73], v[72:73], v[84:85]
  v_pk_add_f32 v[82:83], v[82:83], v[74:75]
  v_pk_fma_f32 v[86:87], v[74:75], v[74:75], v[86:87]
  v_pk_add_f32 v[80:81], v[80:81], v[76:77]
  v_pk_fma_f32 v[84:85], v[76:77], v[76:77], v[84:85]
  v_pk_add_f32 v[82:83], v[82:83], v[78:79]
  v_pk_fma_f32 v[86:87], v[78:79], v[78:79], v[86:87]
  v_pk_add_f32 v[80:81], v[80:81], v[82:83]
  v_pk_add_f32 v[84:85], v[84:85], v[86:87]
  v_add_f32 v80, v80, v81
  v_add_f32 v84, v84, v85
  s_nop 0
  v_add_f32_dpp v80, v80, v80 quad_perm:[1,0,3,2] row_mask:0xf bank_mask:0xf
  v_add_f32_dpp v84, v84, v84 quad_perm:[1,0,3,2] row_mask:0xf bank_mask:0xf
  s_nop 0
  v_add_f32_dpp v80, v80, v80 quad_perm:[2,3,0,1] row_mask:0xf bank_mask:0xf
  v_add_f32_dpp v84, v84, v84 quad_perm:[2,3,0,1] row_mask:0xf bank_mask:0xf
  s_nop 0
  v_add_f32_dpp v80, v80, v80 row_half_mirror row_mask:0xf bank_mask:0xf
  v_add_f32_dpp v84, v84, v84 row_half_mirror row_mask:0xf bank_mask:0xf
  v_mul_f32 v80, 0x3acccccd, v80
  v_mul_f32 v84, 0x3acccccd, v84
  v_fma_f32 v84, -v80, v80, v84
  v_max_f32 v84, 0, v84
  v_cvt_pk_bf16_f32 v84, v84, v80
  v_and_b32 v81, s75, v84
  v_lshlrev_b32 v84, 16, v84
  v_add_f32 v84, 0x3727c5ac, v84
  v_cvt_pk_bf16_f32 v84, v84, v84
  v_lshlrev_b32 v84, 16, v84
  v_sqrt_f32 v84, v84
  s_nop 0
  v_cvt_pk_bf16_f32 v84, v84, v84
  v_lshlrev_b32 v84, 16, v84
  v_rcp_f32 v80, v84
  s_nop 0
  v_mul_f32 v82, -v81, v80
  v_pk_fma_f32 v[0:1], v[0:1], v[80:81], v[82:83] op_sel_hi:[1,0,0]
  v_pk_fma_f32 v[2:3], v[2:3], v[80:81], v[82:83] op_sel_hi:[1,0,0]
  v_pk_fma_f32 v[4:5], v[4:5], v[80:81], v[82:83] op_sel_hi:[1,0,0]
  v_pk_fma_f32 v[6:7], v[6:7], v[80:81], v[82:83] op_sel_hi:[1,0,0]
  v_cvt_pk_bf16_f32 v84, v0, v1
  v_cvt_pk_bf16_f32 v85, v2, v3
  v_cvt_pk_bf16_f32 v86, v4, v5
  v_cvt_pk_bf16_f32 v87, v6, v7
  ds_write_b128 v121, v[84:87] offset:0
  v_pk_fma_f32 v[8:9], v[8:9], v[80:81], v[82:83] op_sel_hi:[1,0,0]
  v_pk_fma_f32 v[10:11], v[10:11], v[80:81], v[82:83] op_sel_hi:[1,0,0]
  v_pk_fma_f32 v[12:13], v[12:13], v[80:81], v[82:83] op_sel_hi:[1,0,0]
  v_pk_fma_f32 v[14:15], v[14:15], v[80:81], v[82:83] op_sel_hi:[1,0,0]
  v_cvt_pk_bf16_f32 v88, v8, v9
  v_cvt_pk_bf16_f32 v89, v10, v11
  v_cvt_pk_bf16_f32 v90, v12, v13
  v_cvt_pk_bf16_f32 v91, v14, v15
  ds_write_b128 v121, v[88:91] offset:8192
  v_pk_fma_f32 v[16:17], v[16:17], v[80:81], v[82:83] op_sel_hi:[1,0,0]
  v_pk_fma_f32 v[18:19], v[18:19], v[80:81], v[82:83] op_sel_hi:[1,0,0]
  v_pk_fma_f32 v[20:21], v[20:21], v[80:81], v[82:83] op_sel_hi:[1,0,0]
  v_pk_fma_f32 v[22:23], v[22:23], v[80:81], v[82:83] op_sel_hi:[1,0,0]
  v_cvt_pk_bf16_f32 v92, v16, v17
  v_cvt_pk_bf16_f32 v93, v18, v19
  v_cvt_pk_bf16_f32 v94, v20, v21
  v_cvt_pk_bf16_f32 v95, v22, v23
  ds_write_b128 v121, v[92:95] offset:16384
  v_pk_fma_f32 v[24:25], v[24:25], v[80:81], v[82:83] op_sel_hi:[1,0,0]
  v_pk_fma_f32 v[26:27], v[26:27], v[80:81], v[82:83] op_sel_hi:[1,0,0]
  v_pk_fma_f32 v[28:29], v[28:29], v[80:81], v[82:83] op_sel_hi:[1,0,0]
  v_pk_fma_f32 v[30:31], v[30:31], v[80:81], v[82:83] op_sel_hi:[1,0,0]
  v_cvt_pk_bf16_f32 v96, v24, v25
  v_cvt_pk_bf16_f32 v97, v26, v27
  v_cvt_pk_bf16_f32 v98, v28, v29
  v_cvt_pk_bf16_f32 v99, v30, v31
  ds_write_b128 v121, v[96:99] offset:24576
  v_pk_fma_f32 v[32:33], v[32:33], v[80:81], v[82:83] op_sel_hi:[1,0,0]
  v_pk_fma_f32 v[34:35], v[34:35], v[80:81], v[82:83] op_sel_hi:[1,0,0]
  v_pk_fma_f32 v[36:37], v[36:37], v[80:81], v[82:83] op_sel_hi:[1,0,0]
  v_pk_fma_f32 v[38:39], v[38:39], v[80:81], v[82:83] op_sel_hi:[1,0,0]
  v_cvt_pk_bf16_f32 v100, v32, v33
  v_cvt_pk_bf16_f32 v101, v34, v35
  v_cvt_pk_bf16_f32 v102, v36, v37
  v_cvt_pk_bf16_f32 v103, v38, v39
  ds_write_b128 v121, v[100:103] offset:32768
  v_pk_fma_f32 v[40:41], v[40:41], v[80:81], v[82:83] op_sel_hi:[1,0,0]
  v_pk_fma_f32 v[42:43], v[42:43], v[80:81], v[82:83] op_sel_hi:[1,0,0]
  v_pk_fma_f32 v[44:45], v[44:45], v[80:81], v[82:83] op_sel_hi:[1,0,0]
  v_pk_fma_f32 v[46:47], v[46:47], v[80:81], v[82:83] op_sel_hi:[1,0,0]
  v_cvt_pk_bf16_f32 v104, v40, v41
  v_cvt_pk_bf16_f32 v105, v42, v43
  v_cvt_pk_bf16_f32 v106, v44, v45
  v_cvt_pk_bf16_f32 v107, v46, v47
  ds_write_b128 v122, v[104:107] offset:0
  v_pk_fma_f32 v[48:49], v[48:49], v[80:81], v[82:83] op_sel_hi:[1,0,0]
  v_pk_fma_f32 v[50:51], v[50:51], v[80:81], v[82:83] op_sel_hi:[1,0,0]
  v_pk_fma_f32 v[52:53], v[52:53], v[80:81], v[82:83] op_sel_hi:[1,0,0]
  v_pk_fma_f32 v[54:55], v[54:55], v[80:81], v[82:83] op_sel_hi:[1,0,0]
  v_cvt_pk_bf16_f32 v108, v48, v49
  v_cvt_pk_bf16_f32 v109, v50, v51
  v_cvt_pk_bf16_f32 v110, v52, v53
  v_cvt_pk_bf16_f32 v111, v54, v55
  ds_write_b128 v122, v[108:111] offset:8192
  v_pk_fma_f32 v[56:57], v[56:57], v[80:81], v[82:83] op_sel_hi:[1,0,0]
  v_pk_fma_f32 v[58:59], v[58:59], v[80:81], v[82:83] op_sel_hi:[1,0,0]
  v_pk_fma_f32 v[60:61], v[60:61], v[80:81], v[82:83] op_sel_hi:[1,0,0]
  v_pk_fma_f32 v[62:63], v[62:63], v[80:81], v[82:83] op_sel_hi:[1,0,0]
  v_cvt_pk_bf16_f32 v112, v56, v57
  v_cvt_pk_bf16_f32 v113, v58, v59
  v_cvt_pk_bf16_f32 v114, v60, v61
  v_cvt_pk_bf16_f32 v115, v62, v63
  ds_write_b128 v122, v[112:115] offset:16384
  v_pk_fma_f32 v[64:65], v[64:65], v[80:81], v[82:83] op_sel_hi:[1,0,0]
  v_pk_fma_f32 v[66:67], v[66:67], v[80:81], v[82:83] op_sel_hi:[1,0,0]
  v_pk_fma_f32 v[68:69], v[68:69], v[80:81], v[82:83] op_sel_hi:[1,0,0]
  v_pk_fma_f32 v[70:71], v[70:71], v[80:81], v[82:83] op_sel_hi:[1,0,0]
  v_cvt_pk_bf16_f32 v84, v64, v65
  v_cvt_pk_bf16_f32 v85, v66, v67
  v_cvt_pk_bf16_f32 v86, v68, v69
  v_cvt_pk_bf16_f32 v87, v70, v71
  ds_write_b128 v122, v[84:87] offset:24576
  v_pk_fma_f32 v[72:73], v[72:73], v[80:81], v[82:83] op_sel_hi:[1,0,0]
  v_pk_fma_f32 v[74:75], v[74:75], v[80:81], v[82:83] op_sel_hi:[1,0,0]
  v_pk_fma_f32 v[76:77], v[76:77], v[80:81], v[82:83] op_sel_hi:[1,0,0]
  v_pk_fma_f32 v[78:79], v[78:79], v[80:81], v[82:83] op_sel_hi:[1,0,0]
  v_cvt_pk_bf16_f32 v88, v72, v73
  v_cvt_pk_bf16_f32 v89, v74, v75
  v_cvt_pk_bf16_f32 v90, v76, v77
  v_cvt_pk_bf16_f32 v91, v78, v79
  ds_write_b128 v122, v[88:91] offset:32768
  v_mov_b32 v53, v125
  v_mov_b32 v54, v126
  v_mov_b32 v55, v124
  v_lshrrev_b32 v56, 5, v123
  v_and_b32 v57, 31, v123
  v_bfe_u32 v58, v123, 1, 3
  v_xor_b32 v58, v58, v56
  v_lshlrev_b32 v58, 4, v58
  v_lshl_add_u32 v48, v57, 7, v58
  s_lshl_b32 s58, s74, 14
  v_add_u32 v48, s58, v48
  v_xor_b32 v49, 32, v48
  v_xor_b32 v50, 64, v48
  v_xor_b32 v51, 96, v48
  v_bfe_u32 v58, v123, 2, 2
  v_lshl_add_u32 v59, v56, 3, v58
  v_bfe_u32 v60, v123, 4, 1
  v_and_b32 v61, 3, v123
  v_lshl_add_u32 v60, v60, 2, v61
  s_mov_b32 s65, 0
  s_cmp_ge_u32 s36, 4
  s_cbranch_scc1 L_kg_helper
  v_mov_b32 v24, 0
  v_mov_b32 v25, 0
  v_mov_b32 v26, 0
  v_mov_b32 v27, 0
  v_mov_b32 v28, 0
  v_mov_b32 v29, 0
  v_mov_b32 v30, 0
  v_mov_b32 v31, 0
  v_mov_b32 v32, 0
  v_mov_b32 v33, 0
  v_mov_b32 v34, 0
  v_mov_b32 v35, 0
  v_mov_b32 v36, 0
  v_mov_b32 v37, 0
  v_mov_b32 v38, 0
  v_mov_b32 v39, 0
  v_mov_b32 v40, 0
  v_mov_b32 v41, 0
  v_mov_b32 v42, 0
  v_mov_b32 v43, 0
  v_mov_b32 v44, 0
  v_mov_b32 v45, 0
  v_mov_b32 v46, 0
  v_mov_b32 v47, 0
  v_mfma_f32_32x32x16_bf16 v[64:79], v[24:27], v[24:27], 0
  v_mfma_f32_32x32x16_bf16 v[80:95], v[24:27], v[24:27], 0
  s_cmp_eq_u32 s36, 0
  s_cbranch_scc0 L_kg_a_nz
  v_mov_b32 v8, -1
  v_mov_b32 v9, -1
  v_mov_b32 v10, -1
  v_mov_b32 v11, -1
  s_lshl_b32 s58, s34, 3
  s_add_u32 s58, s58, s35
  s_lshl_b32 s58, s58, 10
  s_add_u32 s59, s58, 22142976
  buffer_store_dwordx4 v[24:27], v55, s[40:43], s59 offen sc1
  s_lshl_b32 s58, s58, 1
  s_add_u32 s58, s58, 6881280
  buffer_store_dwordx4 v[8:11], v55, s[40:43], s58 offen sc1
  buffer_store_dwordx4 v[8:11], v55, s[40:43], s58 offen offset:1024 sc1
  v_lshl_add_u32 v12, v123, 2, v120
  ds_write_b32 v12, v24
  s_waitcnt vmcnt(0)
  s_mov_b32 s52, s30
  s_and_b32 s53, s31, 0xffff
  s_mov_b32 s54, 256
  s_mov_b32 s55, 0x20000
  s_and_b32 s58, s2, 3
  s_bfe_u32 s59, s2, 0x10002
  s_lshl_b32 s59, s59, 5
  s_add_u32 s58, s58, s59
  s_lshl_b32 s58, s58, 2
  s_mov_b64 exec, 1
  v_mov_b32 v121, 0
  v_mov_b32 v122, 1
  buffer_atomic_add v122, v121, s[52:55], s58 offen offset:0 sc1
  s_mov_b64 exec, -1
  L_kg_a_nz:
  s_mov_b32 s66, 1
  s_cmp_eq_u32 s36, 3
  s_cbranch_scc1 L_kg_a_kv
  v_lshrrev_b32 v61, 1, v60
  v_mul_u32_u24 v62, 40, v61
  v_add_u32 v62, 32, v62
  v_lshrrev_b32 v61, 2, v60
  v_mul_u32_u24 v61, 40, v61
  v_and_b32 v63, 3, v60
  v_lshl_add_u32 v61, v63, 3, v61
  s_mul_i32 s58, s36, 80
  v_add_u32 v61, s58, v61
  s_cmp_eq_u32 s36, 2
  s_cselect_b64 s[70:71], -1, 0
  v_cndmask_b32 v61, v61, v62, s[70:71]
  v_add_u32 v61, s67, v61
  v_lshlrev_b32 v62, 6, v58
  v_xor_b32 v61, v61, v62
  v_lshl_add_u32 v52, v59, 8, v61
  v_add_u32 v52, 81920, v52
L_kg_Aq1:
  s_waitcnt vmcnt(4) lgkmcnt(0)
  s_barrier
  v_mfma_f32_32x32x16_bf16 v[64:79], v[24:27], v[28:31], v[64:79]
  ds_read_b64_tr_b16 v[0:1], v52 offset:0
  ds_read_b64_tr_b16 v[2:3], v52 offset:1024
  ds_read_b128 v[4:7], v48 offset:0
  v_mfma_f32_32x32x16_bf16 v[80:95], v[24:27], v[32:35], v[80:95]
  ds_read_b128 v[8:11], v48 offset:4096
  ds_read_b64_tr_b16 v[12:13], v52 offset:4096
  ds_read_b64_tr_b16 v[14:15], v52 offset:5120
  v_mfma_f32_32x32x16_bf16 v[64:79], v[36:39], v[40:43], v[64:79]
  ds_read_b128 v[16:19], v49 offset:0
  ds_read_b128 v[20:23], v49 offset:4096
  v_mfma_f32_32x32x16_bf16 v[80:95], v[36:39], v[44:47], v[80:95]
  s_add_u32 m0, s63, 55296
  s_nop 0
  buffer_load_dwordx4 v53, s[44:47], s61 offen lds
  buffer_load_dwordx4 v54, s[44:47], s61 offen offset:1024 lds
  s_add_u32 s61, s61, s69
  s_cmp_eq_u32 s61, s39
  s_cselect_b32 s61, 0, s61
  s_cmp_ge_u32 s65, 4
  s_cselect_b32 s46, 0, s46
  s_waitcnt vmcnt(4) lgkmcnt(0)
  s_barrier
  v_mfma_f32_32x32x16_bf16 v[64:79], v[0:3], v[4:7], v[64:79]
  ds_read_b64_tr_b16 v[24:25], v52 offset:18432
  ds_read_b64_tr_b16 v[26:27], v52 offset:19456
  ds_read_b128 v[28:31], v50 offset:0
  v_mfma_f32_32x32x16_bf16 v[80:95], v[0:3], v[8:11], v[80:95]
  ds_read_b128 v[32:35], v50 offset:4096
  ds_read_b64_tr_b16 v[36:37], v52 offset:22528
  ds_read_b64_tr_b16 v[38:39], v52 offset:23552
  v_mfma_f32_32x32x16_bf16 v[64:79], v[12:15], v[16:19], v[64:79]
  ds_read_b128 v[40:43], v51 offset:0
  ds_read_b128 v[44:47], v51 offset:4096
  v_mfma_f32_32x32x16_bf16 v[80:95], v[12:15], v[20:23], v[80:95]
  s_add_u32 m0, s63, 0
  s_nop 0
  buffer_load_dwordx4 v53, s[44:47], s61 offen lds
  buffer_load_dwordx4 v54, s[44:47], s61 offen offset:1024 lds
  s_add_u32 s61, s61, s69
  s_waitcnt vmcnt(4) lgkmcnt(0)
  s_barrier
  v_mfma_f32_32x32x16_bf16 v[64:79], v[24:27], v[28:31], v[64:79]
  ds_read_b64_tr_b16 v[0:1], v52 offset:36864
  ds_read_b64_tr_b16 v[2:3], v52 offset:37888
  ds_read_b128 v[4:7], v48 offset:8192
  v_mfma_f32_32x32x16_bf16 v[80:95], v[24:27], v[32:35], v[80:95]
  ds_read_b128 v[8:11], v48 offset:12288
  ds_read_b64_tr_b16 v[12:13], v52 offset:40960
  ds_read_b64_tr_b16 v[14:15], v52 offset:41984
  v_mfma_f32_32x32x16_bf16 v[64:79], v[36:39], v[40:43], v[64:79]
  ds_read_b128 v[16:19], v49 offset:8192
  ds_read_b128 v[20:23], v49 offset:12288
  v_mfma_f32_32x32x16_bf16 v[80:95], v[36:39], v[44:47], v[80:95]
  s_add_u32 m0, s63, 18432
  s_nop 0
  buffer_load_dwordx4 v53, s[44:47], s61 offen lds
  buffer_load_dwordx4 v54, s[44:47], s61 offen offset:1024 lds
  s_add_u32 s61, s61, s69
  s_add_u32 s58, s65, s74
  s_cmp_eq_u32 s58, 4
  s_movk_i32 s58, 16384
  s_cselect_b32 s58, 4294901760, s58
  s_add_u32 s65, s65, 1
  v_add_u32 v48, s58, v48
  v_add_u32 v49, s58, v49
  s_waitcnt vmcnt(4) lgkmcnt(0)
  s_barrier
  v_mfma_f32_32x32x16_bf16 v[64:79], v[0:3], v[4:7], v[64:79]
  ds_read_b64_tr_b16 v[24:25], v52 offset:55296
  ds_read_b64_tr_b16 v[26:27], v52 offset:56320
  ds_read_b128 v[28:31], v50 offset:8192
  v_mfma_f32_32x32x16_bf16 v[80:95], v[0:3], v[8:11], v[80:95]
  ds_read_b128 v[32:35], v50 offset:12288
  ds_read_b64_tr_b16 v[36:37], v52 offset:59392
  ds_read_b64_tr_b16 v[38:39], v52 offset:60416
  v_mfma_f32_32x32x16_bf16 v[64:79], v[12:15], v[16:19], v[64:79]
  ds_read_b128 v[40:43], v51 offset:8192
  ds_read_b128 v[44:47], v51 offset:12288
  v_mfma_f32_32x32x16_bf16 v[80:95], v[12:15], v[20:23], v[80:95]
  s_add_u32 m0, s63, 36864
  s_nop 0
  buffer_load_dwordx4 v53, s[44:47], s61 offen lds
  buffer_load_dwordx4 v54, s[44:47], s61 offen offset:1024 lds
  s_add_u32 s61, s61, s69
  v_add_u32 v50, s58, v50
  v_add_u32 v51, s58, v51
  s_cmp_lt_u32 s65, 5
  s_cbranch_scc1 L_kg_Aq1
L_kg_Aqe:
  s_waitcnt vmcnt(0) lgkmcnt(0)
  s_barrier
  v_mfma_f32_32x32x16_bf16 v[64:79], v[24:27], v[28:31], v[64:79]
  v_mfma_f32_32x32x16_bf16 v[80:95], v[24:27], v[32:35], v[80:95]
  v_mfma_f32_32x32x16_bf16 v[64:79], v[36:39], v[40:43], v[64:79]
  v_mfma_f32_32x32x16_bf16 v[80:95], v[36:39], v[44:47], v[80:95]
  s_lshl_b32 s58, s37, 6
  s_and_b32 s58, s58, 0xffffff80
  s_sub_u32 s59, 2211840, s58
  s_add_u32 s44, s20, s58
  s_addc_u32 s45, s21, 0
  s_and_b32 s45, s45, 0xffff
  s_mov_b32 s46, s59
  s_mov_b32 s47, 0x20000
  v_lshrrev_b32 v61, 4, v123
  v_and_b32 v62, 15, v123
  v_lshlrev_b32 v63, 2, v61
  v_xor_b32 v62, v62, v63
  s_lshl_b32 s58, s36, 4
  v_add_u32 v61, s58, v61
  v_mul_u32_u24 v61, 3456, v61
  v_lshl_add_u32 v48, v62, 4, v61
  v_add_u32 v49, 12800, v48
  v_add_u32 v50, 25600, v48
  v_add_u32 v51, 38400, v48
  s_lshl_b32 s63, s36, 12
  s_add_u32 s63, s63, 81920
  s_mul_i32 s61, s74, 442368
  s_add_u32 m0, s63, 0
  s_nop 0
  buffer_load_dwordx4 v48, s[44:47], s61 offen offset:0 lds
  buffer_load_dwordx4 v49, s[44:47], s61 offen offset:1024 lds
  buffer_load_dwordx4 v50, s[44:47], s61 offen offset:2048 lds
  buffer_load_dwordx4 v51, s[44:47], s61 offen offset:3072 lds
  s_add_u32 s61, s61, 221184
  s_add_u32 m0, s63, 18432
  s_nop 0
  buffer_load_dwordx4 v48, s[44:47], s61 offen offset:0 lds
  buffer_load_dwordx4 v49, s[44:47], s61 offen offset:1024 lds
  buffer_load_dwordx4 v50, s[44:47], s61 offen offset:2048 lds
  buffer_load_dwordx4 v51, s[44:47], s61 offen offset:3072 lds
  s_add_u32 s61, s61, 221184
  s_cmp_eq_u32 s61, 2211840
  s_cselect_b32 s61, 0, s61
  v_lshlrev_b32 v62, 3, v123
  s_mul_i32 s58, s36, 2560
  s_add_u32 s58, s58, 137216
  v_add_u32 v63, s58, v62
  v_add_u32 v62, 138240, v62
  v_mul_f32 v64, 0x3ea52b5c, v64
  v_mul_f32 v65, 0x3ea52b5c, v65
  v_mul_f32 v66, 0x3ea52b5c, v66
  v_mul_f32 v67, 0x3ea52b5c, v67
  v_mul_f32 v68, 0x3ea52b5c, v68
  v_mul_f32 v69, 0x3ea52b5c, v69
  v_mul_f32 v70, 0x3ea52b5c, v70
  v_mul_f32 v71, 0x3ea52b5c, v71
  v_mul_f32 v72, 0x3ea52b5c, v72
  v_mul_f32 v73, 0x3ea52b5c, v73
  v_mul_f32 v74, 0x3ea52b5c, v74
  v_mul_f32 v75, 0x3ea52b5c, v75
  v_mul_f32 v76, 0x3ea52b5c, v76
  v_mul_f32 v77, 0x3ea52b5c, v77
  v_mul_f32 v78, 0x3ea52b5c, v78
  v_mul_f32 v79, 0x3ea52b5c, v79
  v_mul_f32 v80, 0x3ea52b5c, v80
  v_mul_f32 v81, 0x3ea52b5c, v81
  v_mul_f32 v82, 0x3ea52b5c, v82
  v_mul_f32 v83, 0x3ea52b5c, v83
  v_mul_f32 v84, 0x3ea52b5c, v84
  v_mul_f32 v85, 0x3ea52b5c, v85
  v_mul_f32 v86, 0x3ea52b5c, v86
  v_mul_f32 v87, 0x3ea52b5c, v87
  v_mul_f32 v88, 0x3ea52b5c, v88
  v_mul_f32 v89, 0x3ea52b5c, v89
  v_mul_f32 v90, 0x3ea52b5c, v90
  v_mul_f32 v91, 0x3ea52b5c, v91
  v_mul_f32 v92, 0x3ea52b5c, v92
  v_mul_f32 v93, 0x3ea52b5c, v93
  v_mul_f32 v94, 0x3ea52b5c, v94
  v_mul_f32 v95, 0x3ea52b5c, v95
  v_cvt_pk_bf16_f32 v0, v64, v65
  v_cvt_pk_bf16_f32 v1, v66, v67
  v_cvt_pk_bf16_f32 v2, v68, v69
  v_cvt_pk_bf16_f32 v3, v70, v71
  v_cvt_pk_bf16_f32 v4, v72, v73
  v_cvt_pk_bf16_f32 v5, v74, v75
  v_cvt_pk_bf16_f32 v6, v76, v77
  v_cvt_pk_bf16_f32 v7, v78, v79
  v_cvt_pk_bf16_f32 v8, v80, v81
  v_cvt_pk_bf16_f32 v9, v82, v83
  v_cvt_pk_bf16_f32 v10, v84, v85
  v_cvt_pk_bf16_f32 v11, v86, v87
  v_cvt_pk_bf16_f32 v12, v88, v89
  v_cvt_pk_bf16_f32 v13, v90, v91
  v_cvt_pk_bf16_f32 v14, v92, v93
  v_cvt_pk_bf16_f32 v15, v94, v95
  s_cmp_eq_u32 s36, 2
  s_cbranch_scc1 L_kg_a_q2
  ds_write_b64 v63, v[0:1] offset:0
  ds_write_b64 v63, v[2:3] offset:512
  ds_write_b64 v63, v[4:5] offset:1280
  ds_write_b64 v63, v[6:7] offset:1792
  ds_write_b64 v63, v[8:9] offset:5120
  ds_write_b64 v63, v[10:11] offset:5632
  ds_write_b64 v63, v[12:13] offset:6400
  ds_write_b64 v63, v[14:15] offset:6912
L_kg_a_plain:
  s_waitcnt vmcnt(4) lgkmcnt(0)
  s_barrier
  s_add_u32 m0, s63, 36864
  s_nop 0
  buffer_load_dwordx4 v48, s[44:47], s61 offen offset:0 lds
  buffer_load_dwordx4 v49, s[44:47], s61 offen offset:1024 lds
  buffer_load_dwordx4 v50, s[44:47], s61 offen offset:2048 lds
  buffer_load_dwordx4 v51, s[44:47], s61 offen offset:3072 lds
  s_add_u32 s61, s61, 221184
  s_waitcnt vmcnt(4) lgkmcnt(0)
  s_barrier
  s_add_u32 m0, s63, 0
  s_nop 0
  buffer_load_dwordx4 v48, s[44:47], s61 offen offset:0 lds
  buffer_load_dwordx4 v49, s[44:47], s61 offen offset:1024 lds
  buffer_load_dwordx4 v50, s[44:47], s61 offen offset:2048 lds
  buffer_load_dwordx4 v51, s[44:47], s61 offen offset:3072 lds
  s_add_u32 s61, s61, 221184
  s_cmp_eq_u32 s61, 2211840
  s_cselect_b32 s61, 0, s61
  s_waitcnt vmcnt(4) lgkmcnt(0)
  s_barrier
  s_add_u32 m0, s63, 18432
  s_nop 0
  buffer_load_dwordx4 v48, s[44:47], s61 offen offset:0 lds
  buffer_load_dwordx4 v49, s[44:47], s61 offen offset:1024 lds
  buffer_load_dwordx4 v50, s[44:47], s61 offen offset:2048 lds
  buffer_load_dwordx4 v51, s[44:47], s61 offen offset:3072 lds
  s_add_u32 s61, s61, 221184
  s_waitcnt vmcnt(4) lgkmcnt(0)
  s_barrier
  s_add_u32 m0, s63, 36864
  s_nop 0
  buffer_load_dwordx4 v48, s[44:47], s61 offen offset:0 lds
  buffer_load_dwordx4 v49, s[44:47], s61 offen offset:1024 lds
  buffer_load_dwordx4 v50, s[44:47], s61 offen offset:2048 lds
  buffer_load_dwordx4 v51, s[44:47], s61 offen offset:3072 lds
  s_add_u32 s61, s61, 221184
  s_cmp_eq_u32 s61, 2211840
  s_cselect_b32 s61, 0, s61
  s_waitcnt vmcnt(4) lgkmcnt(0)
  s_barrier
  s_add_u32 m0, s63, 0
  s_nop 0
  buffer_load_dwordx4 v48, s[44:47], s61 offen offset:0 lds
  buffer_load_dwordx4 v49, s[44:47], s61 offen offset:1024 lds
  buffer_load_dwordx4 v50, s[44:47], s61 offen offset:2048 lds
  buffer_load_dwordx4 v51, s[44:47], s61 offen offset:3072 lds
  s_add_u32 s61, s61, 221184
  s_waitcnt vmcnt(4) lgkmcnt(0)
  s_barrier
  s_add_u32 m0, s63, 18432
  s_nop 0
  buffer_load_dwordx4 v48, s[44:47], s61 offen offset:0 lds
  buffer_load_dwordx4 v49, s[44:47], s61 offen offset:1024 lds
  buffer_load_dwordx4 v50, s[44:47], s61 offen offset:2048 lds
  buffer_load_dwordx4 v51, s[44:47], s61 offen offset:3072 lds
  s_add_u32 s61, s61, 221184
  s_cmp_eq_u32 s61, 2211840
  s_cselect_b32 s61, 0, s61
  s_waitcnt vmcnt(4) lgkmcnt(0)
  s_barrier
  s_add_u32 m0, s63, 36864
  s_nop 0
  buffer_load_dwordx4 v48, s[44:47], s61 offen offset:0 lds
  buffer_load_dwordx4 v49, s[44:47], s61 offen offset:1024 lds
  buffer_load_dwordx4 v50, s[44:47], s61 offen offset:2048 lds
  buffer_load_dwordx4 v51, s[44:47], s61 offen offset:3072 lds
  s_add_u32 s61, s61, 221184
  s_waitcnt vmcnt(4) lgkmcnt(0)
  s_barrier
  s_add_u32 m0, s63, 0
  s_nop 0
  buffer_load_dwordx4 v48, s[44:47], s61 offen offset:0 lds
  buffer_load_dwordx4 v49, s[44:47], s61 offen offset:1024 lds
  buffer_load_dwordx4 v50, s[44:47], s61 offen offset:2048 lds
  buffer_load_dwordx4 v51, s[44:47], s61 offen offset:3072 lds
  s_add_u32 s61, s61, 221184
  s_cmp_eq_u32 s61, 2211840
  s_cselect_b32 s61, 0, s61
  s_branch L_kg_a_done
L_kg_a_q2:
  s_mov_b32 exec_hi, 0
  ds_write_b64 v62, v[0:1] offset:0
  ds_write_b64 v62, v[2:3] offset:1280
  ds_write_b64 v62, v[4:5] offset:2560
  ds_write_b64 v62, v[6:7] offset:3840
  ds_write_b64 v62, v[8:9] offset:5120
  ds_write_b64 v62, v[10:11] offset:6400
  ds_write_b64 v62, v[12:13] offset:7680
  ds_write_b64 v62, v[14:15] offset:8960
  s_mov_b32 exec_hi, -1
  v_lshlrev_b32 v41, 2, v123
  s_lshr_b32 s62, s34, 2
  s_lshl_b32 s62, s62, 15
  s_add_u32 s62, s62, 22142976
  s_waitcnt vmcnt(4) lgkmcnt(0)
  s_barrier
  s_add_u32 m0, s63, 36864
  s_nop 0
  buffer_load_dwordx4 v48, s[44:47], s61 offen offset:0 lds
  buffer_load_dwordx4 v49, s[44:47], s61 offen offset:1024 lds
  buffer_load_dwordx4 v50, s[44:47], s61 offen offset:2048 lds
  buffer_load_dwordx4 v51, s[44:47], s61 offen offset:3072 lds
  s_add_u32 s61, s61, 221184
  s_waitcnt vmcnt(4) lgkmcnt(0)
  s_barrier
  s_add_u32 m0, s63, 0
  s_nop 0
  buffer_load_dwordx4 v48, s[44:47], s61 offen offset:0 lds
  buffer_load_dwordx4 v49, s[44:47], s61 offen offset:1024 lds
  buffer_load_dwordx4 v50, s[44:47], s61 offen offset:2048 lds
  buffer_load_dwordx4 v51, s[44:47], s61 offen offset:3072 lds
  s_add_u32 s61, s61, 221184
  s_cmp_eq_u32 s61, 2211840
  s_cselect_b32 s61, 0, s61
  s_waitcnt vmcnt(4) lgkmcnt(0)
  s_barrier
  s_add_u32 m0, s63, 18432
  s_nop 0
  buffer_load_dwordx4 v48, s[44:47], s61 offen offset:0 lds
  buffer_load_dwordx4 v49, s[44:47], s61 offen offset:1024 lds
  buffer_load_dwordx4 v50, s[44:47], s61 offen offset:2048 lds
  buffer_load_dwordx4 v51, s[44:47], s61 offen offset:3072 lds
  s_add_u32 s61, s61, 221184
  s_waitcnt vmcnt(4) lgkmcnt(0)
  s_barrier
  s_add_u32 m0, s63, 36864
  s_nop 0
  buffer_load_dwordx4 v48, s[44:47], s61 offen offset:0 lds
  buffer_load_dwordx4 v49, s[44:47], s61 offen offset:1024 lds
  buffer_load_dwordx4 v50, s[44:47], s61 offen offset:2048 lds
  buffer_load_dwordx4 v51, s[44:47], s61 offen offset:3072 lds
  s_add_u32 s61, s61, 221184
  s_cmp_eq_u32 s61, 2211840
  s_cselect_b32 s61, 0, s61
  s_waitcnt vmcnt(4) lgkmcnt(0)
  s_barrier
  s_add_u32 m0, s63, 0
  s_nop 0
  buffer_load_dwordx4 v48, s[44:47], s61 offen offset:0 lds
  buffer_load_dwordx4 v49, s[44:47], s61 offen offset:1024 lds
  buffer_load_dwordx4 v50, s[44:47], s61 offen offset:2048 lds
  buffer_load_dwordx4 v51, s[44:47], s61 offen offset:3072 lds
  s_add_u32 s61, s61, 221184
  s_waitcnt vmcnt(4) lgkmcnt(0)
  s_barrier
  s_add_u32 m0, s63, 18432
  s_nop 0
  buffer_load_dwordx4 v48, s[44:47], s61 offen offset:0 lds
  buffer_load_dwordx4 v49, s[44:47], s61 offen offset:1024 lds
  buffer_load_dwordx4 v50, s[44:47], s61 offen offset:2048 lds
  buffer_load_dwordx4 v51, s[44:47], s61 offen offset:3072 lds
  s_add_u32 s61, s61, 221184
  s_cmp_eq_u32 s61, 2211840
  s_cselect_b32 s61, 0, s61
  s_waitcnt vmcnt(4) lgkmcnt(0)
  s_barrier
  buffer_load_dword v40, v41, s[40:43], s62 offen sc1
  s_add_u32 m0, s63, 36864
  s_nop 0
  buffer_load_dwordx4 v48, s[44:47], s61 offen offset:0 lds
  buffer_load_dwordx4 v49, s[44:47], s61 offen offset:1024 lds
  buffer_load_dwordx4 v50, s[44:47], s61 offen offset:2048 lds
  buffer_load_dwordx4 v51, s[44:47], s61 offen offset:3072 lds
  s_add_u32 s61, s61, 221184
  s_waitcnt vmcnt(4) lgkmcnt(0)
  s_barrier
  s_waitcnt vmcnt(0)
  v_cmp_gt_u32 vcc, 1, v40
  s_nop 4
  s_cbranch_vccnz L_kg_a_nfk
  s_mov_b64 exec, 1
  v_mov_b32 v121, 1
  ds_add_u32 v120, v121 offset:40
  s_mov_b64 exec, -1
L_kg_a_nfk:
  s_add_u32 m0, s63, 0
  s_nop 0
  buffer_load_dwordx4 v48, s[44:47], s61 offen offset:0 lds
  buffer_load_dwordx4 v49, s[44:47], s61 offen offset:1024 lds
  buffer_load_dwordx4 v50, s[44:47], s61 offen offset:2048 lds
  buffer_load_dwordx4 v51, s[44:47], s61 offen offset:3072 lds
  s_add_u32 s61, s61, 221184
  s_cmp_eq_u32 s61, 2211840
  s_cselect_b32 s61, 0, s61
  s_branch L_kg_a_done
  L_kg_a_kv:
  s_lshr_b32 s58, s35, 1
  s_cmp_eq_u32 s58, 3
  s_cselect_b32 s66, 1, 0
  v_mul_u32_u24 v61, 40, v59
  v_lshl_add_u32 v61, v60, 3, v61
  v_add_u32 v52, 98304, v61
  s_waitcnt vmcnt(0)
  s_cmp_eq_u32 s66, 0
  s_cbranch_scc1 L_kg_Ak0
L_kg_Ak1:
  s_waitcnt vmcnt(8) lgkmcnt(0)
  s_barrier
  v_mfma_f32_32x32x16_bf16 v[64:79], v[24:27], v[28:31], v[64:79]
  ds_read_b64_tr_b16 v[0:1], v52 offset:0
  ds_read_b64_tr_b16 v[2:3], v52 offset:160
  ds_read_b128 v[4:7], v48 offset:0
  v_mfma_f32_32x32x16_bf16 v[80:95], v[24:27], v[32:35], v[80:95]
  ds_read_b128 v[8:11], v48 offset:4096
  ds_read_b64_tr_b16 v[12:13], v52 offset:640
  ds_read_b64_tr_b16 v[14:15], v52 offset:800
  v_mfma_f32_32x32x16_bf16 v[64:79], v[36:39], v[40:43], v[64:79]
  ds_read_b128 v[16:19], v49 offset:0
  ds_read_b128 v[20:23], v49 offset:4096
  v_mfma_f32_32x32x16_bf16 v[80:95], v[36:39], v[44:47], v[80:95]
  s_add_u32 m0, s63, 55296
  s_nop 0
  buffer_load_dwordx4 v53, s[44:47], s61 offen lds
  buffer_load_dwordx4 v54, s[44:47], s61 offen offset:1024 lds
  s_add_u32 s61, s61, s69
  s_cmp_eq_u32 s61, s39
  s_cselect_b32 s61, 0, s61
  s_mov_b32 m0, 153600
  s_nop 0
  buffer_load_dwordx4 v55, s[48:51], s62 offen lds
  buffer_load_dwordx4 v55, s[48:51], s62 offen offset:1024 lds
  s_add_u32 s62, s62, 1280
  s_cmp_eq_u32 s62, 25600
  s_cselect_b32 s62, 0, s62
  s_cmp_ge_u32 s65, 4
  s_cselect_b32 s46, 0, s46
  s_cselect_b32 s50, 0, s50
  s_waitcnt vmcnt(8) lgkmcnt(0)
  s_barrier
  v_mfma_f32_32x32x16_bf16 v[64:79], v[0:3], v[4:7], v[64:79]
  ds_read_b64_tr_b16 v[24:25], v52 offset:18432
  ds_read_b64_tr_b16 v[26:27], v52 offset:18592
  ds_read_b128 v[28:31], v50 offset:0
  v_mfma_f32_32x32x16_bf16 v[80:95], v[0:3], v[8:11], v[80:95]
  ds_read_b128 v[32:35], v50 offset:4096
  ds_read_b64_tr_b16 v[36:37], v52 offset:19072
  ds_read_b64_tr_b16 v[38:39], v52 offset:19232
  v_mfma_f32_32x32x16_bf16 v[64:79], v[12:15], v[16:19], v[64:79]
  ds_read_b128 v[40:43], v51 offset:0
  ds_read_b128 v[44:47], v51 offset:4096
  v_mfma_f32_32x32x16_bf16 v[80:95], v[12:15], v[20:23], v[80:95]
  s_add_u32 m0, s63, 0
  s_nop 0
  buffer_load_dwordx4 v53, s[44:47], s61 offen lds
  buffer_load_dwordx4 v54, s[44:47], s61 offen offset:1024 lds
  s_add_u32 s61, s61, s69
  s_mov_b32 m0, 98304
  s_nop 0
  buffer_load_dwordx4 v55, s[48:51], s62 offen lds
  buffer_load_dwordx4 v55, s[48:51], s62 offen offset:1024 lds
  s_add_u32 s62, s62, 1280
  s_waitcnt vmcnt(8) lgkmcnt(0)
  s_barrier
  v_mfma_f32_32x32x16_bf16 v[64:79], v[24:27], v[28:31], v[64:79]
  ds_read_b64_tr_b16 v[0:1], v52 offset:36864
  ds_read_b64_tr_b16 v[2:3], v52 offset:37024
  ds_read_b128 v[4:7], v48 offset:8192
  v_mfma_f32_32x32x16_bf16 v[80:95], v[24:27], v[32:35], v[80:95]
  ds_read_b128 v[8:11], v48 offset:12288
  ds_read_b64_tr_b16 v[12:13], v52 offset:37504
  ds_read_b64_tr_b16 v[14:15], v52 offset:37664
  v_mfma_f32_32x32x16_bf16 v[64:79], v[36:39], v[40:43], v[64:79]
  ds_read_b128 v[16:19], v49 offset:8192
  ds_read_b128 v[20:23], v49 offset:12288
  v_mfma_f32_32x32x16_bf16 v[80:95], v[36:39], v[44:47], v[80:95]
  s_add_u32 m0, s63, 18432
  s_nop 0
  buffer_load_dwordx4 v53, s[44:47], s61 offen lds
  buffer_load_dwordx4 v54, s[44:47], s61 offen offset:1024 lds
  s_add_u32 s61, s61, s69
  s_mov_b32 m0, 116736
  s_nop 0
  buffer_load_dwordx4 v55, s[48:51], s62 offen lds
  buffer_load_dwordx4 v55, s[48:51], s62 offen offset:1024 lds
  s_add_u32 s62, s62, 1280
  s_add_u32 s58, s65, s74
  s_cmp_eq_u32 s58, 4
  s_movk_i32 s58, 16384
  s_cselect_b32 s58, 4294901760, s58
  s_add_u32 s65, s65, 1
  v_add_u32 v48, s58, v48
  v_add_u32 v49, s58, v49
  s_waitcnt vmcnt(8) lgkmcnt(0)
  s_barrier
  v_mfma_f32_32x32x16_bf16 v[64:79], v[0:3], v[4:7], v[64:79]
  ds_read_b64_tr_b16 v[24:25], v52 offset:55296
  ds_read_b64_tr_b16 v[26:27], v52 offset:55456
  ds_read_b128 v[28:31], v50 offset:8192
  v_mfma_f32_32x32x16_bf16 v[80:95], v[0:3], v[8:11], v[80:95]
  ds_read_b128 v[32:35], v50 offset:12288
  ds_read_b64_tr_b16 v[36:37], v52 offset:55936
  ds_read_b64_tr_b16 v[38:39], v52 offset:56096
  v_mfma_f32_32x32x16_bf16 v[64:79], v[12:15], v[16:19], v[64:79]
  ds_read_b128 v[40:43], v51 offset:8192
  ds_read_b128 v[44:47], v51 offset:12288
  v_mfma_f32_32x32x16_bf16 v[80:95], v[12:15], v[20:23], v[80:95]
  s_add_u32 m0, s63, 36864
  s_nop 0
  buffer_load_dwordx4 v53, s[44:47], s61 offen lds
  buffer_load_dwordx4 v54, s[44:47], s61 offen offset:1024 lds
  s_add_u32 s61, s61, s69
  s_mov_b32 m0, 135168
  s_nop 0
  buffer_load_dwordx4 v55, s[48:51], s62 offen lds
  buffer_load_dwordx4 v55, s[48:51], s62 offen offset:1024 lds
  s_add_u32 s62, s62, 1280
  v_add_u32 v50, s58, v50
  v_add_u32 v51, s58, v51
  s_cmp_lt_u32 s65, 5
  s_cbranch_scc1 L_kg_Ak1
  s_branch L_kg_Ake
L_kg_Ak0:
  s_waitcnt vmcnt(4) lgkmcnt(0)
  s_barrier
  s_add_u32 m0, s63, 55296
  s_nop 0
  buffer_load_dwordx4 v53, s[44:47], s61 offen lds
  buffer_load_dwordx4 v54, s[44:47], s61 offen offset:1024 lds
  s_add_u32 s61, s61, s69
  s_cmp_eq_u32 s61, s39
  s_cselect_b32 s61, 0, s61
  s_cmp_ge_u32 s65, 4
  s_cselect_b32 s46, 0, s46
  s_waitcnt vmcnt(4) lgkmcnt(0)
  s_barrier
  s_add_u32 m0, s63, 0
  s_nop 0
  buffer_load_dwordx4 v53, s[44:47], s61 offen lds
  buffer_load_dwordx4 v54, s[44:47], s61 offen offset:1024 lds
  s_add_u32 s61, s61, s69
  s_waitcnt vmcnt(4) lgkmcnt(0)
  s_barrier
  s_add_u32 m0, s63, 18432
  s_nop 0
  buffer_load_dwordx4 v53, s[44:47], s61 offen lds
  buffer_load_dwordx4 v54, s[44:47], s61 offen offset:1024 lds
  s_add_u32 s61, s61, s69
  s_add_u32 s58, s65, s74
  s_cmp_eq_u32 s58, 4
  s_movk_i32 s58, 16384
  s_cselect_b32 s58, 4294901760, s58
  s_add_u32 s65, s65, 1
  s_waitcnt vmcnt(4) lgkmcnt(0)
  s_barrier
  s_add_u32 m0, s63, 36864
  s_nop 0
  buffer_load_dwordx4 v53, s[44:47], s61 offen lds
  buffer_load_dwordx4 v54, s[44:47], s61 offen offset:1024 lds
  s_add_u32 s61, s61, s69
  s_cmp_lt_u32 s65, 5
  s_cbranch_scc1 L_kg_Ak0
L_kg_Ake:
  s_waitcnt vmcnt(0) lgkmcnt(0)
  s_barrier
  v_mfma_f32_32x32x16_bf16 v[64:79], v[24:27], v[28:31], v[64:79]
  v_mfma_f32_32x32x16_bf16 v[80:95], v[24:27], v[32:35], v[80:95]
  v_mfma_f32_32x32x16_bf16 v[64:79], v[36:39], v[40:43], v[64:79]
  v_mfma_f32_32x32x16_bf16 v[80:95], v[36:39], v[44:47], v[80:95]
  s_lshl_b32 s58, s37, 6
  s_and_b32 s58, s58, 0xffffff80
  s_sub_u32 s59, 2211840, s58
  s_add_u32 s44, s20, s58
  s_addc_u32 s45, s21, 0
  s_and_b32 s45, s45, 0xffff
  s_mov_b32 s46, s59
  s_mov_b32 s47, 0x20000
  v_lshrrev_b32 v61, 4, v123
  v_and_b32 v62, 15, v123
  v_lshlrev_b32 v63, 2, v61
  v_xor_b32 v62, v62, v63
  s_lshl_b32 s58, s36, 4
  v_add_u32 v61, s58, v61
  v_mul_u32_u24 v61, 3456, v61
  v_lshl_add_u32 v48, v62, 4, v61
  v_add_u32 v49, 12800, v48
  v_add_u32 v50, 25600, v48
  v_add_u32 v51, 38400, v48
  s_lshl_b32 s63, s36, 12
  s_add_u32 s63, s63, 81920
  s_mul_i32 s61, s74, 442368
  s_add_u32 m0, s63, 0
  s_nop 0
  buffer_load_dwordx4 v48, s[44:47], s61 offen offset:0 lds
  buffer_load_dwordx4 v49, s[44:47], s61 offen offset:1024 lds
  buffer_load_dwordx4 v50, s[44:47], s61 offen offset:2048 lds
  buffer_load_dwordx4 v51, s[44:47], s61 offen offset:3072 lds
  s_add_u32 s61, s61, 221184
  s_add_u32 m0, s63, 18432
  s_nop 0
  buffer_load_dwordx4 v48, s[44:47], s61 offen offset:0 lds
  buffer_load_dwordx4 v49, s[44:47], s61 offen offset:1024 lds
  buffer_load_dwordx4 v50, s[44:47], s61 offen offset:2048 lds
  buffer_load_dwordx4 v51, s[44:47], s61 offen offset:3072 lds
  s_add_u32 s61, s61, 221184
  s_cmp_eq_u32 s61, 2211840
  s_cselect_b32 s61, 0, s61
  s_cmp_eq_u32 s66, 0
  s_cbranch_scc1 L_kg_a_plain
  s_mov_b32 s52, s30
  s_and_b32 s53, s31, 0xffff
  s_mov_b32 s54, 256
  s_mov_b32 s55, 0x20000
  v_and_b32 v121, 3, v123
  v_bfe_u32 v122, v123, 2, 1
  v_lshl_add_u32 v121, v122, 5, v121
  v_lshlrev_b32 v41, 2, v121
  buffer_load_dword v40, v41, s[52:55], 0 offen offset:0 sc1
  v_cvt_pk_bf16_f32 v0, v64, v65
  v_cvt_pk_bf16_f32 v1, v66, v67
  v_cvt_pk_bf16_f32 v2, v68, v69
  v_cvt_pk_bf16_f32 v3, v70, v71
  v_cvt_pk_bf16_f32 v4, v72, v73
  v_cvt_pk_bf16_f32 v5, v74, v75
  v_cvt_pk_bf16_f32 v6, v76, v77
  v_cvt_pk_bf16_f32 v7, v78, v79
  v_cvt_pk_bf16_f32 v8, v80, v81
  v_cvt_pk_bf16_f32 v9, v82, v83
  v_cvt_pk_bf16_f32 v10, v84, v85
  v_cvt_pk_bf16_f32 v11, v86, v87
  v_cvt_pk_bf16_f32 v12, v88, v89
  v_cvt_pk_bf16_f32 v13, v90, v91
  v_cvt_pk_bf16_f32 v14, v92, v93
  v_cvt_pk_bf16_f32 v15, v94, v95
  v_lshlrev_b32 v62, 4, v123
  v_lshlrev_b32 v63, 3, v123
  s_mul_i32 s58, s34, 7168
  s_add_u32 s58, s58, 2621440
  s_add_u32 s59, s58, 3584
  s_mov_b32 s72, 0x3f803f80
  s_cmp_eq_u32 s35, 6
  s_cbranch_scc0 L_kg_a_v
  s_mov_b32 exec_lo, 0
  v_mov_b32 v4, s72
  v_mov_b32 v5, 0x3f80
  v_mov_b32 v12, s72
  v_mov_b32 v13, 0x3f80
  s_mov_b32 exec_lo, -1
  buffer_store_dwordx4 v[0:3], v62, s[40:43], s58 offen sc1
  buffer_store_dwordx2 v[4:5], v63, s[40:43], s58 offen offset:3072 sc1
  buffer_store_dwordx4 v[8:11], v62, s[40:43], s59 offen sc1
  buffer_store_dwordx2 v[12:13], v63, s[40:43], s59 offen offset:3072 sc1
  s_branch L_kg_a_kvs
  L_kg_a_v:
  v_mov_b32 v6, 0
  v_mov_b32 v7, 0
  v_mov_b32 v14, 0
  v_mov_b32 v15, 0
  s_mov_b32 exec_lo, 0
  v_mov_b32 v4, 0x3f80
  v_mov_b32 v5, 0
  v_mov_b32 v12, 0x3f80
  v_mov_b32 v13, 0
  s_mov_b32 exec_lo, -1
  v_lshlrev_b32 v32, 6, v57
  v_lshl_add_u32 v32, v56, 3, v32
  v_add_u32 v32, 155648, v32
  v_lshl_add_u32 v33, v56, 2, v58
  v_lshlrev_b32 v33, 6, v33
  v_lshl_add_u32 v33, v60, 3, v33
  v_add_u32 v33, 155648, v33
  ds_write_b64 v32, v[0:1] offset:0
  ds_write_b64 v32, v[2:3] offset:16
  ds_write_b64 v32, v[4:5] offset:32
  ds_write_b64 v32, v[6:7] offset:48
  ds_write_b64 v32, v[8:9] offset:2048
  ds_write_b64 v32, v[10:11] offset:2064
  ds_write_b64 v32, v[12:13] offset:2080
  ds_write_b64 v32, v[14:15] offset:2096
  ds_read_b64_tr_b16 v[16:17], v33 offset:0
  ds_read_b64_tr_b16 v[18:19], v33 offset:512
  ds_read_b64_tr_b16 v[20:21], v33 offset:1024
  ds_read_b64_tr_b16 v[22:23], v33 offset:1536
  ds_read_b64_tr_b16 v[24:25], v33 offset:2048
  ds_read_b64_tr_b16 v[26:27], v33 offset:2560
  ds_read_b64_tr_b16 v[28:29], v33 offset:3072
  ds_read_b64_tr_b16 v[30:31], v33 offset:3584
  s_waitcnt lgkmcnt(0)
  buffer_store_dwordx4 v[16:19], v62, s[40:43], s58 offen offset:1024 sc1
  buffer_store_dwordx4 v[20:23], v62, s[40:43], s58 offen offset:2048 sc1
  buffer_store_dwordx4 v[24:27], v62, s[40:43], s59 offen offset:1024 sc1
  buffer_store_dwordx4 v[28:31], v62, s[40:43], s59 offen offset:2048 sc1
  L_kg_a_kvs:
  v_lshlrev_b32 v62, 15, v123
  v_mov_b32 v63, 1
  s_lshl_b32 s62, s34, 1
  s_add_u32 s62, s62, s35
  s_sub_u32 s62, s62, 6
  s_lshl_b32 s62, s62, 2
  s_add_u32 s62, s62, 22142976
  s_waitcnt vmcnt(4) lgkmcnt(0)
  s_barrier
  s_mov_b32 s80, 0x200000
  L_kg_d_1:
  s_waitcnt vmcnt(0)
  v_cmp_gt_u32 vcc, 32, v40
  s_nop 4
  s_cbranch_vccz L_kg_d_1_d
  s_sleep 3
  buffer_load_dword v40, v41, s[52:55], 0 offen offset:0 sc1
  s_sub_u32 s80, s80, 1
  s_cbranch_scc0 L_kg_d_1
  L_kg_d_1_d:
  s_mov_b64 exec, 0xff
  buffer_store_dword v63, v62, s[40:43], s62 offen sc1
  s_mov_b64 exec, -1
  s_add_u32 m0, s63, 36864
  s_nop 0
  buffer_load_dwordx4 v48, s[44:47], s61 offen offset:0 lds
  buffer_load_dwordx4 v49, s[44:47], s61 offen offset:1024 lds
  buffer_load_dwordx4 v50, s[44:47], s61 offen offset:2048 lds
  buffer_load_dwordx4 v51, s[44:47], s61 offen offset:3072 lds
  s_add_u32 s61, s61, 221184
  s_waitcnt vmcnt(4) lgkmcnt(0)
  s_barrier
  s_add_u32 m0, s63, 0
  s_nop 0
  buffer_load_dwordx4 v48, s[44:47], s61 offen offset:0 lds
  buffer_load_dwordx4 v49, s[44:47], s61 offen offset:1024 lds
  buffer_load_dwordx4 v50, s[44:47], s61 offen offset:2048 lds
  buffer_load_dwordx4 v51, s[44:47], s61 offen offset:3072 lds
  s_add_u32 s61, s61, 221184
  s_cmp_eq_u32 s61, 2211840
  s_cselect_b32 s61, 0, s61
  s_waitcnt vmcnt(4) lgkmcnt(0)
  s_barrier
  s_add_u32 m0, s63, 18432
  s_nop 0
  buffer_load_dwordx4 v48, s[44:47], s61 offen offset:0 lds
  buffer_load_dwordx4 v49, s[44:47], s61 offen offset:1024 lds
  buffer_load_dwordx4 v50, s[44:47], s61 offen offset:2048 lds
  buffer_load_dwordx4 v51, s[44:47], s61 offen offset:3072 lds
  s_add_u32 s61, s61, 221184
  s_waitcnt vmcnt(4) lgkmcnt(0)
  s_barrier
  s_add_u32 m0, s63, 36864
  s_nop 0
  buffer_load_dwordx4 v48, s[44:47], s61 offen offset:0 lds
  buffer_load_dwordx4 v49, s[44:47], s61 offen offset:1024 lds
  buffer_load_dwordx4 v50, s[44:47], s61 offen offset:2048 lds
  buffer_load_dwordx4 v51, s[44:47], s61 offen offset:3072 lds
  s_add_u32 s61, s61, 221184
  s_cmp_eq_u32 s61, 2211840
  s_cselect_b32 s61, 0, s61
  s_waitcnt vmcnt(4) lgkmcnt(0)
  s_barrier
  s_add_u32 m0, s63, 0
  s_nop 0
  buffer_load_dwordx4 v48, s[44:47], s61 offen offset:0 lds
  buffer_load_dwordx4 v49, s[44:47], s61 offen offset:1024 lds
  buffer_load_dwordx4 v50, s[44:47], s61 offen offset:2048 lds
  buffer_load_dwordx4 v51, s[44:47], s61 offen offset:3072 lds
  s_add_u32 s61, s61, 221184
  s_waitcnt vmcnt(4) lgkmcnt(0)
  s_barrier
  s_add_u32 m0, s63, 18432
  s_nop 0
  buffer_load_dwordx4 v48, s[44:47], s61 offen offset:0 lds
  buffer_load_dwordx4 v49, s[44:47], s61 offen offset:1024 lds
  buffer_load_dwordx4 v50, s[44:47], s61 offen offset:2048 lds
  buffer_load_dwordx4 v51, s[44:47], s61 offen offset:3072 lds
  s_add_u32 s61, s61, 221184
  s_cmp_eq_u32 s61, 2211840
  s_cselect_b32 s61, 0, s61
  s_waitcnt vmcnt(4) lgkmcnt(0)
  s_barrier
  s_add_u32 m0, s63, 36864
  s_nop 0
  buffer_load_dwordx4 v48, s[44:47], s61 offen offset:0 lds
  buffer_load_dwordx4 v49, s[44:47], s61 offen offset:1024 lds
  buffer_load_dwordx4 v50, s[44:47], s61 offen offset:2048 lds
  buffer_load_dwordx4 v51, s[44:47], s61 offen offset:3072 lds
  s_add_u32 s61, s61, 221184
  s_waitcnt vmcnt(4) lgkmcnt(0)
  s_barrier
  s_add_u32 m0, s63, 0
  s_nop 0
  buffer_load_dwordx4 v48, s[44:47], s61 offen offset:0 lds
  buffer_load_dwordx4 v49, s[44:47], s61 offen offset:1024 lds
  buffer_load_dwordx4 v50, s[44:47], s61 offen offset:2048 lds
  buffer_load_dwordx4 v51, s[44:47], s61 offen offset:3072 lds
  s_add_u32 s61, s61, 221184
  s_cmp_eq_u32 s61, 2211840
  s_cselect_b32 s61, 0, s61
L_kg_a_done:
  v_lshlrev_b32 v76, 4, v123
  v_lshlrev_b32 v77, 3, v123
  v_lshrrev_b32 v78, 5, v123
  v_and_b32 v79, 31, v123
  s_lshl_b32 s56, s34, 3
  s_add_u32 s56, s56, s35
  s_lshl_b32 s56, s56, 10
  s_add_u32 s56, s56, 22142976
  s_mul_i32 s63, s36, 57344
  s_add_u32 s63, s63, 2621440
  s_mov_b32 s62, 0
  s_mov_b32 s67, s63
  s_lshr_b32 s73, s34, 2
  s_lshl_b32 s73, s73, 15
  s_add_u32 s73, s73, 22142976
  s_waitcnt vmcnt(4) lgkmcnt(0)
  s_barrier
  ds_read_b32 v122, v120 offset:40
  v_mov_b32 v68, 0
  v_mov_b32 v96, 0
  v_mov_b32 v69, 0
  v_mov_b32 v97, 0
  v_mov_b32 v70, 0
  v_mov_b32 v98, 0
  v_mov_b32 v71, 0
  v_mov_b32 v99, 0
  v_mov_b32 v72, 0
  v_mov_b32 v100, 0
  v_mov_b32 v73, 0
  v_mov_b32 v101, 0
  v_mov_b32 v74, 0
  v_mov_b32 v102, 0
  v_mov_b32 v75, 0
  v_mov_b32 v103, 0
  v_mfma_f32_32x32x16_bf16 a[0:15], v[96:99], v[96:99], 0
  v_mfma_f32_32x32x16_bf16 a[16:31], v[96:99], v[96:99], 0
  v_mfma_f32_32x32x16_bf16 a[32:47], v[96:99], v[96:99], 0
  v_mfma_f32_32x32x16_bf16 a[48:63], v[96:99], v[96:99], 0
  v_mfma_f32_32x32x16_bf16 a[64:79], v[96:99], v[96:99], 0
  v_mfma_f32_32x32x16_bf16 a[80:95], v[96:99], v[96:99], 0
  v_mfma_f32_32x32x16_bf16 a[96:111], v[96:99], v[96:99], 0
  v_mfma_f32_32x32x16_bf16 a[112:127], v[96:99], v[96:99], 0
  s_mov_b32 s61, 0
  s_waitcnt lgkmcnt(0)
  v_readfirstlane_b32 s72, v122
  s_nop 0
  s_cmp_eq_u32 s72, 0
  s_cbranch_scc1 L_kg_at_nokv
  s_mov_b32 s60, s67
  buffer_load_dwordx4 v[48:51], v76, s[40:43], s60 offen sc1
  buffer_load_dwordx2 v[52:53], v77, s[40:43], s60 offen offset:3072 sc1
  buffer_load_dwordx4 v[54:57], v76, s[40:43], s60 offen offset:1024 sc1
  buffer_load_dwordx4 v[58:61], v76, s[40:43], s60 offen offset:2048 sc1
  s_add_u32 s60, s60, 3584
  buffer_load_dwordx4 v[62:65], v76, s[40:43], s60 offen sc1
  buffer_load_dwordx2 v[66:67], v77, s[40:43], s60 offen offset:3072 sc1
  s_waitcnt vmcnt(6)
  s_branch L_kg_at_b9
L_kg_at_nokv:
  s_waitcnt vmcnt(0)
L_kg_at_b9:
  s_barrier
  s_add_u32 s57, s36, 0
  s_and_b32 s57, s57, 3
  s_mul_i32 s57, s57, 2560
  s_add_u32 s57, s57, 137216
  v_add_u32 v80, s57, v77
  s_add_u32 s57, s36, 1
  s_and_b32 s57, s57, 3
  s_mul_i32 s57, s57, 2560
  s_add_u32 s57, s57, 137216
  v_add_u32 v81, s57, v77
  s_add_u32 s57, s36, 2
  s_and_b32 s57, s57, 3
  s_mul_i32 s57, s57, 2560
  s_add_u32 s57, s57, 137216
  v_add_u32 v82, s57, v77
  s_add_u32 s57, s36, 3
  s_and_b32 s57, s57, 3
  s_mul_i32 s57, s57, 2560
  s_add_u32 s57, s57, 137216
  v_add_u32 v83, s57, v77
  s_add_u32 s57, s36, 1
  s_and_b32 s57, s57, 3
  s_mul_i32 s57, s57, 18432
  s_add_u32 s57, s57, 73728
  v_add_u32 v124, s57, v76
  s_add_u32 s57, s36, 2
  s_and_b32 s57, s57, 3
  s_mul_i32 s57, s57, 18432
  s_add_u32 s57, s57, 79872
  v_add_u32 v125, s57, v76
  s_add_u32 s57, s36, 3
  s_and_b32 s57, s57, 3
  s_mul_i32 s57, s57, 18432
  s_add_u32 s57, s57, 86016
  v_add_u32 v126, s57, v76
  s_mul_i32 s57, s36, 18432
  s_add_u32 s57, s57, 73728
  v_add_u32 v117, s57, v76
  v_mov_b32 v4, 0
  v_mov_b32 v5, 0
  v_mov_b32 v10, 0
  v_mov_b32 v11, 0
  v_mov_b32 v16, 0
  v_mov_b32 v17, 0
  v_mov_b32 v22, 0
  v_mov_b32 v23, 0
  v_mov_b32 v28, 0
  v_mov_b32 v29, 0
  v_mov_b32 v34, 0
  v_mov_b32 v35, 0
  v_mov_b32 v40, 0
  v_mov_b32 v41, 0
  v_mov_b32 v46, 0
  v_mov_b32 v47, 0
  ds_read_b64 v[0:1], v80 offset:0
  ds_read_b64 v[2:3], v80 offset:512
  ds_read_b64 v[6:7], v80 offset:1280
  ds_read_b64 v[8:9], v80 offset:1792
  ds_read_b64 v[12:13], v81 offset:0
  ds_read_b64 v[14:15], v81 offset:512
  ds_read_b64 v[18:19], v81 offset:1280
  ds_read_b64 v[20:21], v81 offset:1792
  ds_read_b64 v[24:25], v82 offset:0
  ds_read_b64 v[26:27], v82 offset:512
  ds_read_b64 v[30:31], v82 offset:1280
  ds_read_b64 v[32:33], v82 offset:1792
  ds_read_b64 v[36:37], v83 offset:0
  ds_read_b64 v[38:39], v83 offset:512
  ds_read_b64 v[42:43], v83 offset:1280
  ds_read_b64 v[44:45], v83 offset:1792
  s_mov_b32 exec_hi, 0
  ds_read_b64 v[4:5], v80 offset:1024
  ds_read_b64 v[10:11], v80 offset:2304
  ds_read_b64 v[16:17], v81 offset:1024
  ds_read_b64 v[22:23], v81 offset:2304
  ds_read_b64 v[28:29], v82 offset:1024
  ds_read_b64 v[34:35], v82 offset:2304
  ds_read_b64 v[40:41], v83 offset:1024
  ds_read_b64 v[46:47], v83 offset:2304
  s_mov_b32 exec_hi, -1
  s_barrier
  s_cmp_lg_u32 s72, 0
  s_cbranch_scc1 L_kg_at_go
  s_cmp_eq_u32 s36, 2
  s_cbranch_scc0 L_kg_at_fol
  v_lshrrev_b32 v118, 2, v76
  s_mov_b32 s80, 0x200000
  L_kg_g_2:
  buffer_load_dword v122, v118, s[40:43], s73 offen sc1
  s_waitcnt vmcnt(0)
  v_cmp_gt_u32 vcc, 1, v122
  s_nop 4
  s_cbranch_vccz L_kg_g_2_d
  s_sleep 1
  s_sub_u32 s80, s80, 1
  s_cbranch_scc0 L_kg_g_2
  L_kg_g_2_d:
  s_mov_b64 exec, 1
  v_mov_b32 v121, 1
  ds_add_u32 v120, v121 offset:40
  s_mov_b64 exec, -1
L_kg_at_fol:
  s_mov_b32 s80, 0x8000000
L_kg_w_3:
  ds_read_b32 v122, v120 offset:40
  s_waitcnt lgkmcnt(0)
  v_readfirstlane_b32 s57, v122
  s_nop 0
  s_cmp_ge_u32 s57, 1
  s_cbranch_scc1 L_kg_w_3_d
  s_sleep 1
  s_sub_u32 s80, s80, 1
  s_cbranch_scc0 L_kg_w_3
L_kg_w_3_d:
  s_mov_b32 s60, s67
  buffer_load_dwordx4 v[48:51], v76, s[40:43], s60 offen sc1
  buffer_load_dwordx2 v[52:53], v77, s[40:43], s60 offen offset:3072 sc1
  buffer_load_dwordx4 v[54:57], v76, s[40:43], s60 offen offset:1024 sc1
  buffer_load_dwordx4 v[58:61], v76, s[40:43], s60 offen offset:2048 sc1
  s_add_u32 s60, s60, 3584
  buffer_load_dwordx4 v[62:65], v76, s[40:43], s60 offen sc1
  buffer_load_dwordx2 v[66:67], v77, s[40:43], s60 offen offset:3072 sc1
L_kg_at_go:
  s_waitcnt vmcnt(0) lgkmcnt(0)
  v_mfma_f32_32x32x16_bf16 v[80:95], v[48:51], v[0:3], 0
  v_mfma_f32_32x32x8_bf16 v[80:95], v[52:53], v[4:5], v[80:95]
  s_nop 11
  .p2align 3
L_kg_at_loop:
  v_mfma_f32_32x32x16_bf16 a[112:127], v[68:71], v[96:99], a[112:127]
  v_exp_f32 v80, v80
  v_exp_f32 v81, v81
  v_exp_f32 v82, v82
  v_mfma_f32_32x32x16_bf16 a[112:127], v[72:75], v[100:103], a[112:127]
  v_exp_f32 v83, v83
  v_exp_f32 v84, v84
  v_exp_f32 v85, v85
  v_mfma_f32_32x32x16_bf16 v[96:111], v[48:51], v[6:9], 0
  v_exp_f32 v86, v86
  v_exp_f32 v87, v87
  v_exp_f32 v88, v88
  v_mfma_f32_32x32x8_bf16 v[96:111], v[52:53], v[10:11], v[96:111]
  v_exp_f32 v89, v89
  v_exp_f32 v90, v90
  v_exp_f32 v91, v91
  v_exp_f32 v92, v92
  v_exp_f32 v93, v93
  v_exp_f32 v94, v94
  v_exp_f32 v95, v95
  buffer_load_dwordx4 v[68:71], v76, s[40:43], s60 offen offset:1024 sc1
  v_cvt_pk_bf16_f32 v80, v80, v81
  v_cvt_pk_bf16_f32 v81, v82, v83
  v_cvt_pk_bf16_f32 v82, v84, v85
  v_cvt_pk_bf16_f32 v83, v86, v87
  v_cvt_pk_bf16_f32 v84, v88, v89
  v_cvt_pk_bf16_f32 v85, v90, v91
  v_cvt_pk_bf16_f32 v86, v92, v93
  v_cvt_pk_bf16_f32 v87, v94, v95
  s_waitcnt vmcnt(3)
  v_mfma_f32_32x32x16_bf16 a[0:15], v[54:57], v[80:83], a[0:15]
  v_exp_f32 v96, v96
  v_exp_f32 v97, v97
  v_exp_f32 v98, v98
  v_mfma_f32_32x32x16_bf16 a[0:15], v[58:61], v[84:87], a[0:15]
  v_exp_f32 v99, v99
  v_exp_f32 v100, v100
  v_exp_f32 v101, v101
  v_mfma_f32_32x32x16_bf16 v[80:95], v[48:51], v[12:15], 0
  v_exp_f32 v102, v102
  v_exp_f32 v103, v103
  v_exp_f32 v104, v104
  v_mfma_f32_32x32x8_bf16 v[80:95], v[52:53], v[16:17], v[80:95]
  v_exp_f32 v105, v105
  v_exp_f32 v106, v106
  v_exp_f32 v107, v107
  v_exp_f32 v108, v108
  v_exp_f32 v109, v109
  v_exp_f32 v110, v110
  v_exp_f32 v111, v111
  buffer_load_dwordx4 v[72:75], v76, s[40:43], s60 offen offset:2048 sc1
  s_add_u32 s60, s60, 3584
  v_cvt_pk_bf16_f32 v96, v96, v97
  v_cvt_pk_bf16_f32 v97, v98, v99
  v_cvt_pk_bf16_f32 v98, v100, v101
  v_cvt_pk_bf16_f32 v99, v102, v103
  v_cvt_pk_bf16_f32 v100, v104, v105
  v_cvt_pk_bf16_f32 v101, v106, v107
  v_cvt_pk_bf16_f32 v102, v108, v109
  v_cvt_pk_bf16_f32 v103, v110, v111
  v_mfma_f32_32x32x16_bf16 a[16:31], v[54:57], v[96:99], a[16:31]
  v_exp_f32 v80, v80
  v_exp_f32 v81, v81
  v_exp_f32 v82, v82
  v_mfma_f32_32x32x16_bf16 a[16:31], v[58:61], v[100:103], a[16:31]
  v_exp_f32 v83, v83
  v_exp_f32 v84, v84
  v_exp_f32 v85, v85
  v_mfma_f32_32x32x16_bf16 v[96:111], v[48:51], v[18:21], 0
  v_exp_f32 v86, v86
  v_exp_f32 v87, v87
  v_exp_f32 v88, v88
  v_mfma_f32_32x32x8_bf16 v[96:111], v[52:53], v[22:23], v[96:111]
  v_exp_f32 v89, v89
  v_exp_f32 v90, v90
  v_exp_f32 v91, v91
  v_exp_f32 v92, v92
  v_exp_f32 v93, v93
  v_exp_f32 v94, v94
  v_exp_f32 v95, v95
  v_cvt_pk_bf16_f32 v80, v80, v81
  v_cvt_pk_bf16_f32 v81, v82, v83
  v_cvt_pk_bf16_f32 v82, v84, v85
  v_cvt_pk_bf16_f32 v83, v86, v87
  v_cvt_pk_bf16_f32 v84, v88, v89
  v_cvt_pk_bf16_f32 v85, v90, v91
  v_cvt_pk_bf16_f32 v86, v92, v93
  v_cvt_pk_bf16_f32 v87, v94, v95
  v_mfma_f32_32x32x16_bf16 a[32:47], v[54:57], v[80:83], a[32:47]
  v_exp_f32 v96, v96
  v_exp_f32 v97, v97
  v_exp_f32 v98, v98
  v_mfma_f32_32x32x16_bf16 a[32:47], v[58:61], v[84:87], a[32:47]
  v_exp_f32 v99, v99
  v_exp_f32 v100, v100
  v_exp_f32 v101, v101
  v_mfma_f32_32x32x16_bf16 v[80:95], v[48:51], v[24:27], 0
  v_exp_f32 v102, v102
  v_exp_f32 v103, v103
  v_exp_f32 v104, v104
  v_mfma_f32_32x32x8_bf16 v[80:95], v[52:53], v[28:29], v[80:95]
  v_exp_f32 v105, v105
  v_exp_f32 v106, v106
  v_exp_f32 v107, v107
  v_exp_f32 v108, v108
  v_exp_f32 v109, v109
  v_exp_f32 v110, v110
  v_exp_f32 v111, v111
  v_cvt_pk_bf16_f32 v96, v96, v97
  v_cvt_pk_bf16_f32 v97, v98, v99
  v_cvt_pk_bf16_f32 v98, v100, v101
  v_cvt_pk_bf16_f32 v99, v102, v103
  v_cvt_pk_bf16_f32 v100, v104, v105
  v_cvt_pk_bf16_f32 v101, v106, v107
  v_cvt_pk_bf16_f32 v102, v108, v109
  v_cvt_pk_bf16_f32 v103, v110, v111
  v_mfma_f32_32x32x16_bf16 a[48:63], v[54:57], v[96:99], a[48:63]
  v_exp_f32 v80, v80
  v_exp_f32 v81, v81
  v_exp_f32 v82, v82
  v_mfma_f32_32x32x16_bf16 a[48:63], v[58:61], v[100:103], a[48:63]
  v_exp_f32 v83, v83
  v_exp_f32 v84, v84
  v_exp_f32 v85, v85
  v_mfma_f32_32x32x16_bf16 v[96:111], v[48:51], v[30:33], 0
  v_exp_f32 v86, v86
  v_exp_f32 v87, v87
  v_exp_f32 v88, v88
  v_mfma_f32_32x32x8_bf16 v[96:111], v[52:53], v[34:35], v[96:111]
  v_exp_f32 v89, v89
  v_exp_f32 v90, v90
  v_exp_f32 v91, v91
  v_exp_f32 v92, v92
  v_exp_f32 v93, v93
  v_exp_f32 v94, v94
  v_exp_f32 v95, v95
  v_cvt_pk_bf16_f32 v80, v80, v81
  v_cvt_pk_bf16_f32 v81, v82, v83
  v_cvt_pk_bf16_f32 v82, v84, v85
  v_cvt_pk_bf16_f32 v83, v86, v87
  v_cvt_pk_bf16_f32 v84, v88, v89
  v_cvt_pk_bf16_f32 v85, v90, v91
  v_cvt_pk_bf16_f32 v86, v92, v93
  v_cvt_pk_bf16_f32 v87, v94, v95
  v_mfma_f32_32x32x16_bf16 a[64:79], v[54:57], v[80:83], a[64:79]
  v_exp_f32 v96, v96
  v_exp_f32 v97, v97
  v_exp_f32 v98, v98
  v_mfma_f32_32x32x16_bf16 a[64:79], v[58:61], v[84:87], a[64:79]
  v_exp_f32 v99, v99
  v_exp_f32 v100, v100
  v_exp_f32 v101, v101
  v_mfma_f32_32x32x16_bf16 v[80:95], v[48:51], v[36:39], 0
  v_exp_f32 v102, v102
  v_exp_f32 v103, v103
  v_exp_f32 v104, v104
  v_mfma_f32_32x32x8_bf16 v[80:95], v[52:53], v[40:41], v[80:95]
  v_exp_f32 v105, v105
  v_exp_f32 v106, v106
  v_exp_f32 v107, v107
  v_exp_f32 v108, v108
  v_exp_f32 v109, v109
  v_exp_f32 v110, v110
  v_exp_f32 v111, v111
  v_cvt_pk_bf16_f32 v96, v96, v97
  v_cvt_pk_bf16_f32 v97, v98, v99
  v_cvt_pk_bf16_f32 v98, v100, v101
  v_cvt_pk_bf16_f32 v99, v102, v103
  v_cvt_pk_bf16_f32 v100, v104, v105
  v_cvt_pk_bf16_f32 v101, v106, v107
  v_cvt_pk_bf16_f32 v102, v108, v109
  v_cvt_pk_bf16_f32 v103, v110, v111
  v_mfma_f32_32x32x16_bf16 a[80:95], v[54:57], v[96:99], a[80:95]
  v_exp_f32 v80, v80
  v_exp_f32 v81, v81
  v_exp_f32 v82, v82
  v_mfma_f32_32x32x16_bf16 a[80:95], v[58:61], v[100:103], a[80:95]
  v_exp_f32 v83, v83
  v_exp_f32 v84, v84
  v_exp_f32 v85, v85
  v_mfma_f32_32x32x16_bf16 v[96:111], v[48:51], v[42:45], 0
  v_exp_f32 v86, v86
  v_exp_f32 v87, v87
  v_exp_f32 v88, v88
  v_mfma_f32_32x32x8_bf16 v[96:111], v[52:53], v[46:47], v[96:111]
  v_exp_f32 v89, v89
  v_exp_f32 v90, v90
  v_exp_f32 v91, v91
  v_exp_f32 v92, v92
  v_exp_f32 v93, v93
  v_exp_f32 v94, v94
  v_exp_f32 v95, v95
  v_cvt_pk_bf16_f32 v80, v80, v81
  v_cvt_pk_bf16_f32 v81, v82, v83
  v_cvt_pk_bf16_f32 v82, v84, v85
  v_cvt_pk_bf16_f32 v83, v86, v87
  v_cvt_pk_bf16_f32 v84, v88, v89
  v_cvt_pk_bf16_f32 v85, v90, v91
  v_cvt_pk_bf16_f32 v86, v92, v93
  v_cvt_pk_bf16_f32 v87, v94, v95
  v_mfma_f32_32x32x16_bf16 a[96:111], v[54:57], v[80:83], a[96:111]
  v_exp_f32 v96, v96
  v_exp_f32 v97, v97
  v_exp_f32 v98, v98
  v_mfma_f32_32x32x16_bf16 a[96:111], v[58:61], v[84:87], a[96:111]
  v_exp_f32 v99, v99
  v_exp_f32 v100, v100
  v_exp_f32 v101, v101
  s_waitcnt vmcnt(2)
  v_mfma_f32_32x32x16_bf16 v[80:95], v[62:65], v[0:3], 0
  v_exp_f32 v102, v102
  v_exp_f32 v103, v103
  v_exp_f32 v104, v104
  v_mfma_f32_32x32x8_bf16 v[80:95], v[66:67], v[4:5], v[80:95]
  v_exp_f32 v105, v105
  v_exp_f32 v106, v106
  v_exp_f32 v107, v107
  v_exp_f32 v108, v108
  v_exp_f32 v109, v109
  v_exp_f32 v110, v110
  v_exp_f32 v111, v111
  buffer_load_dwordx4 v[48:51], v76, s[40:43], s60 offen sc1
  buffer_load_dwordx2 v[52:53], v77, s[40:43], s60 offen offset:3072 sc1
  v_cvt_pk_bf16_f32 v96, v96, v97
  v_cvt_pk_bf16_f32 v97, v98, v99
  v_cvt_pk_bf16_f32 v98, v100, v101
  v_cvt_pk_bf16_f32 v99, v102, v103
  v_cvt_pk_bf16_f32 v100, v104, v105
  v_cvt_pk_bf16_f32 v101, v106, v107
  v_cvt_pk_bf16_f32 v102, v108, v109
  v_cvt_pk_bf16_f32 v103, v110, v111
  v_mfma_f32_32x32x16_bf16 a[112:127], v[54:57], v[96:99], a[112:127]
  v_exp_f32 v80, v80
  v_exp_f32 v81, v81
  v_exp_f32 v82, v82
  v_mfma_f32_32x32x16_bf16 a[112:127], v[58:61], v[100:103], a[112:127]
  v_exp_f32 v83, v83
  v_exp_f32 v84, v84
  v_exp_f32 v85, v85
  v_mfma_f32_32x32x16_bf16 v[96:111], v[62:65], v[6:9], 0
  v_exp_f32 v86, v86
  v_exp_f32 v87, v87
  v_exp_f32 v88, v88
  v_mfma_f32_32x32x8_bf16 v[96:111], v[66:67], v[10:11], v[96:111]
  v_exp_f32 v89, v89
  v_exp_f32 v90, v90
  v_exp_f32 v91, v91
  v_exp_f32 v92, v92
  v_exp_f32 v93, v93
  v_exp_f32 v94, v94
  v_exp_f32 v95, v95
  buffer_load_dwordx4 v[54:57], v76, s[40:43], s60 offen offset:1024 sc1
  v_cvt_pk_bf16_f32 v80, v80, v81
  v_cvt_pk_bf16_f32 v81, v82, v83
  v_cvt_pk_bf16_f32 v82, v84, v85
  v_cvt_pk_bf16_f32 v83, v86, v87
  v_cvt_pk_bf16_f32 v84, v88, v89
  v_cvt_pk_bf16_f32 v85, v90, v91
  v_cvt_pk_bf16_f32 v86, v92, v93
  v_cvt_pk_bf16_f32 v87, v94, v95
  s_waitcnt vmcnt(3)
  v_mfma_f32_32x32x16_bf16 a[0:15], v[68:71], v[80:83], a[0:15]
  v_exp_f32 v96, v96
  v_exp_f32 v97, v97
  v_exp_f32 v98, v98
  v_mfma_f32_32x32x16_bf16 a[0:15], v[72:75], v[84:87], a[0:15]
  v_exp_f32 v99, v99
  v_exp_f32 v100, v100
  v_exp_f32 v101, v101
  v_mfma_f32_32x32x16_bf16 v[80:95], v[62:65], v[12:15], 0
  v_exp_f32 v102, v102
  v_exp_f32 v103, v103
  v_exp_f32 v104, v104
  v_mfma_f32_32x32x8_bf16 v[80:95], v[66:67], v[16:17], v[80:95]
  v_exp_f32 v105, v105
  v_exp_f32 v106, v106
  v_exp_f32 v107, v107
  v_exp_f32 v108, v108
  v_exp_f32 v109, v109
  v_exp_f32 v110, v110
  v_exp_f32 v111, v111
  buffer_load_dwordx4 v[58:61], v76, s[40:43], s60 offen offset:2048 sc1
  s_add_u32 s60, s60, 3584
  v_cvt_pk_bf16_f32 v96, v96, v97
  v_cvt_pk_bf16_f32 v97, v98, v99
  v_cvt_pk_bf16_f32 v98, v100, v101
  v_cvt_pk_bf16_f32 v99, v102, v103
  v_cvt_pk_bf16_f32 v100, v104, v105
  v_cvt_pk_bf16_f32 v101, v106, v107
  v_cvt_pk_bf16_f32 v102, v108, v109
  v_cvt_pk_bf16_f32 v103, v110, v111
  v_mfma_f32_32x32x16_bf16 a[16:31], v[68:71], v[96:99], a[16:31]
  v_exp_f32 v80, v80
  v_exp_f32 v81, v81
  v_exp_f32 v82, v82
  v_mfma_f32_32x32x16_bf16 a[16:31], v[72:75], v[100:103], a[16:31]
  v_exp_f32 v83, v83
  v_exp_f32 v84, v84
  v_exp_f32 v85, v85
  v_mfma_f32_32x32x16_bf16 v[96:111], v[62:65], v[18:21], 0
  v_exp_f32 v86, v86
  v_exp_f32 v87, v87
  v_exp_f32 v88, v88
  v_mfma_f32_32x32x8_bf16 v[96:111], v[66:67], v[22:23], v[96:111]
  v_exp_f32 v89, v89
  v_exp_f32 v90, v90
  v_exp_f32 v91, v91
  v_exp_f32 v92, v92
  v_exp_f32 v93, v93
  v_exp_f32 v94, v94
  v_exp_f32 v95, v95
  v_cvt_pk_bf16_f32 v80, v80, v81
  v_cvt_pk_bf16_f32 v81, v82, v83
  v_cvt_pk_bf16_f32 v82, v84, v85
  v_cvt_pk_bf16_f32 v83, v86, v87
  v_cvt_pk_bf16_f32 v84, v88, v89
  v_cvt_pk_bf16_f32 v85, v90, v91
  v_cvt_pk_bf16_f32 v86, v92, v93
  v_cvt_pk_bf16_f32 v87, v94, v95
  v_mfma_f32_32x32x16_bf16 a[32:47], v[68:71], v[80:83], a[32:47]
  v_exp_f32 v96, v96
  v_exp_f32 v97, v97
  v_exp_f32 v98, v98
  v_mfma_f32_32x32x16_bf16 a[32:47], v[72:75], v[84:87], a[32:47]
  v_exp_f32 v99, v99
  v_exp_f32 v100, v100
  v_exp_f32 v101, v101
  v_mfma_f32_32x32x16_bf16 v[80:95], v[62:65], v[24:27], 0
  v_exp_f32 v102, v102
  v_exp_f32 v103, v103
  v_exp_f32 v104, v104
  v_mfma_f32_32x32x8_bf16 v[80:95], v[66:67], v[28:29], v[80:95]
  v_exp_f32 v105, v105
  v_exp_f32 v106, v106
  v_exp_f32 v107, v107
  v_exp_f32 v108, v108
  v_exp_f32 v109, v109
  v_exp_f32 v110, v110
  v_exp_f32 v111, v111
  v_cvt_pk_bf16_f32 v96, v96, v97
  v_cvt_pk_bf16_f32 v97, v98, v99
  v_cvt_pk_bf16_f32 v98, v100, v101
  v_cvt_pk_bf16_f32 v99, v102, v103
  v_cvt_pk_bf16_f32 v100, v104, v105
  v_cvt_pk_bf16_f32 v101, v106, v107
  v_cvt_pk_bf16_f32 v102, v108, v109
  v_cvt_pk_bf16_f32 v103, v110, v111
  v_mfma_f32_32x32x16_bf16 a[48:63], v[68:71], v[96:99], a[48:63]
  v_exp_f32 v80, v80
  v_exp_f32 v81, v81
  v_exp_f32 v82, v82
  v_mfma_f32_32x32x16_bf16 a[48:63], v[72:75], v[100:103], a[48:63]
  v_exp_f32 v83, v83
  v_exp_f32 v84, v84
  v_exp_f32 v85, v85
  v_mfma_f32_32x32x16_bf16 v[96:111], v[62:65], v[30:33], 0
  v_exp_f32 v86, v86
  v_exp_f32 v87, v87
  v_exp_f32 v88, v88
  v_mfma_f32_32x32x8_bf16 v[96:111], v[66:67], v[34:35], v[96:111]
  v_exp_f32 v89, v89
  v_exp_f32 v90, v90
  v_exp_f32 v91, v91
  v_exp_f32 v92, v92
  v_exp_f32 v93, v93
  v_exp_f32 v94, v94
  v_exp_f32 v95, v95
  v_cvt_pk_bf16_f32 v80, v80, v81
  v_cvt_pk_bf16_f32 v81, v82, v83
  v_cvt_pk_bf16_f32 v82, v84, v85
  v_cvt_pk_bf16_f32 v83, v86, v87
  v_cvt_pk_bf16_f32 v84, v88, v89
  v_cvt_pk_bf16_f32 v85, v90, v91
  v_cvt_pk_bf16_f32 v86, v92, v93
  v_cvt_pk_bf16_f32 v87, v94, v95
  v_mfma_f32_32x32x16_bf16 a[64:79], v[68:71], v[80:83], a[64:79]
  v_exp_f32 v96, v96
  v_exp_f32 v97, v97
  v_exp_f32 v98, v98
  v_mfma_f32_32x32x16_bf16 a[64:79], v[72:75], v[84:87], a[64:79]
  v_exp_f32 v99, v99
  v_exp_f32 v100, v100
  v_exp_f32 v101, v101
  v_mfma_f32_32x32x16_bf16 v[80:95], v[62:65], v[36:39], 0
  v_exp_f32 v102, v102
  v_exp_f32 v103, v103
  v_exp_f32 v104, v104
  v_mfma_f32_32x32x8_bf16 v[80:95], v[66:67], v[40:41], v[80:95]
  v_exp_f32 v105, v105
  v_exp_f32 v106, v106
  v_exp_f32 v107, v107
  v_exp_f32 v108, v108
  v_exp_f32 v109, v109
  v_exp_f32 v110, v110
  v_exp_f32 v111, v111
  v_cvt_pk_bf16_f32 v96, v96, v97
  v_cvt_pk_bf16_f32 v97, v98, v99
  v_cvt_pk_bf16_f32 v98, v100, v101
  v_cvt_pk_bf16_f32 v99, v102, v103
  v_cvt_pk_bf16_f32 v100, v104, v105
  v_cvt_pk_bf16_f32 v101, v106, v107
  v_cvt_pk_bf16_f32 v102, v108, v109
  v_cvt_pk_bf16_f32 v103, v110, v111
  v_mfma_f32_32x32x16_bf16 a[80:95], v[68:71], v[96:99], a[80:95]
  v_exp_f32 v80, v80
  v_exp_f32 v81, v81
  v_exp_f32 v82, v82
  v_mfma_f32_32x32x16_bf16 a[80:95], v[72:75], v[100:103], a[80:95]
  v_exp_f32 v83, v83
  v_exp_f32 v84, v84
  v_exp_f32 v85, v85
  v_mfma_f32_32x32x16_bf16 v[96:111], v[62:65], v[42:45], 0
  v_exp_f32 v86, v86
  v_exp_f32 v87, v87
  v_exp_f32 v88, v88
  v_mfma_f32_32x32x8_bf16 v[96:111], v[66:67], v[46:47], v[96:111]
  v_exp_f32 v89, v89
  v_exp_f32 v90, v90
  v_exp_f32 v91, v91
  v_exp_f32 v92, v92
  v_exp_f32 v93, v93
  v_exp_f32 v94, v94
  v_exp_f32 v95, v95
  s_add_u32 s61, s61, 1
  s_cmp_lt_u32 s61, 7
  v_cvt_pk_bf16_f32 v80, v80, v81
  v_cvt_pk_bf16_f32 v81, v82, v83
  v_cvt_pk_bf16_f32 v82, v84, v85
  v_cvt_pk_bf16_f32 v83, v86, v87
  v_cvt_pk_bf16_f32 v84, v88, v89
  v_cvt_pk_bf16_f32 v85, v90, v91
  v_cvt_pk_bf16_f32 v86, v92, v93
  v_cvt_pk_bf16_f32 v87, v94, v95
  v_mfma_f32_32x32x16_bf16 a[96:111], v[68:71], v[80:83], a[96:111]
  v_exp_f32 v96, v96
  v_exp_f32 v97, v97
  v_exp_f32 v98, v98
  v_mfma_f32_32x32x16_bf16 a[96:111], v[72:75], v[84:87], a[96:111]
  v_exp_f32 v99, v99
  v_exp_f32 v100, v100
  v_exp_f32 v101, v101
  s_waitcnt vmcnt(2)
  v_mfma_f32_32x32x16_bf16 v[80:95], v[48:51], v[0:3], 0
  v_exp_f32 v102, v102
  v_exp_f32 v103, v103
  v_exp_f32 v104, v104
  v_mfma_f32_32x32x8_bf16 v[80:95], v[52:53], v[4:5], v[80:95]
  v_exp_f32 v105, v105
  v_exp_f32 v106, v106
  v_exp_f32 v107, v107
  v_exp_f32 v108, v108
  v_exp_f32 v109, v109
  v_exp_f32 v110, v110
  v_exp_f32 v111, v111
  buffer_load_dwordx4 v[62:65], v76, s[40:43], s60 offen sc1
  buffer_load_dwordx2 v[66:67], v77, s[40:43], s60 offen offset:3072 sc1
  v_cvt_pk_bf16_f32 v96, v96, v97
  v_cvt_pk_bf16_f32 v97, v98, v99
  v_cvt_pk_bf16_f32 v98, v100, v101
  v_cvt_pk_bf16_f32 v99, v102, v103
  v_cvt_pk_bf16_f32 v100, v104, v105
  v_cvt_pk_bf16_f32 v101, v106, v107
  v_cvt_pk_bf16_f32 v102, v108, v109
  v_cvt_pk_bf16_f32 v103, v110, v111
  s_cbranch_scc1 L_kg_at_loop
  v_mfma_f32_32x32x16_bf16 a[112:127], v[68:71], v[96:99], a[112:127]
  v_exp_f32 v80, v80
  v_exp_f32 v81, v81
  v_exp_f32 v82, v82
  v_mfma_f32_32x32x16_bf16 a[112:127], v[72:75], v[100:103], a[112:127]
  v_exp_f32 v83, v83
  v_exp_f32 v84, v84
  v_exp_f32 v85, v85
  v_mfma_f32_32x32x16_bf16 v[96:111], v[48:51], v[6:9], 0
  v_exp_f32 v86, v86
  v_exp_f32 v87, v87
  v_exp_f32 v88, v88
  v_mfma_f32_32x32x8_bf16 v[96:111], v[52:53], v[10:11], v[96:111]
  v_exp_f32 v89, v89
  v_exp_f32 v90, v90
  v_exp_f32 v91, v91
  v_exp_f32 v92, v92
  v_exp_f32 v93, v93
  v_exp_f32 v94, v94
  v_exp_f32 v95, v95
  buffer_load_dwordx4 v[68:71], v76, s[40:43], s60 offen offset:1024 sc1
  v_cvt_pk_bf16_f32 v80, v80, v81
  v_cvt_pk_bf16_f32 v81, v82, v83
  v_cvt_pk_bf16_f32 v82, v84, v85
  v_cvt_pk_bf16_f32 v83, v86, v87
  v_cvt_pk_bf16_f32 v84, v88, v89
  v_cvt_pk_bf16_f32 v85, v90, v91
  v_cvt_pk_bf16_f32 v86, v92, v93
  v_cvt_pk_bf16_f32 v87, v94, v95
  s_waitcnt vmcnt(3)
  v_mfma_f32_32x32x16_bf16 a[0:15], v[54:57], v[80:83], a[0:15]
  v_exp_f32 v96, v96
  v_exp_f32 v97, v97
  v_exp_f32 v98, v98
  v_mfma_f32_32x32x16_bf16 a[0:15], v[58:61], v[84:87], a[0:15]
  v_exp_f32 v99, v99
  v_exp_f32 v100, v100
  v_exp_f32 v101, v101
  v_mfma_f32_32x32x16_bf16 v[80:95], v[48:51], v[12:15], 0
  v_exp_f32 v102, v102
  v_exp_f32 v103, v103
  v_exp_f32 v104, v104
  v_mfma_f32_32x32x8_bf16 v[80:95], v[52:53], v[16:17], v[80:95]
  v_exp_f32 v105, v105
  v_exp_f32 v106, v106
  v_exp_f32 v107, v107
  v_exp_f32 v108, v108
  v_exp_f32 v109, v109
  v_exp_f32 v110, v110
  v_exp_f32 v111, v111
  buffer_load_dwordx4 v[72:75], v76, s[40:43], s60 offen offset:2048 sc1
  s_add_u32 s60, s60, 3584
  v_cvt_pk_bf16_f32 v96, v96, v97
  v_cvt_pk_bf16_f32 v97, v98, v99
  v_cvt_pk_bf16_f32 v98, v100, v101
  v_cvt_pk_bf16_f32 v99, v102, v103
  v_cvt_pk_bf16_f32 v100, v104, v105
  v_cvt_pk_bf16_f32 v101, v106, v107
  v_cvt_pk_bf16_f32 v102, v108, v109
  v_cvt_pk_bf16_f32 v103, v110, v111
  v_mfma_f32_32x32x16_bf16 a[16:31], v[54:57], v[96:99], a[16:31]
  v_exp_f32 v80, v80
  v_exp_f32 v81, v81
  v_exp_f32 v82, v82
  v_mfma_f32_32x32x16_bf16 a[16:31], v[58:61], v[100:103], a[16:31]
  v_exp_f32 v83, v83
  v_exp_f32 v84, v84
  v_exp_f32 v85, v85
  v_mfma_f32_32x32x16_bf16 v[96:111], v[48:51], v[18:21], 0
  v_exp_f32 v86, v86
  v_exp_f32 v87, v87
  v_exp_f32 v88, v88
  v_mfma_f32_32x32x8_bf16 v[96:111], v[52:53], v[22:23], v[96:111]
  v_exp_f32 v89, v89
  v_exp_f32 v90, v90
  v_exp_f32 v91, v91
  v_exp_f32 v92, v92
  v_exp_f32 v93, v93
  v_exp_f32 v94, v94
  v_exp_f32 v95, v95
  v_cvt_pk_bf16_f32 v80, v80, v81
  v_cvt_pk_bf16_f32 v81, v82, v83
  v_cvt_pk_bf16_f32 v82, v84, v85
  v_cvt_pk_bf16_f32 v83, v86, v87
  v_cvt_pk_bf16_f32 v84, v88, v89
  v_cvt_pk_bf16_f32 v85, v90, v91
  v_cvt_pk_bf16_f32 v86, v92, v93
  v_cvt_pk_bf16_f32 v87, v94, v95
  v_mfma_f32_32x32x16_bf16 a[32:47], v[54:57], v[80:83], a[32:47]
  v_exp_f32 v96, v96
  v_exp_f32 v97, v97
  v_exp_f32 v98, v98
  v_mfma_f32_32x32x16_bf16 a[32:47], v[58:61], v[84:87], a[32:47]
  v_exp_f32 v99, v99
  v_exp_f32 v100, v100
  v_exp_f32 v101, v101
  v_mfma_f32_32x32x16_bf16 v[80:95], v[48:51], v[24:27], 0
  v_exp_f32 v102, v102
  v_exp_f32 v103, v103
  v_exp_f32 v104, v104
  v_mfma_f32_32x32x8_bf16 v[80:95], v[52:53], v[28:29], v[80:95]
  v_exp_f32 v105, v105
  v_exp_f32 v106, v106
  v_exp_f32 v107, v107
  v_exp_f32 v108, v108
  v_exp_f32 v109, v109
  v_exp_f32 v110, v110
  v_exp_f32 v111, v111
  v_cvt_pk_bf16_f32 v96, v96, v97
  v_cvt_pk_bf16_f32 v97, v98, v99
  v_cvt_pk_bf16_f32 v98, v100, v101
  v_cvt_pk_bf16_f32 v99, v102, v103
  v_cvt_pk_bf16_f32 v100, v104, v105
  v_cvt_pk_bf16_f32 v101, v106, v107
  v_cvt_pk_bf16_f32 v102, v108, v109
  v_cvt_pk_bf16_f32 v103, v110, v111
  v_mfma_f32_32x32x16_bf16 a[48:63], v[54:57], v[96:99], a[48:63]
  v_exp_f32 v80, v80
  v_exp_f32 v81, v81
  v_exp_f32 v82, v82
  v_mfma_f32_32x32x16_bf16 a[48:63], v[58:61], v[100:103], a[48:63]
  v_exp_f32 v83, v83
  v_exp_f32 v84, v84
  v_exp_f32 v85, v85
  v_mfma_f32_32x32x16_bf16 v[96:111], v[48:51], v[30:33], 0
  v_exp_f32 v86, v86
  v_exp_f32 v87, v87
  v_exp_f32 v88, v88
  v_mfma_f32_32x32x8_bf16 v[96:111], v[52:53], v[34:35], v[96:111]
  v_exp_f32 v89, v89
  v_exp_f32 v90, v90
  v_exp_f32 v91, v91
  v_exp_f32 v92, v92
  v_exp_f32 v93, v93
  v_exp_f32 v94, v94
  v_exp_f32 v95, v95
  v_cvt_pk_bf16_f32 v80, v80, v81
  v_cvt_pk_bf16_f32 v81, v82, v83
  v_cvt_pk_bf16_f32 v82, v84, v85
  v_cvt_pk_bf16_f32 v83, v86, v87
  v_cvt_pk_bf16_f32 v84, v88, v89
  v_cvt_pk_bf16_f32 v85, v90, v91
  v_cvt_pk_bf16_f32 v86, v92, v93
  v_cvt_pk_bf16_f32 v87, v94, v95
  v_mfma_f32_32x32x16_bf16 a[64:79], v[54:57], v[80:83], a[64:79]
  v_exp_f32 v96, v96
  v_exp_f32 v97, v97
  v_exp_f32 v98, v98
  v_mfma_f32_32x32x16_bf16 a[64:79], v[58:61], v[84:87], a[64:79]
  v_exp_f32 v99, v99
  v_exp_f32 v100, v100
  v_exp_f32 v101, v101
  v_mfma_f32_32x32x16_bf16 v[80:95], v[48:51], v[36:39], 0
  v_exp_f32 v102, v102
  v_exp_f32 v103, v103
  v_exp_f32 v104, v104
  v_mfma_f32_32x32x8_bf16 v[80:95], v[52:53], v[40:41], v[80:95]
  v_exp_f32 v105, v105
  v_exp_f32 v106, v106
  v_exp_f32 v107, v107
  v_exp_f32 v108, v108
  v_exp_f32 v109, v109
  v_exp_f32 v110, v110
  v_exp_f32 v111, v111
  v_cvt_pk_bf16_f32 v96, v96, v97
  v_cvt_pk_bf16_f32 v97, v98, v99
  v_cvt_pk_bf16_f32 v98, v100, v101
  v_cvt_pk_bf16_f32 v99, v102, v103
  v_cvt_pk_bf16_f32 v100, v104, v105
  v_cvt_pk_bf16_f32 v101, v106, v107
  v_cvt_pk_bf16_f32 v102, v108, v109
  v_cvt_pk_bf16_f32 v103, v110, v111
  v_mfma_f32_32x32x16_bf16 a[80:95], v[54:57], v[96:99], a[80:95]
  v_exp_f32 v80, v80
  v_exp_f32 v81, v81
  v_exp_f32 v82, v82
  v_mfma_f32_32x32x16_bf16 a[80:95], v[58:61], v[100:103], a[80:95]
  v_exp_f32 v83, v83
  v_exp_f32 v84, v84
  v_exp_f32 v85, v85
  v_mfma_f32_32x32x16_bf16 v[96:111], v[48:51], v[42:45], 0
  v_exp_f32 v86, v86
  v_exp_f32 v87, v87
  v_exp_f32 v88, v88
  v_mfma_f32_32x32x8_bf16 v[96:111], v[52:53], v[46:47], v[96:111]
  v_exp_f32 v89, v89
  v_exp_f32 v90, v90
  v_exp_f32 v91, v91
  v_exp_f32 v92, v92
  v_exp_f32 v93, v93
  v_exp_f32 v94, v94
  v_exp_f32 v95, v95
  v_cvt_pk_bf16_f32 v80, v80, v81
  v_cvt_pk_bf16_f32 v81, v82, v83
  v_cvt_pk_bf16_f32 v82, v84, v85
  v_cvt_pk_bf16_f32 v83, v86, v87
  v_cvt_pk_bf16_f32 v84, v88, v89
  v_cvt_pk_bf16_f32 v85, v90, v91
  v_cvt_pk_bf16_f32 v86, v92, v93
  v_cvt_pk_bf16_f32 v87, v94, v95
  v_mfma_f32_32x32x16_bf16 a[96:111], v[54:57], v[80:83], a[96:111]
  v_exp_f32 v96, v96
  v_exp_f32 v97, v97
  v_exp_f32 v98, v98
  v_mfma_f32_32x32x16_bf16 a[96:111], v[58:61], v[84:87], a[96:111]
  v_exp_f32 v99, v99
  v_exp_f32 v100, v100
  v_exp_f32 v101, v101
  s_waitcnt vmcnt(2)
  v_mfma_f32_32x32x16_bf16 v[80:95], v[62:65], v[0:3], 0
  v_exp_f32 v102, v102
  v_exp_f32 v103, v103
  v_exp_f32 v104, v104
  v_mfma_f32_32x32x8_bf16 v[80:95], v[66:67], v[4:5], v[80:95]
  v_exp_f32 v105, v105
  v_exp_f32 v106, v106
  v_exp_f32 v107, v107
  v_exp_f32 v108, v108
  v_exp_f32 v109, v109
  v_exp_f32 v110, v110
  v_exp_f32 v111, v111
  v_cvt_pk_bf16_f32 v96, v96, v97
  v_cvt_pk_bf16_f32 v97, v98, v99
  v_cvt_pk_bf16_f32 v98, v100, v101
  v_cvt_pk_bf16_f32 v99, v102, v103
  v_cvt_pk_bf16_f32 v100, v104, v105
  v_cvt_pk_bf16_f32 v101, v106, v107
  v_cvt_pk_bf16_f32 v102, v108, v109
  v_cvt_pk_bf16_f32 v103, v110, v111
  v_mfma_f32_32x32x16_bf16 a[112:127], v[54:57], v[96:99], a[112:127]
  v_exp_f32 v80, v80
  v_exp_f32 v81, v81
  v_exp_f32 v82, v82
  v_mfma_f32_32x32x16_bf16 a[112:127], v[58:61], v[100:103], a[112:127]
  v_exp_f32 v83, v83
  v_exp_f32 v84, v84
  v_exp_f32 v85, v85
  v_mfma_f32_32x32x16_bf16 v[96:111], v[62:65], v[6:9], 0
  v_exp_f32 v86, v86
  v_exp_f32 v87, v87
  v_exp_f32 v88, v88
  v_mfma_f32_32x32x8_bf16 v[96:111], v[66:67], v[10:11], v[96:111]
  v_exp_f32 v89, v89
  v_exp_f32 v90, v90
  v_exp_f32 v91, v91
  v_exp_f32 v92, v92
  v_exp_f32 v93, v93
  v_exp_f32 v94, v94
  v_exp_f32 v95, v95
  v_cvt_pk_bf16_f32 v80, v80, v81
  v_cvt_pk_bf16_f32 v81, v82, v83
  v_cvt_pk_bf16_f32 v82, v84, v85
  v_cvt_pk_bf16_f32 v83, v86, v87
  v_cvt_pk_bf16_f32 v84, v88, v89
  v_cvt_pk_bf16_f32 v85, v90, v91
  v_cvt_pk_bf16_f32 v86, v92, v93
  v_cvt_pk_bf16_f32 v87, v94, v95
  s_waitcnt vmcnt(0)
  v_mfma_f32_32x32x16_bf16 a[0:15], v[68:71], v[80:83], a[0:15]
  v_exp_f32 v96, v96
  v_exp_f32 v97, v97
  v_exp_f32 v98, v98
  v_mfma_f32_32x32x16_bf16 a[0:15], v[72:75], v[84:87], a[0:15]
  v_exp_f32 v99, v99
  v_exp_f32 v100, v100
  v_exp_f32 v101, v101
  v_mfma_f32_32x32x16_bf16 v[80:95], v[62:65], v[12:15], 0
  v_exp_f32 v102, v102
  v_exp_f32 v103, v103
  v_exp_f32 v104, v104
  v_mfma_f32_32x32x8_bf16 v[80:95], v[66:67], v[16:17], v[80:95]
  v_exp_f32 v105, v105
  v_exp_f32 v106, v106
  v_exp_f32 v107, v107
  v_exp_f32 v108, v108
  v_exp_f32 v109, v109
  v_exp_f32 v110, v110
  v_exp_f32 v111, v111
  v_cvt_pk_bf16_f32 v96, v96, v97
  v_cvt_pk_bf16_f32 v97, v98, v99
  v_cvt_pk_bf16_f32 v98, v100, v101
  v_cvt_pk_bf16_f32 v99, v102, v103
  v_cvt_pk_bf16_f32 v100, v104, v105
  v_cvt_pk_bf16_f32 v101, v106, v107
  v_cvt_pk_bf16_f32 v102, v108, v109
  v_cvt_pk_bf16_f32 v103, v110, v111
  v_mfma_f32_32x32x16_bf16 a[16:31], v[68:71], v[96:99], a[16:31]
  v_exp_f32 v80, v80
  v_exp_f32 v81, v81
  v_exp_f32 v82, v82
  v_mfma_f32_32x32x16_bf16 a[16:31], v[72:75], v[100:103], a[16:31]
  v_exp_f32 v83, v83
  v_exp_f32 v84, v84
  v_exp_f32 v85, v85
  v_mfma_f32_32x32x16_bf16 v[96:111], v[62:65], v[18:21], 0
  v_exp_f32 v86, v86
  v_exp_f32 v87, v87
  v_exp_f32 v88, v88
  v_mfma_f32_32x32x8_bf16 v[96:111], v[66:67], v[22:23], v[96:111]
  v_exp_f32 v89, v89
  v_exp_f32 v90, v90
  v_exp_f32 v91, v91
  v_exp_f32 v92, v92
  v_exp_f32 v93, v93
  v_exp_f32 v94, v94
  v_exp_f32 v95, v95
  v_cvt_pk_bf16_f32 v80, v80, v81
  v_cvt_pk_bf16_f32 v81, v82, v83
  v_cvt_pk_bf16_f32 v82, v84, v85
  v_cvt_pk_bf16_f32 v83, v86, v87
  v_cvt_pk_bf16_f32 v84, v88, v89
  v_cvt_pk_bf16_f32 v85, v90, v91
  v_cvt_pk_bf16_f32 v86, v92, v93
  v_cvt_pk_bf16_f32 v87, v94, v95
  s_mov_b32 s52, s30
  s_and_b32 s53, s31, 0xffff
  s_mov_b32 s54, 256
  s_mov_b32 s55, 0x20000
  v_and_b32 v121, 3, v123
  v_bfe_u32 v122, v123, 2, 1
  v_lshl_add_u32 v121, v122, 5, v121
  v_lshlrev_b32 v113, 2, v121
  buffer_load_dword v112, v113, s[52:55], 0 offen offset:32 sc1
  v_mfma_f32_32x32x16_bf16 a[32:47], v[68:71], v[80:83], a[32:47]
  v_exp_f32 v96, v96
  v_exp_f32 v97, v97
  v_exp_f32 v98, v98
  v_mfma_f32_32x32x16_bf16 a[32:47], v[72:75], v[84:87], a[32:47]
  v_exp_f32 v99, v99
  v_exp_f32 v100, v100
  v_exp_f32 v101, v101
  v_mfma_f32_32x32x16_bf16 v[80:95], v[62:65], v[24:27], 0
  v_exp_f32 v102, v102
  v_exp_f32 v103, v103
  v_exp_f32 v104, v104
  v_mfma_f32_32x32x8_bf16 v[80:95], v[66:67], v[28:29], v[80:95]
  v_exp_f32 v105, v105
  v_exp_f32 v106, v106
  v_exp_f32 v107, v107
  v_exp_f32 v108, v108
  v_exp_f32 v109, v109
  v_exp_f32 v110, v110
  v_exp_f32 v111, v111
  v_cvt_pk_bf16_f32 v96, v96, v97
  v_cvt_pk_bf16_f32 v97, v98, v99
  v_cvt_pk_bf16_f32 v98, v100, v101
  v_cvt_pk_bf16_f32 v99, v102, v103
  v_cvt_pk_bf16_f32 v100, v104, v105
  v_cvt_pk_bf16_f32 v101, v106, v107
  v_cvt_pk_bf16_f32 v102, v108, v109
  v_cvt_pk_bf16_f32 v103, v110, v111
  v_mfma_f32_32x32x16_bf16 a[48:63], v[68:71], v[96:99], a[48:63]
  v_exp_f32 v80, v80
  v_exp_f32 v81, v81
  v_exp_f32 v82, v82
  v_mfma_f32_32x32x16_bf16 a[48:63], v[72:75], v[100:103], a[48:63]
  v_exp_f32 v83, v83
  v_exp_f32 v84, v84
  v_exp_f32 v85, v85
  v_mfma_f32_32x32x16_bf16 v[96:111], v[62:65], v[30:33], 0
  v_exp_f32 v86, v86
  v_exp_f32 v87, v87
  v_exp_f32 v88, v88
  v_mfma_f32_32x32x8_bf16 v[96:111], v[66:67], v[34:35], v[96:111]
  v_exp_f32 v89, v89
  v_exp_f32 v90, v90
  v_exp_f32 v91, v91
  v_exp_f32 v92, v92
  v_exp_f32 v93, v93
  v_exp_f32 v94, v94
  v_exp_f32 v95, v95
  ds_write_b128 v124, a[32:35] offset:0
  ds_write_b128 v124, a[36:39] offset:1024
  ds_write_b128 v124, a[40:43] offset:2048
  v_cvt_pk_bf16_f32 v80, v80, v81
  v_cvt_pk_bf16_f32 v81, v82, v83
  v_cvt_pk_bf16_f32 v82, v84, v85
  v_cvt_pk_bf16_f32 v83, v86, v87
  v_cvt_pk_bf16_f32 v84, v88, v89
  v_cvt_pk_bf16_f32 v85, v90, v91
  v_cvt_pk_bf16_f32 v86, v92, v93
  v_cvt_pk_bf16_f32 v87, v94, v95
  v_mfma_f32_32x32x16_bf16 a[64:79], v[68:71], v[80:83], a[64:79]
  v_exp_f32 v96, v96
  v_exp_f32 v97, v97
  v_exp_f32 v98, v98
  v_mfma_f32_32x32x16_bf16 a[64:79], v[72:75], v[84:87], a[64:79]
  v_exp_f32 v99, v99
  v_exp_f32 v100, v100
  v_exp_f32 v101, v101
  v_mfma_f32_32x32x16_bf16 v[80:95], v[62:65], v[36:39], 0
  v_exp_f32 v102, v102
  v_exp_f32 v103, v103
  v_exp_f32 v104, v104
  v_mfma_f32_32x32x8_bf16 v[80:95], v[66:67], v[40:41], v[80:95]
  v_exp_f32 v105, v105
  v_exp_f32 v106, v106
  v_exp_f32 v107, v107
  v_exp_f32 v108, v108
  v_exp_f32 v109, v109
  v_exp_f32 v110, v110
  v_exp_f32 v111, v111
  ds_write_b128 v124, a[48:51] offset:3072
  ds_write_b128 v124, a[52:55] offset:4096
  ds_write_b128 v124, a[56:59] offset:5120
  v_cvt_pk_bf16_f32 v96, v96, v97
  v_cvt_pk_bf16_f32 v97, v98, v99
  v_cvt_pk_bf16_f32 v98, v100, v101
  v_cvt_pk_bf16_f32 v99, v102, v103
  v_cvt_pk_bf16_f32 v100, v104, v105
  v_cvt_pk_bf16_f32 v101, v106, v107
  v_cvt_pk_bf16_f32 v102, v108, v109
  v_cvt_pk_bf16_f32 v103, v110, v111
  v_mfma_f32_32x32x16_bf16 a[80:95], v[68:71], v[96:99], a[80:95]
  v_exp_f32 v80, v80
  v_exp_f32 v81, v81
  v_exp_f32 v82, v82
  v_mfma_f32_32x32x16_bf16 a[80:95], v[72:75], v[100:103], a[80:95]
  v_exp_f32 v83, v83
  v_exp_f32 v84, v84
  v_exp_f32 v85, v85
  v_mfma_f32_32x32x16_bf16 v[96:111], v[62:65], v[42:45], 0
  v_exp_f32 v86, v86
  v_exp_f32 v87, v87
  v_exp_f32 v88, v88
  v_mfma_f32_32x32x8_bf16 v[96:111], v[66:67], v[46:47], v[96:111]
  v_exp_f32 v89, v89
  v_exp_f32 v90, v90
  v_exp_f32 v91, v91
  v_exp_f32 v92, v92
  v_exp_f32 v93, v93
  v_exp_f32 v94, v94
  v_exp_f32 v95, v95
  ds_write_b128 v125, a[64:67] offset:0
  ds_write_b128 v125, a[68:71] offset:1024
  ds_write_b128 v125, a[72:75] offset:2048
  v_cvt_pk_bf16_f32 v80, v80, v81
  v_cvt_pk_bf16_f32 v81, v82, v83
  v_cvt_pk_bf16_f32 v82, v84, v85
  v_cvt_pk_bf16_f32 v83, v86, v87
  v_cvt_pk_bf16_f32 v84, v88, v89
  v_cvt_pk_bf16_f32 v85, v90, v91
  v_cvt_pk_bf16_f32 v86, v92, v93
  v_cvt_pk_bf16_f32 v87, v94, v95
  v_mfma_f32_32x32x16_bf16 a[96:111], v[68:71], v[80:83], a[96:111]
  v_exp_f32 v96, v96
  v_exp_f32 v97, v97
  v_exp_f32 v98, v98
  v_mfma_f32_32x32x16_bf16 a[96:111], v[72:75], v[84:87], a[96:111]
  v_exp_f32 v99, v99
  v_exp_f32 v100, v100
  v_exp_f32 v101, v101
  v_exp_f32 v102, v102
  v_exp_f32 v103, v103
  v_exp_f32 v104, v104
  v_exp_f32 v105, v105
  v_exp_f32 v106, v106
  v_exp_f32 v107, v107
  v_exp_f32 v108, v108
  v_exp_f32 v109, v109
  v_exp_f32 v110, v110
  v_exp_f32 v111, v111
  ds_write_b128 v125, a[80:83] offset:3072
  ds_write_b128 v125, a[84:87] offset:4096
  ds_write_b128 v125, a[88:91] offset:5120
  v_cvt_pk_bf16_f32 v96, v96, v97
  v_cvt_pk_bf16_f32 v97, v98, v99
  v_cvt_pk_bf16_f32 v98, v100, v101
  v_cvt_pk_bf16_f32 v99, v102, v103
  v_cvt_pk_bf16_f32 v100, v104, v105
  v_cvt_pk_bf16_f32 v101, v106, v107
  v_cvt_pk_bf16_f32 v102, v108, v109
  v_cvt_pk_bf16_f32 v103, v110, v111
  v_mfma_f32_32x32x16_bf16 a[112:127], v[68:71], v[96:99], a[112:127]
  s_nop 0
  v_mfma_f32_32x32x16_bf16 a[112:127], v[72:75], v[100:103], a[112:127]
  ds_write_b128 v126, a[96:99] offset:0
  ds_write_b128 v126, a[100:103] offset:1024
  ds_write_b128 v126, a[104:107] offset:2048
  s_nop 8
  ds_write_b128 v126, a[112:115] offset:3072
  ds_write_b128 v126, a[116:119] offset:4096
  ds_write_b128 v126, a[120:123] offset:5120
  v_accvgpr_read_b32 v80, a8
  v_accvgpr_read_b32 v81, a24
  v_accvgpr_read_b32 v82, a40
  v_accvgpr_read_b32 v83, a56
  v_accvgpr_read_b32 v84, a72
  v_accvgpr_read_b32 v85, a88
  v_accvgpr_read_b32 v86, a104
  v_accvgpr_read_b32 v87, a120
  v_max3_f32 v88, v80, v81, v82
  v_min3_f32 v89, v80, v81, v82
  v_max3_f32 v88, v88, v83, v84
  v_min3_f32 v89, v89, v83, v84
  v_max3_f32 v88, v88, v85, v86
  v_min3_f32 v89, v89, v85, v86
  v_max_f32 v88, v88, v87
  v_min_f32 v89, v89, v87
  v_cmp_lt_f32 vcc, 0x5d800000, v88
  s_nop 0
  s_mov_b32 s58, vcc_hi
  v_cmp_gt_f32 vcc, 0x21800000, v89
  s_nop 0
  s_or_b32 s58, s58, vcc_hi
  s_cmp_lg_u32 s58, 0
  s_cselect_b32 s58, 0x10001, 1
  s_cmp_lg_u32 s62, 0
  s_cselect_b32 s58, 1, s58
  v_mov_b32 v121, s58
  s_mov_b64 exec, 1
  ds_add_u32 v120, v121 offset:16
  s_mov_b64 exec, -1
  v_accvgpr_read_b32 v84, a0
  v_accvgpr_read_b32 v85, a1
  v_accvgpr_read_b32 v86, a2
  v_accvgpr_read_b32 v87, a3
  v_accvgpr_read_b32 v88, a4
  v_accvgpr_read_b32 v89, a5
  v_accvgpr_read_b32 v90, a6
  v_accvgpr_read_b32 v91, a7
  v_accvgpr_read_b32 v92, a8
  v_accvgpr_read_b32 v93, a9
  v_accvgpr_read_b32 v94, a10
  v_accvgpr_read_b32 v95, a11
  v_accvgpr_read_b32 v96, a16
  v_accvgpr_read_b32 v97, a17
  v_accvgpr_read_b32 v98, a18
  v_accvgpr_read_b32 v99, a19
  v_accvgpr_read_b32 v100, a20
  v_accvgpr_read_b32 v101, a21
  v_accvgpr_read_b32 v102, a22
  v_accvgpr_read_b32 v103, a23
  v_accvgpr_read_b32 v104, a24
  v_accvgpr_read_b32 v105, a25
  v_accvgpr_read_b32 v106, a26
  v_accvgpr_read_b32 v107, a27
  s_mul_i32 s57, s76, 94
  s_mul_i32 s58, s36, 10
  s_add_u32 s57, s57, s58
  s_lshl_b32 s57, s57, 10
  s_add_u32 s68, s57, 20119552
  s_add_u32 s69, s68, 96256
  s_add_u32 s70, s68, 192512
  s_lshl_b32 s65, s62, 2
  s_add_u32 s65, s65, 4
  v_mov_b32 v119, v76
  s_waitcnt lgkmcnt(0)
  s_mov_b32 s80, 0x200000
  L_kg_d_4:
  s_waitcnt vmcnt(0)
  v_cmp_gt_u32 vcc, 32, v112
  s_nop 4
  s_cbranch_vccz L_kg_d_4_d
  s_sleep 3
  buffer_load_dword v112, v113, s[52:55], 0 offen offset:32 sc1
  s_sub_u32 s80, s80, 1
  s_cbranch_scc0 L_kg_d_4
  L_kg_d_4_d:
  s_mov_b32 s60, 0
  s_mov_b32 s61, s60
  s_lshl_b32 s57, s36, 3
  v_add_u32 v118, s57, v79
  v_and_b32 v118, 31, v118
  v_lshl_add_u32 v118, v78, 5, v118
  v_lshlrev_b32 v118, 4, v118
  s_cmp_eq_u32 s77, 2
  s_cbranch_scc1 L_kg_wo_5
  v_add_u32 v116, s60, v118
  s_add_u32 s60, s60, 1024
  s_cmp_eq_u32 s60, 10240
  s_cselect_b32 s60, 0, s60
  buffer_load_dwordx4 a[0:3], v116, s[40:43], s68 offen sc1
  buffer_load_dwordx4 a[4:7], v116, s[40:43], s69 offen sc1
  buffer_load_dwordx4 a[8:11], v116, s[40:43], s70 offen sc1
  v_add_u32 v116, s60, v118
  s_add_u32 s60, s60, 1024
  s_cmp_eq_u32 s60, 10240
  s_cselect_b32 s60, 0, s60
  buffer_load_dwordx4 a[12:15], v116, s[40:43], s68 offen sc1
  buffer_load_dwordx4 a[16:19], v116, s[40:43], s69 offen sc1
  buffer_load_dwordx4 a[20:23], v116, s[40:43], s70 offen sc1
  v_add_u32 v116, s60, v118
  s_add_u32 s60, s60, 1024
  s_cmp_eq_u32 s60, 10240
  s_cselect_b32 s60, 0, s60
  buffer_load_dwordx4 a[24:27], v116, s[40:43], s68 offen sc1
  buffer_load_dwordx4 a[28:31], v116, s[40:43], s69 offen sc1
  buffer_load_dwordx4 a[32:35], v116, s[40:43], s70 offen sc1
  v_add_u32 v116, s60, v118
  s_add_u32 s60, s60, 1024
  s_cmp_eq_u32 s60, 10240
  s_cselect_b32 s60, 0, s60
  buffer_load_dwordx4 a[36:39], v116, s[40:43], s68 offen sc1
  buffer_load_dwordx4 a[40:43], v116, s[40:43], s69 offen sc1
  buffer_load_dwordx4 a[44:47], v116, s[40:43], s70 offen sc1
  s_branch L_kg_wo_5e
L_kg_wo_5:
  v_add_u32 v116, s60, v118
  s_add_u32 s60, s60, 1024
  s_cmp_eq_u32 s60, 10240
  s_cselect_b32 s60, 0, s60
  buffer_load_dwordx4 a[0:3], v116, s[40:43], s68 offen sc1
  buffer_load_dwordx4 a[4:7], v116, s[40:43], s69 offen sc1
  v_add_u32 v116, s60, v118
  s_add_u32 s60, s60, 1024
  s_cmp_eq_u32 s60, 10240
  s_cselect_b32 s60, 0, s60
  buffer_load_dwordx4 a[12:15], v116, s[40:43], s68 offen sc1
  buffer_load_dwordx4 a[16:19], v116, s[40:43], s69 offen sc1
  v_add_u32 v116, s60, v118
  s_add_u32 s60, s60, 1024
  s_cmp_eq_u32 s60, 10240
  s_cselect_b32 s60, 0, s60
  buffer_load_dwordx4 a[24:27], v116, s[40:43], s68 offen sc1
  buffer_load_dwordx4 a[28:31], v116, s[40:43], s69 offen sc1
  v_add_u32 v116, s60, v118
  s_add_u32 s60, s60, 1024
  s_cmp_eq_u32 s60, 10240
  s_cselect_b32 s60, 0, s60
  buffer_load_dwordx4 a[36:39], v116, s[40:43], s68 offen sc1
  buffer_load_dwordx4 a[40:43], v116, s[40:43], s69 offen sc1
L_kg_wo_5e:
  s_lshr_b32 s57, s36, 1
  s_lshl_b32 s58, s34, 1
  s_add_u32 s57, s57, s58
  s_mul_i32 s64, s57, 40960
  s_mul_i32 s57, s35, 5120
  s_add_u32 s64, s64, s57
  s_add_u32 s64, s64, 17498112
  s_and_b32 s57, s36, 1
  s_lshl_b32 s58, s57, 9
  s_add_u32 s59, s64, s58
  s_add_u32 s59, s59, 4096
  s_lshl_b32 s57, s57, 11
  s_add_u32 s64, s64, s57
  s_mov_b32 s80, 0x8000000
L_kg_w_6:
  ds_read_b32 v122, v120 offset:16
  s_waitcnt lgkmcnt(0)
  v_readfirstlane_b32 s57, v122
  s_nop 0
  s_and_b32 s58, s57, 0xffff
  s_cmp_ge_u32 s58, s65
  s_cbranch_scc1 L_kg_w_6_d
  s_sleep 1
  s_sub_u32 s80, s80, 1
  s_cbranch_scc0 L_kg_w_6
L_kg_w_6_d:
  s_lshr_b32 s57, s57, 16
  s_cmp_lg_u32 s57, 0
  s_cselect_b32 s57, 1, 0
  s_cmp_lt_u32 s62, s57
  s_cbranch_scc1 L_kg_fallback
  ds_read_b128 v[0:3], v117 offset:0
  ds_read_b128 v[4:7], v117 offset:1024
  ds_read_b128 v[8:11], v117 offset:2048
  ds_read_b128 v[12:15], v117 offset:3072
  ds_read_b128 v[16:19], v117 offset:4096
  ds_read_b128 v[20:23], v117 offset:5120
  ds_read_b128 v[24:27], v117 offset:6144
  ds_read_b128 v[28:31], v117 offset:7168
  ds_read_b128 v[32:35], v117 offset:8192
  ds_read_b128 v[36:39], v117 offset:9216
  ds_read_b128 v[40:43], v117 offset:10240
  ds_read_b128 v[44:47], v117 offset:11264
  ds_read_b128 v[48:51], v117 offset:12288
  ds_read_b128 v[52:55], v117 offset:13312
  ds_read_b128 v[56:59], v117 offset:14336
  ds_read_b128 v[60:63], v117 offset:15360
  ds_read_b128 v[64:67], v117 offset:16384
  ds_read_b128 v[68:71], v117 offset:17408
  s_waitcnt lgkmcnt(12)
  v_pk_add_f32 v[84:85], v[84:85], v[0:1]
  v_pk_add_f32 v[86:87], v[86:87], v[2:3]
  v_pk_add_f32 v[88:89], v[88:89], v[4:5]
  v_pk_add_f32 v[90:91], v[90:91], v[6:7]
  v_pk_add_f32 v[92:93], v[92:93], v[8:9]
  v_pk_add_f32 v[94:95], v[94:95], v[10:11]
  v_pk_add_f32 v[96:97], v[96:97], v[12:13]
  v_pk_add_f32 v[98:99], v[98:99], v[14:15]
  v_pk_add_f32 v[100:101], v[100:101], v[16:17]
  v_pk_add_f32 v[102:103], v[102:103], v[18:19]
  v_pk_add_f32 v[104:105], v[104:105], v[20:21]
  v_pk_add_f32 v[106:107], v[106:107], v[22:23]
  s_waitcnt lgkmcnt(6)
  v_pk_add_f32 v[84:85], v[84:85], v[24:25]
  v_pk_add_f32 v[86:87], v[86:87], v[26:27]
  v_pk_add_f32 v[88:89], v[88:89], v[28:29]
  v_pk_add_f32 v[90:91], v[90:91], v[30:31]
  v_pk_add_f32 v[92:93], v[92:93], v[32:33]
  v_pk_add_f32 v[94:95], v[94:95], v[34:35]
  v_pk_add_f32 v[96:97], v[96:97], v[36:37]
  v_pk_add_f32 v[98:99], v[98:99], v[38:39]
  v_pk_add_f32 v[100:101], v[100:101], v[40:41]
  v_pk_add_f32 v[102:103], v[102:103], v[42:43]
  v_pk_add_f32 v[104:105], v[104:105], v[44:45]
  v_pk_add_f32 v[106:107], v[106:107], v[46:47]
  s_waitcnt lgkmcnt(0)
  v_pk_add_f32 v[84:85], v[84:85], v[48:49]
  v_pk_add_f32 v[86:87], v[86:87], v[50:51]
  v_pk_add_f32 v[88:89], v[88:89], v[52:53]
  v_pk_add_f32 v[90:91], v[90:91], v[54:55]
  v_pk_add_f32 v[92:93], v[92:93], v[56:57]
  v_pk_add_f32 v[94:95], v[94:95], v[58:59]
  v_pk_add_f32 v[96:97], v[96:97], v[60:61]
  v_pk_add_f32 v[98:99], v[98:99], v[62:63]
  v_pk_add_f32 v[100:101], v[100:101], v[64:65]
  v_pk_add_f32 v[102:103], v[102:103], v[66:67]
  v_pk_add_f32 v[104:105], v[104:105], v[68:69]
  v_pk_add_f32 v[106:107], v[106:107], v[70:71]
  v_mov_b32 v0, v92
  v_mov_b32 v1, v92
  v_mov_b32 v2, v104
  v_mov_b32 v3, v104
  s_nop 0
  v_permlane32_swap_b32 v0, v1
  v_permlane32_swap_b32 v2, v3
  v_rcp_f32 v0, v1
  v_rcp_f32 v2, v3
  v_pk_mul_f32 v[84:85], v[84:85], v[0:1] op_sel_hi:[1,0]
  v_pk_mul_f32 v[86:87], v[86:87], v[0:1] op_sel_hi:[1,0]
  v_pk_mul_f32 v[88:89], v[88:89], v[0:1] op_sel_hi:[1,0]
  v_pk_mul_f32 v[90:91], v[90:91], v[0:1] op_sel_hi:[1,0]
  v_pk_mul_f32 v[92:93], v[92:93], v[0:1] op_sel_hi:[1,0]
  v_pk_mul_f32 v[94:95], v[94:95], v[0:1] op_sel_hi:[1,0]
  v_pk_mul_f32 v[96:97], v[96:97], v[2:3] op_sel_hi:[1,0]
  v_pk_mul_f32 v[98:99], v[98:99], v[2:3] op_sel_hi:[1,0]
  v_pk_mul_f32 v[100:101], v[100:101], v[2:3] op_sel_hi:[1,0]
  v_pk_mul_f32 v[102:103], v[102:103], v[2:3] op_sel_hi:[1,0]
  v_pk_mul_f32 v[104:105], v[104:105], v[2:3] op_sel_hi:[1,0]
  v_pk_mul_f32 v[106:107], v[106:107], v[2:3] op_sel_hi:[1,0]
  v_cvt_pk_bf16_f32 v4, v84, v85
  v_cvt_pk_bf16_f32 v5, v86, v87
  v_cvt_pk_bf16_f32 v6, v88, v89
  v_cvt_pk_bf16_f32 v7, v90, v91
  v_cvt_pk_bf16_f32 v12, v92, v93
  v_cvt_pk_bf16_f32 v13, v94, v95
  v_cvt_pk_bf16_f32 v8, v96, v97
  v_cvt_pk_bf16_f32 v9, v98, v99
  v_cvt_pk_bf16_f32 v10, v100, v101
  v_cvt_pk_bf16_f32 v11, v102, v103
  v_cvt_pk_bf16_f32 v14, v104, v105
  v_cvt_pk_bf16_f32 v15, v106, v107
  buffer_store_dwordx4 v[4:7], v76, s[40:43], s64 offen sc1
  buffer_store_dwordx4 v[8:11], v76, s[40:43], s64 offen offset:1024 sc1
  s_mov_b32 exec_hi, 0
  buffer_store_dwordx4 v[12:15], v76, s[40:43], s59 offen sc1
  s_mov_b32 exec_hi, -1
  s_lshl_b32 s71, s34, 13
  s_lshl_b32 s57, s35, 2
  s_add_u32 s72, s71, s57
  s_add_u32 s72, s72, 22143744
  s_add_u32 s71, s56, 768
  v_and_b32 v123, 7, v79
  v_and_b32 v123, 1, v79
  s_lshl_b32 s57, s36, 1
  v_add_u32 v123, s57, v123
  s_mov_b32 exec_hi, 0
  v_mov_b32 v123, s35
  s_mov_b32 exec_hi, -1
  v_lshlrev_b32 v123, 2, v123
  v_mul_u32_u24 v124, 48, v79
  v_lshl_add_u32 v124, v78, 3, v124
  s_mul_i32 s57, s36, 18496
  s_add_u32 s57, s57, 73728
  v_add_u32 v124, s57, v124
  s_waitcnt vmcnt(0)
  s_mov_b64 exec, 1
  v_mov_b32 v121, 1
  ds_add_rtn_u32 v122, v120, v121 offset:36
  s_mov_b64 exec, -1
  s_waitcnt lgkmcnt(0)
  v_readfirstlane_b32 s57, v122
  s_nop 0
  s_cmp_eq_u32 s57, 3
  s_cbranch_scc0 L_kg_p_7
  v_lshlrev_b32 v121, 10, v79
  v_mov_b32 v122, 1
  s_mov_b32 exec_lo, 0xff
  s_mov_b32 exec_hi, 0
  buffer_store_dword v122, v121, s[40:43], s72 offen sc1
  s_mov_b64 exec, -1
L_kg_p_7:
  s_cmp_eq_u32 s77, 2
  s_cbranch_scc1 L_kg_wo_8
  v_add_u32 v116, s60, v118
  s_add_u32 s60, s60, 1024
  s_cmp_eq_u32 s60, 10240
  s_cselect_b32 s60, 0, s60
  buffer_load_dwordx4 a[48:51], v116, s[40:43], s68 offen sc1
  buffer_load_dwordx4 a[52:55], v116, s[40:43], s69 offen sc1
  buffer_load_dwordx4 a[56:59], v116, s[40:43], s70 offen sc1
  v_add_u32 v116, s60, v118
  s_add_u32 s60, s60, 1024
  s_cmp_eq_u32 s60, 10240
  s_cselect_b32 s60, 0, s60
  buffer_load_dwordx4 a[60:63], v116, s[40:43], s68 offen sc1
  buffer_load_dwordx4 a[64:67], v116, s[40:43], s69 offen sc1
  buffer_load_dwordx4 a[68:71], v116, s[40:43], s70 offen sc1
  v_add_u32 v116, s60, v118
  s_add_u32 s60, s60, 1024
  s_cmp_eq_u32 s60, 10240
  s_cselect_b32 s60, 0, s60
  buffer_load_dwordx4 a[72:75], v116, s[40:43], s68 offen sc1
  buffer_load_dwordx4 a[76:79], v116, s[40:43], s69 offen sc1
  buffer_load_dwordx4 a[80:83], v116, s[40:43], s70 offen sc1
  v_add_u32 v116, s60, v118
  s_add_u32 s60, s60, 1024
  s_cmp_eq_u32 s60, 10240
  s_cselect_b32 s60, 0, s60
  buffer_load_dwordx4 a[84:87], v116, s[40:43], s68 offen sc1
  buffer_load_dwordx4 a[88:91], v116, s[40:43], s69 offen sc1
  buffer_load_dwordx4 a[92:95], v116, s[40:43], s70 offen sc1
  v_add_u32 v116, s60, v118
  s_add_u32 s60, s60, 1024
  s_cmp_eq_u32 s60, 10240
  s_cselect_b32 s60, 0, s60
  buffer_load_dwordx4 a[96:99], v116, s[40:43], s68 offen sc1
  buffer_load_dwordx4 a[100:103], v116, s[40:43], s69 offen sc1
  buffer_load_dwordx4 a[104:107], v116, s[40:43], s70 offen sc1
  v_add_u32 v116, s60, v118
  s_add_u32 s60, s60, 1024
  s_cmp_eq_u32 s60, 10240
  s_cselect_b32 s60, 0, s60
  buffer_load_dwordx4 a[108:111], v116, s[40:43], s68 offen sc1
  buffer_load_dwordx4 a[112:115], v116, s[40:43], s69 offen sc1
  buffer_load_dwordx4 a[116:119], v116, s[40:43], s70 offen sc1
  s_branch L_kg_wo_8e
L_kg_wo_8:
  v_add_u32 v116, s60, v118
  s_add_u32 s60, s60, 1024
  s_cmp_eq_u32 s60, 10240
  s_cselect_b32 s60, 0, s60
  buffer_load_dwordx4 a[48:51], v116, s[40:43], s68 offen sc1
  buffer_load_dwordx4 a[52:55], v116, s[40:43], s69 offen sc1
  v_add_u32 v116, s60, v118
  s_add_u32 s60, s60, 1024
  s_cmp_eq_u32 s60, 10240
  s_cselect_b32 s60, 0, s60
  buffer_load_dwordx4 a[60:63], v116, s[40:43], s68 offen sc1
  buffer_load_dwordx4 a[64:67], v116, s[40:43], s69 offen sc1
  v_add_u32 v116, s60, v118
  s_add_u32 s60, s60, 1024
  s_cmp_eq_u32 s60, 10240
  s_cselect_b32 s60, 0, s60
  buffer_load_dwordx4 a[72:75], v116, s[40:43], s68 offen sc1
  buffer_load_dwordx4 a[76:79], v116, s[40:43], s69 offen sc1
  v_add_u32 v116, s60, v118
  s_add_u32 s60, s60, 1024
  s_cmp_eq_u32 s60, 10240
  s_cselect_b32 s60, 0, s60
  buffer_load_dwordx4 a[84:87], v116, s[40:43], s68 offen sc1
  buffer_load_dwordx4 a[88:91], v116, s[40:43], s69 offen sc1
  v_add_u32 v116, s60, v118
  s_add_u32 s60, s60, 1024
  s_cmp_eq_u32 s60, 10240
  s_cselect_b32 s60, 0, s60
  buffer_load_dwordx4 a[96:99], v116, s[40:43], s68 offen sc1
  buffer_load_dwordx4 a[100:103], v116, s[40:43], s69 offen sc1
  v_add_u32 v116, s60, v118
  s_add_u32 s60, s60, 1024
  s_cmp_eq_u32 s60, 10240
  s_cselect_b32 s60, 0, s60
  buffer_load_dwordx4 a[108:111], v116, s[40:43], s68 offen sc1
  buffer_load_dwordx4 a[112:115], v116, s[40:43], s69 offen sc1
L_kg_wo_8e:
  s_mul_i32 s73, s34, 81920
  s_mul_i32 s57, s36, 10240
  s_add_u32 s73, s73, s57
  s_add_u32 s73, s73, 17498112
  s_add_u32 s74, s73, 40960
  s_mov_b32 s80, 0x200000
  L_kg_g_9:
  buffer_load_dword v122, v123, s[40:43], s71 offen sc1
  s_waitcnt vmcnt(0)
  v_cmp_gt_u32 vcc, 1, v122
  s_nop 4
  s_cbranch_vccz L_kg_g_9_d
  s_sleep 1
  s_sub_u32 s80, s80, 1
  s_cbranch_scc0 L_kg_g_9
  L_kg_g_9_d:
  s_cmp_eq_u32 s77, 2
  s_cbranch_scc1 L_kg_s2
  v_mov_b32 v125, v119
  v_add_u32 v126, s61, v125
  s_add_u32 s61, s61, 1024
  s_cmp_eq_u32 s61, 10240
  s_cselect_b32 s61, 0, s61
  buffer_load_dwordx4 v[96:99], v126, s[40:43], s73 offen sc1
  buffer_load_dwordx4 v[100:103], v126, s[40:43], s74 offen sc1
  v_add_u32 v126, s61, v125
  s_add_u32 s61, s61, 1024
  s_cmp_eq_u32 s61, 10240
  s_cselect_b32 s61, 0, s61
  buffer_load_dwordx4 v[104:107], v126, s[40:43], s73 offen sc1
  buffer_load_dwordx4 v[108:111], v126, s[40:43], s74 offen sc1
  v_add_u32 v126, s61, v125
  s_add_u32 s61, s61, 1024
  s_cmp_eq_u32 s61, 10240
  s_cselect_b32 s61, 0, s61
  buffer_load_dwordx4 v[112:115], v126, s[40:43], s73 offen sc1
  buffer_load_dwordx4 v[116:119], v126, s[40:43], s74 offen sc1
  v_add_u32 v126, s61, v125
  s_add_u32 s61, s61, 1024
  s_cmp_eq_u32 s61, 10240
  s_cselect_b32 s61, 0, s61
  buffer_load_dwordx4 a[120:123], v126, s[40:43], s73 offen sc1
  buffer_load_dwordx4 a[124:127], v126, s[40:43], s74 offen sc1
  s_waitcnt vmcnt(6)
  v_mfma_f32_32x32x16_bf16 v[0:15], a[0:3], v[96:99], 0
  v_mfma_f32_32x32x16_bf16 v[16:31], a[0:3], v[100:103], 0
  v_mfma_f32_32x32x16_bf16 v[32:47], a[4:7], v[96:99], 0
  v_mfma_f32_32x32x16_bf16 v[48:63], a[4:7], v[100:103], 0
  v_mfma_f32_32x32x16_bf16 v[64:79], a[8:11], v[96:99], 0
  v_mfma_f32_32x32x16_bf16 v[80:95], a[8:11], v[100:103], 0
  v_add_u32 v126, s61, v125
  s_add_u32 s61, s61, 1024
  s_cmp_eq_u32 s61, 10240
  s_cselect_b32 s61, 0, s61
  buffer_load_dwordx4 v[96:99], v126, s[40:43], s73 offen sc1
  buffer_load_dwordx4 v[100:103], v126, s[40:43], s74 offen sc1
  s_waitcnt vmcnt(6)
  v_mfma_f32_32x32x16_bf16 v[0:15], a[12:15], v[104:107], v[0:15]
  v_mfma_f32_32x32x16_bf16 v[16:31], a[12:15], v[108:111], v[16:31]
  v_mfma_f32_32x32x16_bf16 v[32:47], a[16:19], v[104:107], v[32:47]
  v_mfma_f32_32x32x16_bf16 v[48:63], a[16:19], v[108:111], v[48:63]
  v_mfma_f32_32x32x16_bf16 v[64:79], a[20:23], v[104:107], v[64:79]
  v_mfma_f32_32x32x16_bf16 v[80:95], a[20:23], v[108:111], v[80:95]
  v_add_u32 v126, s61, v125
  s_add_u32 s61, s61, 1024
  s_cmp_eq_u32 s61, 10240
  s_cselect_b32 s61, 0, s61
  buffer_load_dwordx4 v[104:107], v126, s[40:43], s73 offen sc1
  buffer_load_dwordx4 v[108:111], v126, s[40:43], s74 offen sc1
  s_waitcnt vmcnt(6)
  v_mfma_f32_32x32x16_bf16 v[0:15], a[24:27], v[112:115], v[0:15]
  v_mfma_f32_32x32x16_bf16 v[16:31], a[24:27], v[116:119], v[16:31]
  v_mfma_f32_32x32x16_bf16 v[32:47], a[28:31], v[112:115], v[32:47]
  v_mfma_f32_32x32x16_bf16 v[48:63], a[28:31], v[116:119], v[48:63]
  v_mfma_f32_32x32x16_bf16 v[64:79], a[32:35], v[112:115], v[64:79]
  v_mfma_f32_32x32x16_bf16 v[80:95], a[32:35], v[116:119], v[80:95]
  v_add_u32 v126, s61, v125
  s_add_u32 s61, s61, 1024
  s_cmp_eq_u32 s61, 10240
  s_cselect_b32 s61, 0, s61
  buffer_load_dwordx4 v[112:115], v126, s[40:43], s73 offen sc1
  buffer_load_dwordx4 v[116:119], v126, s[40:43], s74 offen sc1
  s_waitcnt vmcnt(6)
  v_mfma_f32_32x32x16_bf16 v[0:15], a[36:39], a[120:123], v[0:15]
  v_mfma_f32_32x32x16_bf16 v[16:31], a[36:39], a[124:127], v[16:31]
  v_mfma_f32_32x32x16_bf16 v[32:47], a[40:43], a[120:123], v[32:47]
  v_mfma_f32_32x32x16_bf16 v[48:63], a[40:43], a[124:127], v[48:63]
  v_mfma_f32_32x32x16_bf16 v[64:79], a[44:47], a[120:123], v[64:79]
  v_mfma_f32_32x32x16_bf16 v[80:95], a[44:47], a[124:127], v[80:95]
  v_add_u32 v126, s61, v125
  s_add_u32 s61, s61, 1024
  s_cmp_eq_u32 s61, 10240
  s_cselect_b32 s61, 0, s61
  buffer_load_dwordx4 a[120:123], v126, s[40:43], s73 offen sc1
  buffer_load_dwordx4 a[124:127], v126, s[40:43], s74 offen sc1
  s_waitcnt vmcnt(6)
  v_mfma_f32_32x32x16_bf16 v[0:15], a[48:51], v[96:99], v[0:15]
  v_mfma_f32_32x32x16_bf16 v[16:31], a[48:51], v[100:103], v[16:31]
  v_mfma_f32_32x32x16_bf16 v[32:47], a[52:55], v[96:99], v[32:47]
  v_mfma_f32_32x32x16_bf16 v[48:63], a[52:55], v[100:103], v[48:63]
  v_mfma_f32_32x32x16_bf16 v[64:79], a[56:59], v[96:99], v[64:79]
  v_mfma_f32_32x32x16_bf16 v[80:95], a[56:59], v[100:103], v[80:95]
  v_add_u32 v126, s61, v125
  s_add_u32 s61, s61, 1024
  s_cmp_eq_u32 s61, 10240
  s_cselect_b32 s61, 0, s61
  buffer_load_dwordx4 v[96:99], v126, s[40:43], s73 offen sc1
  buffer_load_dwordx4 v[100:103], v126, s[40:43], s74 offen sc1
  s_waitcnt vmcnt(6)
  v_mfma_f32_32x32x16_bf16 v[0:15], a[60:63], v[104:107], v[0:15]
  v_mfma_f32_32x32x16_bf16 v[16:31], a[60:63], v[108:111], v[16:31]
  v_mfma_f32_32x32x16_bf16 v[32:47], a[64:67], v[104:107], v[32:47]
  v_mfma_f32_32x32x16_bf16 v[48:63], a[64:67], v[108:111], v[48:63]
  v_mfma_f32_32x32x16_bf16 v[64:79], a[68:71], v[104:107], v[64:79]
  v_mfma_f32_32x32x16_bf16 v[80:95], a[68:71], v[108:111], v[80:95]
  v_add_u32 v126, s61, v125
  s_add_u32 s61, s61, 1024
  s_cmp_eq_u32 s61, 10240
  s_cselect_b32 s61, 0, s61
  buffer_load_dwordx4 v[104:107], v126, s[40:43], s73 offen sc1
  buffer_load_dwordx4 v[108:111], v126, s[40:43], s74 offen sc1
  s_waitcnt vmcnt(6)
  v_mfma_f32_32x32x16_bf16 v[0:15], a[72:75], v[112:115], v[0:15]
  v_mfma_f32_32x32x16_bf16 v[16:31], a[72:75], v[116:119], v[16:31]
  v_mfma_f32_32x32x16_bf16 v[32:47], a[76:79], v[112:115], v[32:47]
  v_mfma_f32_32x32x16_bf16 v[48:63], a[76:79], v[116:119], v[48:63]
  v_mfma_f32_32x32x16_bf16 v[64:79], a[80:83], v[112:115], v[64:79]
  v_mfma_f32_32x32x16_bf16 v[80:95], a[80:83], v[116:119], v[80:95]
  s_waitcnt vmcnt(4)
  v_mfma_f32_32x32x16_bf16 v[0:15], a[84:87], a[120:123], v[0:15]
  v_mfma_f32_32x32x16_bf16 v[16:31], a[84:87], a[124:127], v[16:31]
  v_mfma_f32_32x32x16_bf16 v[32:47], a[88:91], a[120:123], v[32:47]
  v_mfma_f32_32x32x16_bf16 v[48:63], a[88:91], a[124:127], v[48:63]
  v_mfma_f32_32x32x16_bf16 v[64:79], a[92:95], a[120:123], v[64:79]
  v_mfma_f32_32x32x16_bf16 v[80:95], a[92:95], a[124:127], v[80:95]
  s_waitcnt vmcnt(2)
  v_mfma_f32_32x32x16_bf16 v[0:15], a[96:99], v[96:99], v[0:15]
  v_mfma_f32_32x32x16_bf16 v[16:31], a[96:99], v[100:103], v[16:31]
  v_mfma_f32_32x32x16_bf16 v[32:47], a[100:103], v[96:99], v[32:47]
  v_mfma_f32_32x32x16_bf16 v[48:63], a[100:103], v[100:103], v[48:63]
  v_mfma_f32_32x32x16_bf16 v[64:79], a[104:107], v[96:99], v[64:79]
  v_mfma_f32_32x32x16_bf16 v[80:95], a[104:107], v[100:103], v[80:95]
  s_waitcnt vmcnt(0)
  v_mfma_f32_32x32x16_bf16 v[0:15], a[108:111], v[104:107], v[0:15]
  v_mfma_f32_32x32x16_bf16 v[16:31], a[108:111], v[108:111], v[16:31]
  v_mfma_f32_32x32x16_bf16 v[32:47], a[112:115], v[104:107], v[32:47]
  v_mfma_f32_32x32x16_bf16 v[48:63], a[112:115], v[108:111], v[48:63]
  v_mfma_f32_32x32x16_bf16 v[64:79], a[116:119], v[104:107], v[64:79]
  v_mfma_f32_32x32x16_bf16 v[80:95], a[116:119], v[108:111], v[80:95]
  s_add_u32 s57, s36, 1
  s_and_b32 s57, s57, 3
  s_mul_i32 s57, s57, 18432
  s_add_u32 s57, s57, 73728
  v_add_u32 v96, s57, v125
  s_add_u32 s57, s36, 2
  s_and_b32 s57, s57, 3
  s_mul_i32 s57, s57, 18432
  s_add_u32 s57, s57, 79872
  v_add_u32 v97, s57, v125
  s_add_u32 s57, s36, 3
  s_and_b32 s57, s57, 3
  s_mul_i32 s57, s57, 18432
  s_add_u32 s57, s57, 86016
  v_add_u32 v98, s57, v125
  s_mul_i32 s57, s36, 18432
  s_add_u32 s57, s57, 73728
  v_add_u32 v99, s57, v125
  ds_write_b128 v96, v[4:7] offset:0
  ds_write_b128 v96, v[20:23] offset:1024
  ds_write_b128 v96, v[36:39] offset:2048
  ds_write_b128 v96, v[52:55] offset:3072
  ds_write_b128 v96, v[68:71] offset:4096
  ds_write_b128 v96, v[84:87] offset:5120
  ds_write_b128 v97, v[8:11] offset:0
  ds_write_b128 v97, v[24:27] offset:1024
  ds_write_b128 v97, v[40:43] offset:2048
  ds_write_b128 v97, v[56:59] offset:3072
  ds_write_b128 v97, v[72:75] offset:4096
  ds_write_b128 v97, v[88:91] offset:5120
  ds_write_b128 v98, v[12:15] offset:0
  ds_write_b128 v98, v[28:31] offset:1024
  ds_write_b128 v98, v[44:47] offset:2048
  ds_write_b128 v98, v[60:63] offset:3072
  ds_write_b128 v98, v[76:79] offset:4096
  ds_write_b128 v98, v[92:95] offset:5120
  s_mov_b64 exec, 1
  v_mov_b32 v121, 1
  ds_add_u32 v120, v121 offset:32
  s_mov_b64 exec, -1
  v_lshrrev_b32 v105, 4, v125
  s_lshl_b32 s57, s36, 6
  v_add_u32 v105, s57, v105
  s_mul_i32 s68, s34, 81920
  s_lshl_b32 s58, s76, 6
  s_add_u32 s68, s68, s58
  s_mov_b32 s75, 0xffff0000
  s_mov_b32 s44, s8
  s_and_b32 s45, s9, 0xffff
  s_mov_b32 s46, 2621440
  s_mov_b32 s47, 0x20000
  s_mov_b32 s48, s28
  s_and_b32 s49, s29, 0xffff
  s_mov_b32 s50, 2621440
  s_mov_b32 s51, 0x20000
  v_mul_u32_u24 v106, 43691, v105
  v_lshrrev_b32 v106, 19, v106
  v_mul_u32_u24 v107, 12, v106
  v_sub_u32 v107, v105, v107
  v_mul_u32_u24 v126, 1280, v106
  v_lshl_add_u32 v96, v107, 4, v126
  buffer_load_dwordx4 v[108:111], v96, s[44:47], s68 offen
  v_and_b32 v126, 3, v107
  v_mul_u32_u24 v126, 18496, v126
  v_mad_u32_u24 v126, v106, 48, v126
  v_lshrrev_b32 v107, 2, v107
  v_lshl_add_u32 v100, v107, 4, v126
  v_add_u32 v105, 256, v105
  v_mul_u32_u24 v106, 43691, v105
  v_lshrrev_b32 v106, 19, v106
  v_mul_u32_u24 v107, 12, v106
  v_sub_u32 v107, v105, v107
  v_mul_u32_u24 v126, 1280, v106
  v_lshl_add_u32 v97, v107, 4, v126
  buffer_load_dwordx4 v[112:115], v97, s[44:47], s68 offen
  v_and_b32 v126, 3, v107
  v_mul_u32_u24 v126, 18496, v126
  v_mad_u32_u24 v126, v106, 48, v126
  v_lshrrev_b32 v107, 2, v107
  v_lshl_add_u32 v101, v107, 4, v126
  v_add_u32 v105, 256, v105
  v_mul_u32_u24 v106, 43691, v105
  v_lshrrev_b32 v106, 19, v106
  v_mul_u32_u24 v107, 12, v106
  v_sub_u32 v107, v105, v107
  v_mul_u32_u24 v126, 1280, v106
  v_lshl_add_u32 v98, v107, 4, v126
  buffer_load_dwordx4 v[116:119], v98, s[44:47], s68 offen
  v_and_b32 v126, 3, v107
  v_mul_u32_u24 v126, 18496, v126
  v_mad_u32_u24 v126, v106, 48, v126
  v_lshrrev_b32 v107, 2, v107
  v_lshl_add_u32 v102, v107, 4, v126
  s_mov_b32 s80, 0x8000000
L_kg_w_10:
  ds_read_b32 v122, v120 offset:32
  s_waitcnt lgkmcnt(0)
  v_readfirstlane_b32 s57, v122
  s_nop 0
  s_cmp_ge_u32 s57, 4
  s_cbranch_scc1 L_kg_w_10_d
  s_sleep 1
  s_sub_u32 s80, s80, 1
  s_cbranch_scc0 L_kg_w_10
L_kg_w_10_d:
  ds_read_b128 v[4:7], v99 offset:0
  ds_read_b128 v[20:23], v99 offset:1024
  ds_read_b128 v[36:39], v99 offset:2048
  ds_read_b128 v[52:55], v99 offset:3072
  ds_read_b128 v[68:71], v99 offset:4096
  ds_read_b128 v[84:87], v99 offset:5120
  ds_read_b128 v[8:11], v99 offset:6144
  ds_read_b128 v[24:27], v99 offset:7168
  ds_read_b128 v[40:43], v99 offset:8192
  ds_read_b128 v[56:59], v99 offset:9216
  ds_read_b128 v[72:75], v99 offset:10240
  ds_read_b128 v[88:91], v99 offset:11264
  ds_read_b128 v[12:15], v99 offset:12288
  ds_read_b128 v[28:31], v99 offset:13312
  ds_read_b128 v[44:47], v99 offset:14336
  ds_read_b128 v[60:63], v99 offset:15360
  ds_read_b128 v[76:79], v99 offset:16384
  ds_read_b128 v[92:95], v99 offset:17408
  s_waitcnt lgkmcnt(12)
  v_pk_add_f32 v[0:1], v[0:1], v[4:5]
  v_pk_add_f32 v[2:3], v[2:3], v[6:7]
  v_pk_add_f32 v[16:17], v[16:17], v[20:21]
  v_pk_add_f32 v[18:19], v[18:19], v[22:23]
  v_pk_add_f32 v[32:33], v[32:33], v[36:37]
  v_pk_add_f32 v[34:35], v[34:35], v[38:39]
  v_pk_add_f32 v[48:49], v[48:49], v[52:53]
  v_pk_add_f32 v[50:51], v[50:51], v[54:55]
  v_pk_add_f32 v[64:65], v[64:65], v[68:69]
  v_pk_add_f32 v[66:67], v[66:67], v[70:71]
  v_pk_add_f32 v[80:81], v[80:81], v[84:85]
  v_pk_add_f32 v[82:83], v[82:83], v[86:87]
  s_waitcnt lgkmcnt(6)
  v_pk_add_f32 v[0:1], v[0:1], v[8:9]
  v_pk_add_f32 v[2:3], v[2:3], v[10:11]
  v_pk_add_f32 v[16:17], v[16:17], v[24:25]
  v_pk_add_f32 v[18:19], v[18:19], v[26:27]
  v_pk_add_f32 v[32:33], v[32:33], v[40:41]
  v_pk_add_f32 v[34:35], v[34:35], v[42:43]
  v_pk_add_f32 v[48:49], v[48:49], v[56:57]
  v_pk_add_f32 v[50:51], v[50:51], v[58:59]
  v_pk_add_f32 v[64:65], v[64:65], v[72:73]
  v_pk_add_f32 v[66:67], v[66:67], v[74:75]
  v_pk_add_f32 v[80:81], v[80:81], v[88:89]
  v_pk_add_f32 v[82:83], v[82:83], v[90:91]
  s_waitcnt lgkmcnt(0)
  v_pk_add_f32 v[0:1], v[0:1], v[12:13]
  v_pk_add_f32 v[2:3], v[2:3], v[14:15]
  v_pk_add_f32 v[16:17], v[16:17], v[28:29]
  v_pk_add_f32 v[18:19], v[18:19], v[30:31]
  v_pk_add_f32 v[32:33], v[32:33], v[44:45]
  v_pk_add_f32 v[34:35], v[34:35], v[46:47]
  v_pk_add_f32 v[48:49], v[48:49], v[60:61]
  v_pk_add_f32 v[50:51], v[50:51], v[62:63]
  v_pk_add_f32 v[64:65], v[64:65], v[76:77]
  v_pk_add_f32 v[66:67], v[66:67], v[78:79]
  v_pk_add_f32 v[80:81], v[80:81], v[92:93]
  v_pk_add_f32 v[82:83], v[82:83], v[94:95]
  v_cvt_pk_bf16_f32 v0, v0, v1
  v_cvt_pk_bf16_f32 v1, v2, v3
  v_cvt_pk_bf16_f32 v16, v16, v17
  v_cvt_pk_bf16_f32 v17, v18, v19
  v_cvt_pk_bf16_f32 v32, v32, v33
  v_cvt_pk_bf16_f32 v33, v34, v35
  v_cvt_pk_bf16_f32 v48, v48, v49
  v_cvt_pk_bf16_f32 v49, v50, v51
  v_cvt_pk_bf16_f32 v64, v64, v65
  v_cvt_pk_bf16_f32 v65, v66, v67
  v_cvt_pk_bf16_f32 v80, v80, v81
  v_cvt_pk_bf16_f32 v81, v82, v83
  ds_write_b64 v124, v[0:1] offset:0
  ds_write_b64 v124, v[16:17] offset:1536
  ds_write_b64 v124, v[32:33] offset:16
  ds_write_b64 v124, v[48:49] offset:1552
  ds_write_b64 v124, v[64:65] offset:32
  ds_write_b64 v124, v[80:81] offset:1568
  v_add_u32 v103, 73728, v100
  v_add_u32 v104, 73728, v101
  v_add_u32 v105, 73728, v102
  s_waitcnt vmcnt(0) lgkmcnt(0)
  s_barrier
  ds_read_b128 v[0:3], v103
  ds_read_b128 v[4:7], v100 offset:0
  ds_read_b128 v[8:11], v104
  ds_read_b128 v[12:15], v101 offset:0
  ds_read_b128 v[16:19], v105
  ds_read_b128 v[20:23], v102 offset:0
  v_lshlrev_b32 v72, 16, v108
  v_and_b32 v73, s75, v108
  v_lshlrev_b32 v74, 16, v109
  v_and_b32 v75, s75, v109
  v_lshlrev_b32 v76, 16, v110
  v_and_b32 v77, s75, v110
  v_lshlrev_b32 v78, 16, v111
  v_and_b32 v79, s75, v111
  v_lshlrev_b32 v80, 16, v112
  v_and_b32 v81, s75, v112
  v_lshlrev_b32 v82, 16, v113
  v_and_b32 v83, s75, v113
  v_lshlrev_b32 v84, 16, v114
  v_and_b32 v85, s75, v114
  v_lshlrev_b32 v86, 16, v115
  v_and_b32 v87, s75, v115
  v_lshlrev_b32 v88, 16, v116
  v_and_b32 v89, s75, v116
  v_lshlrev_b32 v90, 16, v117
  v_and_b32 v91, s75, v117
  v_lshlrev_b32 v92, 16, v118
  v_and_b32 v93, s75, v118
  v_lshlrev_b32 v94, 16, v119
  v_and_b32 v95, s75, v119
  s_waitcnt lgkmcnt(4)
  v_lshlrev_b32 v24, 16, v0
  v_and_b32 v25, s75, v0
  v_lshlrev_b32 v26, 16, v1
  v_and_b32 v27, s75, v1
  v_lshlrev_b32 v28, 16, v2
  v_and_b32 v29, s75, v2
  v_lshlrev_b32 v30, 16, v3
  v_and_b32 v31, s75, v3
  v_lshlrev_b32 v32, 16, v4
  v_and_b32 v33, s75, v4
  v_lshlrev_b32 v34, 16, v5
  v_and_b32 v35, s75, v5
  v_lshlrev_b32 v36, 16, v6
  v_and_b32 v37, s75, v6
  v_lshlrev_b32 v38, 16, v7
  v_and_b32 v39, s75, v7
  v_pk_fma_f32 v[24:25], v[24:25], v[32:33], v[72:73]
  v_pk_fma_f32 v[26:27], v[26:27], v[34:35], v[74:75]
  v_pk_fma_f32 v[28:29], v[28:29], v[36:37], v[76:77]
  v_pk_fma_f32 v[30:31], v[30:31], v[38:39], v[78:79]
  v_cvt_pk_bf16_f32 v108, v24, v25
  v_cvt_pk_bf16_f32 v109, v26, v27
  v_cvt_pk_bf16_f32 v110, v28, v29
  v_cvt_pk_bf16_f32 v111, v30, v31
  buffer_store_dwordx4 v[108:111], v96, s[48:51], s68 offen sc1
  s_waitcnt lgkmcnt(2)
  v_lshlrev_b32 v24, 16, v8
  v_and_b32 v25, s75, v8
  v_lshlrev_b32 v26, 16, v9
  v_and_b32 v27, s75, v9
  v_lshlrev_b32 v28, 16, v10
  v_and_b32 v29, s75, v10
  v_lshlrev_b32 v30, 16, v11
  v_and_b32 v31, s75, v11
  v_lshlrev_b32 v32, 16, v12
  v_and_b32 v33, s75, v12
  v_lshlrev_b32 v34, 16, v13
  v_and_b32 v35, s75, v13
  v_lshlrev_b32 v36, 16, v14
  v_and_b32 v37, s75, v14
  v_lshlrev_b32 v38, 16, v15
  v_and_b32 v39, s75, v15
  v_pk_fma_f32 v[24:25], v[24:25], v[32:33], v[80:81]
  v_pk_fma_f32 v[26:27], v[26:27], v[34:35], v[82:83]
  v_pk_fma_f32 v[28:29], v[28:29], v[36:37], v[84:85]
  v_pk_fma_f32 v[30:31], v[30:31], v[38:39], v[86:87]
  v_cvt_pk_bf16_f32 v112, v24, v25
  v_cvt_pk_bf16_f32 v113, v26, v27
  v_cvt_pk_bf16_f32 v114, v28, v29
  v_cvt_pk_bf16_f32 v115, v30, v31
  buffer_store_dwordx4 v[112:115], v97, s[48:51], s68 offen sc1
  s_waitcnt lgkmcnt(0)
  v_lshlrev_b32 v24, 16, v16
  v_and_b32 v25, s75, v16
  v_lshlrev_b32 v26, 16, v17
  v_and_b32 v27, s75, v17
  v_lshlrev_b32 v28, 16, v18
  v_and_b32 v29, s75, v18
  v_lshlrev_b32 v30, 16, v19
  v_and_b32 v31, s75, v19
  v_lshlrev_b32 v32, 16, v20
  v_and_b32 v33, s75, v20
  v_lshlrev_b32 v34, 16, v21
  v_and_b32 v35, s75, v21
  v_lshlrev_b32 v36, 16, v22
  v_and_b32 v37, s75, v22
  v_lshlrev_b32 v38, 16, v23
  v_and_b32 v39, s75, v23
  v_pk_fma_f32 v[24:25], v[24:25], v[32:33], v[88:89]
  v_pk_fma_f32 v[26:27], v[26:27], v[34:35], v[90:91]
  v_pk_fma_f32 v[28:29], v[28:29], v[36:37], v[92:93]
  v_pk_fma_f32 v[30:31], v[30:31], v[38:39], v[94:95]
  v_cvt_pk_bf16_f32 v116, v24, v25
  v_cvt_pk_bf16_f32 v117, v26, v27
  v_cvt_pk_bf16_f32 v118, v28, v29
  v_cvt_pk_bf16_f32 v119, v30, v31
  buffer_store_dwordx4 v[116:119], v98, s[48:51], s68 offen sc1
  s_branch L_kg_f_end
L_kg_s2:
  v_mov_b32 v125, v119
  v_add_u32 v126, s61, v125
  s_add_u32 s61, s61, 1024
  s_cmp_eq_u32 s61, 10240
  s_cselect_b32 s61, 0, s61
  buffer_load_dwordx4 v[96:99], v126, s[40:43], s73 offen sc1
  buffer_load_dwordx4 v[100:103], v126, s[40:43], s74 offen sc1
  v_add_u32 v126, s61, v125
  s_add_u32 s61, s61, 1024
  s_cmp_eq_u32 s61, 10240
  s_cselect_b32 s61, 0, s61
  buffer_load_dwordx4 v[104:107], v126, s[40:43], s73 offen sc1
  buffer_load_dwordx4 v[108:111], v126, s[40:43], s74 offen sc1
  v_add_u32 v126, s61, v125
  s_add_u32 s61, s61, 1024
  s_cmp_eq_u32 s61, 10240
  s_cselect_b32 s61, 0, s61
  buffer_load_dwordx4 v[112:115], v126, s[40:43], s73 offen sc1
  buffer_load_dwordx4 v[116:119], v126, s[40:43], s74 offen sc1
  v_add_u32 v126, s61, v125
  s_add_u32 s61, s61, 1024
  s_cmp_eq_u32 s61, 10240
  s_cselect_b32 s61, 0, s61
  buffer_load_dwordx4 a[120:123], v126, s[40:43], s73 offen sc1
  buffer_load_dwordx4 a[124:127], v126, s[40:43], s74 offen sc1
  s_waitcnt vmcnt(6)
  v_mfma_f32_32x32x16_bf16 v[0:15], a[0:3], v[96:99], 0
  v_mfma_f32_32x32x16_bf16 v[16:31], a[0:3], v[100:103], 0
  v_mfma_f32_32x32x16_bf16 v[32:47], a[4:7], v[96:99], 0
  v_mfma_f32_32x32x16_bf16 v[48:63], a[4:7], v[100:103], 0
  v_add_u32 v126, s61, v125
  s_add_u32 s61, s61, 1024
  s_cmp_eq_u32 s61, 10240
  s_cselect_b32 s61, 0, s61
  buffer_load_dwordx4 v[96:99], v126, s[40:43], s73 offen sc1
  buffer_load_dwordx4 v[100:103], v126, s[40:43], s74 offen sc1
  s_waitcnt vmcnt(6)
  v_mfma_f32_32x32x16_bf16 v[0:15], a[12:15], v[104:107], v[0:15]
  v_mfma_f32_32x32x16_bf16 v[16:31], a[12:15], v[108:111], v[16:31]
  v_mfma_f32_32x32x16_bf16 v[32:47], a[16:19], v[104:107], v[32:47]
  v_mfma_f32_32x32x16_bf16 v[48:63], a[16:19], v[108:111], v[48:63]
  v_add_u32 v126, s61, v125
  s_add_u32 s61, s61, 1024
  s_cmp_eq_u32 s61, 10240
  s_cselect_b32 s61, 0, s61
  buffer_load_dwordx4 v[104:107], v126, s[40:43], s73 offen sc1
  buffer_load_dwordx4 v[108:111], v126, s[40:43], s74 offen sc1
  s_waitcnt vmcnt(6)
  v_mfma_f32_32x32x16_bf16 v[0:15], a[24:27], v[112:115], v[0:15]
  v_mfma_f32_32x32x16_bf16 v[16:31], a[24:27], v[116:119], v[16:31]
  v_mfma_f32_32x32x16_bf16 v[32:47], a[28:31], v[112:115], v[32:47]
  v_mfma_f32_32x32x16_bf16 v[48:63], a[28:31], v[116:119], v[48:63]
  v_add_u32 v126, s61, v125
  s_add_u32 s61, s61, 1024
  s_cmp_eq_u32 s61, 10240
  s_cselect_b32 s61, 0, s61
  buffer_load_dwordx4 v[112:115], v126, s[40:43], s73 offen sc1
  buffer_load_dwordx4 v[116:119], v126, s[40:43], s74 offen sc1
  s_waitcnt vmcnt(6)
  v_mfma_f32_32x32x16_bf16 v[0:15], a[36:39], a[120:123], v[0:15]
  v_mfma_f32_32x32x16_bf16 v[16:31], a[36:39], a[124:127], v[16:31]
  v_mfma_f32_32x32x16_bf16 v[32:47], a[40:43], a[120:123], v[32:47]
  v_mfma_f32_32x32x16_bf16 v[48:63], a[40:43], a[124:127], v[48:63]
  v_add_u32 v126, s61, v125
  s_add_u32 s61, s61, 1024
  s_cmp_eq_u32 s61, 10240
  s_cselect_b32 s61, 0, s61
  buffer_load_dwordx4 a[120:123], v126, s[40:43], s73 offen sc1
  buffer_load_dwordx4 a[124:127], v126, s[40:43], s74 offen sc1
  s_waitcnt vmcnt(6)
  v_mfma_f32_32x32x16_bf16 v[0:15], a[48:51], v[96:99], v[0:15]
  v_mfma_f32_32x32x16_bf16 v[16:31], a[48:51], v[100:103], v[16:31]
  v_mfma_f32_32x32x16_bf16 v[32:47], a[52:55], v[96:99], v[32:47]
  v_mfma_f32_32x32x16_bf16 v[48:63], a[52:55], v[100:103], v[48:63]
  v_add_u32 v126, s61, v125
  s_add_u32 s61, s61, 1024
  s_cmp_eq_u32 s61, 10240
  s_cselect_b32 s61, 0, s61
  buffer_load_dwordx4 v[96:99], v126, s[40:43], s73 offen sc1
  buffer_load_dwordx4 v[100:103], v126, s[40:43], s74 offen sc1
  s_waitcnt vmcnt(6)
  v_mfma_f32_32x32x16_bf16 v[0:15], a[60:63], v[104:107], v[0:15]
  v_mfma_f32_32x32x16_bf16 v[16:31], a[60:63], v[108:111], v[16:31]
  v_mfma_f32_32x32x16_bf16 v[32:47], a[64:67], v[104:107], v[32:47]
  v_mfma_f32_32x32x16_bf16 v[48:63], a[64:67], v[108:111], v[48:63]
  v_add_u32 v126, s61, v125
  s_add_u32 s61, s61, 1024
  s_cmp_eq_u32 s61, 10240
  s_cselect_b32 s61, 0, s61
  buffer_load_dwordx4 v[104:107], v126, s[40:43], s73 offen sc1
  buffer_load_dwordx4 v[108:111], v126, s[40:43], s74 offen sc1
  s_waitcnt vmcnt(6)
  v_mfma_f32_32x32x16_bf16 v[0:15], a[72:75], v[112:115], v[0:15]
  v_mfma_f32_32x32x16_bf16 v[16:31], a[72:75], v[116:119], v[16:31]
  v_mfma_f32_32x32x16_bf16 v[32:47], a[76:79], v[112:115], v[32:47]
  v_mfma_f32_32x32x16_bf16 v[48:63], a[76:79], v[116:119], v[48:63]
  s_waitcnt vmcnt(4)
  v_mfma_f32_32x32x16_bf16 v[0:15], a[84:87], a[120:123], v[0:15]
  v_mfma_f32_32x32x16_bf16 v[16:31], a[84:87], a[124:127], v[16:31]
  v_mfma_f32_32x32x16_bf16 v[32:47], a[88:91], a[120:123], v[32:47]
  v_mfma_f32_32x32x16_bf16 v[48:63], a[88:91], a[124:127], v[48:63]
  s_waitcnt vmcnt(2)
  v_mfma_f32_32x32x16_bf16 v[0:15], a[96:99], v[96:99], v[0:15]
  v_mfma_f32_32x32x16_bf16 v[16:31], a[96:99], v[100:103], v[16:31]
  v_mfma_f32_32x32x16_bf16 v[32:47], a[100:103], v[96:99], v[32:47]
  v_mfma_f32_32x32x16_bf16 v[48:63], a[100:103], v[100:103], v[48:63]
  s_waitcnt vmcnt(0)
  v_mfma_f32_32x32x16_bf16 v[0:15], a[108:111], v[104:107], v[0:15]
  v_mfma_f32_32x32x16_bf16 v[16:31], a[108:111], v[108:111], v[16:31]
  v_mfma_f32_32x32x16_bf16 v[32:47], a[112:115], v[104:107], v[32:47]
  v_mfma_f32_32x32x16_bf16 v[48:63], a[112:115], v[108:111], v[48:63]
  s_add_u32 s57, s36, 1
  s_and_b32 s57, s57, 3
  s_mul_i32 s57, s57, 18432
  s_add_u32 s57, s57, 73728
  v_add_u32 v96, s57, v125
  s_add_u32 s57, s36, 2
  s_and_b32 s57, s57, 3
  s_mul_i32 s57, s57, 18432
  s_add_u32 s57, s57, 79872
  v_add_u32 v97, s57, v125
  s_add_u32 s57, s36, 3
  s_and_b32 s57, s57, 3
  s_mul_i32 s57, s57, 18432
  s_add_u32 s57, s57, 86016
  v_add_u32 v98, s57, v125
  s_mul_i32 s57, s36, 18432
  s_add_u32 s57, s57, 73728
  v_add_u32 v99, s57, v125
  ds_write_b128 v96, v[4:7] offset:0
  ds_write_b128 v96, v[20:23] offset:1024
  ds_write_b128 v96, v[36:39] offset:2048
  ds_write_b128 v96, v[52:55] offset:3072
  ds_write_b128 v97, v[8:11] offset:0
  ds_write_b128 v97, v[24:27] offset:1024
  ds_write_b128 v97, v[40:43] offset:2048
  ds_write_b128 v97, v[56:59] offset:3072
  ds_write_b128 v98, v[12:15] offset:0
  ds_write_b128 v98, v[28:31] offset:1024
  ds_write_b128 v98, v[44:47] offset:2048
  ds_write_b128 v98, v[60:63] offset:3072
  s_mov_b64 exec, 1
  v_mov_b32 v121, 1
  ds_add_u32 v120, v121 offset:32
  s_mov_b64 exec, -1
  v_lshrrev_b32 v105, 4, v125
  s_lshl_b32 s57, s36, 6
  v_add_u32 v105, s57, v105
  s_mul_i32 s68, s34, 81920
  s_lshl_b32 s58, s76, 6
  s_add_u32 s68, s68, s58
  s_mov_b32 s75, 0xffff0000
  s_mov_b32 s44, s8
  s_and_b32 s45, s9, 0xffff
  s_mov_b32 s46, 2621440
  s_mov_b32 s47, 0x20000
  s_mov_b32 s48, s28
  s_and_b32 s49, s29, 0xffff
  s_mov_b32 s50, 2621440
  s_mov_b32 s51, 0x20000
  v_lshrrev_b32 v106, 3, v105
  v_and_b32 v107, 7, v105
  v_mul_u32_u24 v126, 1280, v106
  v_lshl_add_u32 v96, v107, 4, v126
  buffer_load_dwordx4 v[108:111], v96, s[44:47], s68 offen
  v_and_b32 v126, 3, v107
  v_mul_u32_u24 v126, 18496, v126
  v_mad_u32_u24 v126, v106, 48, v126
  v_lshrrev_b32 v107, 2, v107
  v_lshl_add_u32 v100, v107, 4, v126
  v_add_u32 v105, 256, v105
  v_lshrrev_b32 v106, 3, v105
  v_and_b32 v107, 7, v105
  v_mul_u32_u24 v126, 1280, v106
  v_lshl_add_u32 v97, v107, 4, v126
  buffer_load_dwordx4 v[112:115], v97, s[44:47], s68 offen
  v_and_b32 v126, 3, v107
  v_mul_u32_u24 v126, 18496, v126
  v_mad_u32_u24 v126, v106, 48, v126
  v_lshrrev_b32 v107, 2, v107
  v_lshl_add_u32 v101, v107, 4, v126
  s_mov_b32 s80, 0x8000000
L_kg_w_11:
  ds_read_b32 v122, v120 offset:32
  s_waitcnt lgkmcnt(0)
  v_readfirstlane_b32 s57, v122
  s_nop 0
  s_cmp_ge_u32 s57, 4
  s_cbranch_scc1 L_kg_w_11_d
  s_sleep 1
  s_sub_u32 s80, s80, 1
  s_cbranch_scc0 L_kg_w_11
L_kg_w_11_d:
  ds_read_b128 v[4:7], v99 offset:0
  ds_read_b128 v[20:23], v99 offset:1024
  ds_read_b128 v[36:39], v99 offset:2048
  ds_read_b128 v[52:55], v99 offset:3072
  ds_read_b128 v[8:11], v99 offset:6144
  ds_read_b128 v[24:27], v99 offset:7168
  ds_read_b128 v[40:43], v99 offset:8192
  ds_read_b128 v[56:59], v99 offset:9216
  ds_read_b128 v[12:15], v99 offset:12288
  ds_read_b128 v[28:31], v99 offset:13312
  ds_read_b128 v[44:47], v99 offset:14336
  ds_read_b128 v[60:63], v99 offset:15360
  s_waitcnt lgkmcnt(8)
  v_pk_add_f32 v[0:1], v[0:1], v[4:5]
  v_pk_add_f32 v[2:3], v[2:3], v[6:7]
  v_pk_add_f32 v[16:17], v[16:17], v[20:21]
  v_pk_add_f32 v[18:19], v[18:19], v[22:23]
  v_pk_add_f32 v[32:33], v[32:33], v[36:37]
  v_pk_add_f32 v[34:35], v[34:35], v[38:39]
  v_pk_add_f32 v[48:49], v[48:49], v[52:53]
  v_pk_add_f32 v[50:51], v[50:51], v[54:55]
  s_waitcnt lgkmcnt(4)
  v_pk_add_f32 v[0:1], v[0:1], v[8:9]
  v_pk_add_f32 v[2:3], v[2:3], v[10:11]
  v_pk_add_f32 v[16:17], v[16:17], v[24:25]
  v_pk_add_f32 v[18:19], v[18:19], v[26:27]
  v_pk_add_f32 v[32:33], v[32:33], v[40:41]
  v_pk_add_f32 v[34:35], v[34:35], v[42:43]
  v_pk_add_f32 v[48:49], v[48:49], v[56:57]
  v_pk_add_f32 v[50:51], v[50:51], v[58:59]
  s_waitcnt lgkmcnt(0)
  v_pk_add_f32 v[0:1], v[0:1], v[12:13]
  v_pk_add_f32 v[2:3], v[2:3], v[14:15]
  v_pk_add_f32 v[16:17], v[16:17], v[28:29]
  v_pk_add_f32 v[18:19], v[18:19], v[30:31]
  v_pk_add_f32 v[32:33], v[32:33], v[44:45]
  v_pk_add_f32 v[34:35], v[34:35], v[46:47]
  v_pk_add_f32 v[48:49], v[48:49], v[60:61]
  v_pk_add_f32 v[50:51], v[50:51], v[62:63]
  v_cvt_pk_bf16_f32 v0, v0, v1
  v_cvt_pk_bf16_f32 v1, v2, v3
  v_cvt_pk_bf16_f32 v16, v16, v17
  v_cvt_pk_bf16_f32 v17, v18, v19
  v_cvt_pk_bf16_f32 v32, v32, v33
  v_cvt_pk_bf16_f32 v33, v34, v35
  v_cvt_pk_bf16_f32 v48, v48, v49
  v_cvt_pk_bf16_f32 v49, v50, v51
  ds_write_b64 v124, v[0:1] offset:0
  ds_write_b64 v124, v[16:17] offset:1536
  ds_write_b64 v124, v[32:33] offset:16
  ds_write_b64 v124, v[48:49] offset:1552
  v_add_u32 v103, 73728, v100
  v_add_u32 v104, 73728, v101
  s_waitcnt vmcnt(0) lgkmcnt(0)
  s_barrier
  ds_read_b128 v[0:3], v103
  ds_read_b128 v[4:7], v100 offset:0
  ds_read_b128 v[8:11], v104
  ds_read_b128 v[12:15], v101 offset:0
  v_lshlrev_b32 v72, 16, v108
  v_and_b32 v73, s75, v108
  v_lshlrev_b32 v74, 16, v109
  v_and_b32 v75, s75, v109
  v_lshlrev_b32 v76, 16, v110
  v_and_b32 v77, s75, v110
  v_lshlrev_b32 v78, 16, v111
  v_and_b32 v79, s75, v111
  v_lshlrev_b32 v80, 16, v112
  v_and_b32 v81, s75, v112
  v_lshlrev_b32 v82, 16, v113
  v_and_b32 v83, s75, v113
  v_lshlrev_b32 v84, 16, v114
  v_and_b32 v85, s75, v114
  v_lshlrev_b32 v86, 16, v115
  v_and_b32 v87, s75, v115
  s_waitcnt lgkmcnt(2)
  v_lshlrev_b32 v24, 16, v0
  v_and_b32 v25, s75, v0
  v_lshlrev_b32 v26, 16, v1
  v_and_b32 v27, s75, v1
  v_lshlrev_b32 v28, 16, v2
  v_and_b32 v29, s75, v2
  v_lshlrev_b32 v30, 16, v3
  v_and_b32 v31, s75, v3
  v_lshlrev_b32 v32, 16, v4
  v_and_b32 v33, s75, v4
  v_lshlrev_b32 v34, 16, v5
  v_and_b32 v35, s75, v5
  v_lshlrev_b32 v36, 16, v6
  v_and_b32 v37, s75, v6
  v_lshlrev_b32 v38, 16, v7
  v_and_b32 v39, s75, v7
  v_pk_fma_f32 v[24:25], v[24:25], v[32:33], v[72:73]
  v_pk_fma_f32 v[26:27], v[26:27], v[34:35], v[74:75]
  v_pk_fma_f32 v[28:29], v[28:29], v[36:37], v[76:77]
  v_pk_fma_f32 v[30:31], v[30:31], v[38:39], v[78:79]
  v_cvt_pk_bf16_f32 v108, v24, v25
  v_cvt_pk_bf16_f32 v109, v26, v27
  v_cvt_pk_bf16_f32 v110, v28, v29
  v_cvt_pk_bf16_f32 v111, v30, v31
  buffer_store_dwordx4 v[108:111], v96, s[48:51], s68 offen sc1
  s_waitcnt lgkmcnt(0)
  v_lshlrev_b32 v24, 16, v8
  v_and_b32 v25, s75, v8
  v_lshlrev_b32 v26, 16, v9
  v_and_b32 v27, s75, v9
  v_lshlrev_b32 v28, 16, v10
  v_and_b32 v29, s75, v10
  v_lshlrev_b32 v30, 16, v11
  v_and_b32 v31, s75, v11
  v_lshlrev_b32 v32, 16, v12
  v_and_b32 v33, s75, v12
  v_lshlrev_b32 v34, 16, v13
  v_and_b32 v35, s75, v13
  v_lshlrev_b32 v36, 16, v14
  v_and_b32 v37, s75, v14
  v_lshlrev_b32 v38, 16, v15
  v_and_b32 v39, s75, v15
  v_pk_fma_f32 v[24:25], v[24:25], v[32:33], v[80:81]
  v_pk_fma_f32 v[26:27], v[26:27], v[34:35], v[82:83]
  v_pk_fma_f32 v[28:29], v[28:29], v[36:37], v[84:85]
  v_pk_fma_f32 v[30:31], v[30:31], v[38:39], v[86:87]
  v_cvt_pk_bf16_f32 v112, v24, v25
  v_cvt_pk_bf16_f32 v113, v26, v27
  v_cvt_pk_bf16_f32 v114, v28, v29
  v_cvt_pk_bf16_f32 v115, v30, v31
  buffer_store_dwordx4 v[112:115], v97, s[48:51], s68 offen sc1
  s_branch L_kg_f_end
L_kg_helper:
  v_mov_b32 v24, 0
  v_mov_b32 v25, 0
  v_mov_b32 v26, 0
  v_mov_b32 v27, 0
  v_mov_b32 v28, 0
  v_mov_b32 v29, 0
  v_mov_b32 v30, 0
  v_mov_b32 v31, 0
  v_mov_b32 v32, 0
  v_mov_b32 v33, 0
  v_mov_b32 v34, 0
  v_mov_b32 v35, 0
  v_mov_b32 v36, 0
  v_mov_b32 v37, 0
  v_mov_b32 v38, 0
  v_mov_b32 v39, 0
  v_mov_b32 v40, 0
  v_mov_b32 v41, 0
  v_mov_b32 v42, 0
  v_mov_b32 v43, 0
  v_mov_b32 v44, 0
  v_mov_b32 v45, 0
  v_mov_b32 v46, 0
  v_mov_b32 v47, 0
  v_mfma_f32_32x32x16_bf16 v[64:79], v[24:27], v[24:27], 0
  v_mfma_f32_32x32x16_bf16 v[80:95], v[24:27], v[24:27], 0
  s_sub_u32 s58, s81, 1
  s_cmp_lt_u32 s58, 3
  s_cselect_b32 s58, 4, 3
  s_cmp_lt_u32 s56, s58
  s_cselect_b32 s66, 1, 0
  s_lshl_b32 s58, s56, 6
  s_add_u32 s58, s58, s67
  v_lshl_add_u32 v61, v60, 3, s58
  v_lshlrev_b32 v62, 6, v58
  v_xor_b32 v61, v61, v62
  v_lshl_add_u32 v52, v59, 8, v61
  v_add_u32 v52, 90112, v52
  s_cmp_eq_u32 s66, 0
  s_cbranch_scc1 L_kg_Az0
L_kg_Az1:
  s_waitcnt vmcnt(4) lgkmcnt(0)
  s_barrier
  s_add_u32 m0, s63, 55296
  s_nop 0
  buffer_load_dwordx4 v53, s[44:47], s61 offen lds
  buffer_load_dwordx4 v54, s[44:47], s61 offen offset:1024 lds
  s_add_u32 s61, s61, s69
  s_cmp_eq_u32 s61, s39
  s_cselect_b32 s61, 0, s61
  s_cmp_ge_u32 s65, 4
  s_cselect_b32 s46, 0, s46
  ds_read_b64_tr_b16 v[0:1], v52 offset:0
  ds_read_b64_tr_b16 v[2:3], v52 offset:1024
  ds_read_b128 v[4:7], v48 offset:0
  ds_read_b128 v[8:11], v48 offset:4096
  v_mfma_f32_32x32x16_bf16 v[64:79], v[24:27], v[28:31], v[64:79]
  ds_read_b64_tr_b16 v[12:13], v52 offset:4096
  ds_read_b64_tr_b16 v[14:15], v52 offset:5120
  v_mfma_f32_32x32x16_bf16 v[80:95], v[24:27], v[32:35], v[80:95]
  ds_read_b128 v[16:19], v49 offset:0
  ds_read_b128 v[20:23], v49 offset:4096
  v_mfma_f32_32x32x16_bf16 v[64:79], v[36:39], v[40:43], v[64:79]
  v_mfma_f32_32x32x16_bf16 v[80:95], v[36:39], v[44:47], v[80:95]
  s_waitcnt vmcnt(4) lgkmcnt(0)
  s_barrier
  s_add_u32 m0, s63, 0
  s_nop 0
  buffer_load_dwordx4 v53, s[44:47], s61 offen lds
  buffer_load_dwordx4 v54, s[44:47], s61 offen offset:1024 lds
  s_add_u32 s61, s61, s69
  ds_read_b64_tr_b16 v[24:25], v52 offset:18432
  ds_read_b64_tr_b16 v[26:27], v52 offset:19456
  ds_read_b128 v[28:31], v50 offset:0
  ds_read_b128 v[32:35], v50 offset:4096
  v_mfma_f32_32x32x16_bf16 v[64:79], v[0:3], v[4:7], v[64:79]
  ds_read_b64_tr_b16 v[36:37], v52 offset:22528
  ds_read_b64_tr_b16 v[38:39], v52 offset:23552
  v_mfma_f32_32x32x16_bf16 v[80:95], v[0:3], v[8:11], v[80:95]
  ds_read_b128 v[40:43], v51 offset:0
  ds_read_b128 v[44:47], v51 offset:4096
  v_mfma_f32_32x32x16_bf16 v[64:79], v[12:15], v[16:19], v[64:79]
  v_mfma_f32_32x32x16_bf16 v[80:95], v[12:15], v[20:23], v[80:95]
  s_waitcnt vmcnt(4) lgkmcnt(0)
  s_barrier
  s_add_u32 m0, s63, 18432
  s_nop 0
  buffer_load_dwordx4 v53, s[44:47], s61 offen lds
  buffer_load_dwordx4 v54, s[44:47], s61 offen offset:1024 lds
  s_add_u32 s61, s61, s69
  s_add_u32 s58, s65, s74
  s_cmp_eq_u32 s58, 4
  s_movk_i32 s58, 16384
  s_cselect_b32 s58, 4294901760, s58
  s_add_u32 s65, s65, 1
  ds_read_b64_tr_b16 v[0:1], v52 offset:36864
  ds_read_b64_tr_b16 v[2:3], v52 offset:37888
  ds_read_b128 v[4:7], v48 offset:8192
  ds_read_b128 v[8:11], v48 offset:12288
  v_mfma_f32_32x32x16_bf16 v[64:79], v[24:27], v[28:31], v[64:79]
  ds_read_b64_tr_b16 v[12:13], v52 offset:40960
  ds_read_b64_tr_b16 v[14:15], v52 offset:41984
  v_mfma_f32_32x32x16_bf16 v[80:95], v[24:27], v[32:35], v[80:95]
  ds_read_b128 v[16:19], v49 offset:8192
  ds_read_b128 v[20:23], v49 offset:12288
  v_mfma_f32_32x32x16_bf16 v[64:79], v[36:39], v[40:43], v[64:79]
  v_add_u32 v48, s58, v48
  v_add_u32 v49, s58, v49
  v_mfma_f32_32x32x16_bf16 v[80:95], v[36:39], v[44:47], v[80:95]
  s_waitcnt vmcnt(4) lgkmcnt(0)
  s_barrier
  s_add_u32 m0, s63, 36864
  s_nop 0
  buffer_load_dwordx4 v53, s[44:47], s61 offen lds
  buffer_load_dwordx4 v54, s[44:47], s61 offen offset:1024 lds
  s_add_u32 s61, s61, s69
  ds_read_b64_tr_b16 v[24:25], v52 offset:55296
  ds_read_b64_tr_b16 v[26:27], v52 offset:56320
  ds_read_b128 v[28:31], v50 offset:8192
  ds_read_b128 v[32:35], v50 offset:12288
  v_mfma_f32_32x32x16_bf16 v[64:79], v[0:3], v[4:7], v[64:79]
  ds_read_b64_tr_b16 v[36:37], v52 offset:59392
  ds_read_b64_tr_b16 v[38:39], v52 offset:60416
  v_mfma_f32_32x32x16_bf16 v[80:95], v[0:3], v[8:11], v[80:95]
  ds_read_b128 v[40:43], v51 offset:8192
  ds_read_b128 v[44:47], v51 offset:12288
  v_mfma_f32_32x32x16_bf16 v[64:79], v[12:15], v[16:19], v[64:79]
  v_add_u32 v50, s58, v50
  v_add_u32 v51, s58, v51
  s_cmp_lt_u32 s65, 5
  v_mfma_f32_32x32x16_bf16 v[80:95], v[12:15], v[20:23], v[80:95]
  s_cbranch_scc1 L_kg_Az1
  s_branch L_kg_Aze
L_kg_Az0:
  s_waitcnt vmcnt(4) lgkmcnt(0)
  s_barrier
  s_add_u32 m0, s63, 55296
  s_nop 0
  buffer_load_dwordx4 v53, s[44:47], s61 offen lds
  buffer_load_dwordx4 v54, s[44:47], s61 offen offset:1024 lds
  s_add_u32 s61, s61, s69
  s_cmp_eq_u32 s61, s39
  s_cselect_b32 s61, 0, s61
  s_cmp_ge_u32 s65, 4
  s_cselect_b32 s46, 0, s46
  s_waitcnt vmcnt(4) lgkmcnt(0)
  s_barrier
  s_add_u32 m0, s63, 0
  s_nop 0
  buffer_load_dwordx4 v53, s[44:47], s61 offen lds
  buffer_load_dwordx4 v54, s[44:47], s61 offen offset:1024 lds
  s_add_u32 s61, s61, s69
  s_waitcnt vmcnt(4) lgkmcnt(0)
  s_barrier
  s_add_u32 m0, s63, 18432
  s_nop 0
  buffer_load_dwordx4 v53, s[44:47], s61 offen lds
  buffer_load_dwordx4 v54, s[44:47], s61 offen offset:1024 lds
  s_add_u32 s61, s61, s69
  s_add_u32 s58, s65, s74
  s_cmp_eq_u32 s58, 4
  s_movk_i32 s58, 16384
  s_cselect_b32 s58, 4294901760, s58
  s_add_u32 s65, s65, 1
  s_waitcnt vmcnt(4) lgkmcnt(0)
  s_barrier
  s_add_u32 m0, s63, 36864
  s_nop 0
  buffer_load_dwordx4 v53, s[44:47], s61 offen lds
  buffer_load_dwordx4 v54, s[44:47], s61 offen offset:1024 lds
  s_add_u32 s61, s61, s69
  s_cmp_lt_u32 s65, 5
  s_cbranch_scc1 L_kg_Az0
L_kg_Aze:
  s_waitcnt vmcnt(0) lgkmcnt(0)
  s_barrier
  v_mfma_f32_32x32x16_bf16 v[64:79], v[24:27], v[28:31], v[64:79]
  v_mfma_f32_32x32x16_bf16 v[80:95], v[24:27], v[32:35], v[80:95]
  v_mfma_f32_32x32x16_bf16 v[64:79], v[36:39], v[40:43], v[64:79]
  v_mfma_f32_32x32x16_bf16 v[80:95], v[36:39], v[44:47], v[80:95]
  s_mov_b32 s52, s30
  s_and_b32 s53, s31, 0xffff
  s_mov_b32 s54, 256
  s_mov_b32 s55, 0x20000
  v_and_b32 v121, 3, v123
  v_bfe_u32 v122, v123, 2, 1
  v_lshl_add_u32 v121, v122, 5, v121
  v_lshlrev_b32 v117, 2, v121
  buffer_load_dword v116, v117, s[52:55], 0 offen offset:0 sc1
  s_mov_b32 s79, s70
  v_mov_b32 v62, 0xc0135761
  v_mov_b32 v34, 0xbdd2d3e8
  v_mov_b32 v32, 1.0
  v_pk_mul_f32 v[0:1], v[64:65], v[64:65]
  v_pk_mul_f32 v[2:3], v[66:67], v[66:67]
  v_pk_mul_f32 v[4:5], v[68:69], v[68:69]
  v_pk_mul_f32 v[6:7], v[70:71], v[70:71]
  v_pk_mul_f32 v[8:9], v[72:73], v[72:73]
  v_pk_mul_f32 v[10:11], v[74:75], v[74:75]
  v_pk_mul_f32 v[12:13], v[76:77], v[76:77]
  v_pk_mul_f32 v[14:15], v[78:79], v[78:79]
  v_pk_mul_f32 v[16:17], v[80:81], v[80:81]
  v_pk_mul_f32 v[18:19], v[82:83], v[82:83]
  v_pk_mul_f32 v[20:21], v[84:85], v[84:85]
  v_pk_mul_f32 v[22:23], v[86:87], v[86:87]
  v_pk_mul_f32 v[24:25], v[88:89], v[88:89]
  v_pk_mul_f32 v[26:27], v[90:91], v[90:91]
  v_pk_mul_f32 v[28:29], v[92:93], v[92:93]
  v_pk_mul_f32 v[30:31], v[94:95], v[94:95]
  v_pk_fma_f32 v[0:1], v[0:1], v[34:35], v[62:63] op_sel_hi:[1,0,0]
  v_pk_fma_f32 v[2:3], v[2:3], v[34:35], v[62:63] op_sel_hi:[1,0,0]
  v_pk_fma_f32 v[4:5], v[4:5], v[34:35], v[62:63] op_sel_hi:[1,0,0]
  v_pk_fma_f32 v[6:7], v[6:7], v[34:35], v[62:63] op_sel_hi:[1,0,0]
  v_pk_fma_f32 v[8:9], v[8:9], v[34:35], v[62:63] op_sel_hi:[1,0,0]
  v_pk_fma_f32 v[10:11], v[10:11], v[34:35], v[62:63] op_sel_hi:[1,0,0]
  v_pk_fma_f32 v[12:13], v[12:13], v[34:35], v[62:63] op_sel_hi:[1,0,0]
  v_pk_fma_f32 v[14:15], v[14:15], v[34:35], v[62:63] op_sel_hi:[1,0,0]
  v_pk_fma_f32 v[16:17], v[16:17], v[34:35], v[62:63] op_sel_hi:[1,0,0]
  v_pk_fma_f32 v[18:19], v[18:19], v[34:35], v[62:63] op_sel_hi:[1,0,0]
  v_pk_fma_f32 v[20:21], v[20:21], v[34:35], v[62:63] op_sel_hi:[1,0,0]
  v_pk_fma_f32 v[22:23], v[22:23], v[34:35], v[62:63] op_sel_hi:[1,0,0]
  v_pk_fma_f32 v[24:25], v[24:25], v[34:35], v[62:63] op_sel_hi:[1,0,0]
  v_pk_fma_f32 v[26:27], v[26:27], v[34:35], v[62:63] op_sel_hi:[1,0,0]
  v_pk_fma_f32 v[28:29], v[28:29], v[34:35], v[62:63] op_sel_hi:[1,0,0]
  v_pk_fma_f32 v[30:31], v[30:31], v[34:35], v[62:63] op_sel_hi:[1,0,0]
  v_pk_mul_f32 v[0:1], v[0:1], v[64:65]
  v_pk_mul_f32 v[2:3], v[2:3], v[66:67]
  v_pk_mul_f32 v[4:5], v[4:5], v[68:69]
  v_pk_mul_f32 v[6:7], v[6:7], v[70:71]
  v_pk_mul_f32 v[8:9], v[8:9], v[72:73]
  v_pk_mul_f32 v[10:11], v[10:11], v[74:75]
  v_pk_mul_f32 v[12:13], v[12:13], v[76:77]
  v_pk_mul_f32 v[14:15], v[14:15], v[78:79]
  v_pk_mul_f32 v[16:17], v[16:17], v[80:81]
  v_pk_mul_f32 v[18:19], v[18:19], v[82:83]
  v_pk_mul_f32 v[20:21], v[20:21], v[84:85]
  v_pk_mul_f32 v[22:23], v[22:23], v[86:87]
  v_pk_mul_f32 v[24:25], v[24:25], v[88:89]
  v_pk_mul_f32 v[26:27], v[26:27], v[90:91]
  v_pk_mul_f32 v[28:29], v[28:29], v[92:93]
  v_pk_mul_f32 v[30:31], v[30:31], v[94:95]
  v_exp_f32 v0, v0
  v_exp_f32 v1, v1
  v_exp_f32 v2, v2
  v_exp_f32 v3, v3
  v_exp_f32 v4, v4
  v_exp_f32 v5, v5
  v_exp_f32 v6, v6
  v_exp_f32 v7, v7
  v_exp_f32 v8, v8
  v_exp_f32 v9, v9
  v_exp_f32 v10, v10
  v_exp_f32 v11, v11
  v_exp_f32 v12, v12
  v_exp_f32 v13, v13
  v_exp_f32 v14, v14
  v_exp_f32 v15, v15
  v_exp_f32 v16, v16
  v_exp_f32 v17, v17
  v_exp_f32 v18, v18
  v_exp_f32 v19, v19
  v_exp_f32 v20, v20
  v_exp_f32 v21, v21
  v_exp_f32 v22, v22
  v_exp_f32 v23, v23
  v_exp_f32 v24, v24
  v_exp_f32 v25, v25
  v_exp_f32 v26, v26
  v_exp_f32 v27, v27
  v_exp_f32 v28, v28
  v_exp_f32 v29, v29
  v_exp_f32 v30, v30
  v_exp_f32 v31, v31
  v_pk_add_f32 v[0:1], v[0:1], v[32:33] op_sel_hi:[1,0]
  v_pk_add_f32 v[2:3], v[2:3], v[32:33] op_sel_hi:[1,0]
  v_pk_add_f32 v[4:5], v[4:5], v[32:33] op_sel_hi:[1,0]
  v_pk_add_f32 v[6:7], v[6:7], v[32:33] op_sel_hi:[1,0]
  v_pk_add_f32 v[8:9], v[8:9], v[32:33] op_sel_hi:[1,0]
  v_pk_add_f32 v[10:11], v[10:11], v[32:33] op_sel_hi:[1,0]
  v_pk_add_f32 v[12:13], v[12:13], v[32:33] op_sel_hi:[1,0]
  v_pk_add_f32 v[14:15], v[14:15], v[32:33] op_sel_hi:[1,0]
  v_pk_add_f32 v[16:17], v[16:17], v[32:33] op_sel_hi:[1,0]
  v_pk_add_f32 v[18:19], v[18:19], v[32:33] op_sel_hi:[1,0]
  v_pk_add_f32 v[20:21], v[20:21], v[32:33] op_sel_hi:[1,0]
  v_pk_add_f32 v[22:23], v[22:23], v[32:33] op_sel_hi:[1,0]
  v_pk_add_f32 v[24:25], v[24:25], v[32:33] op_sel_hi:[1,0]
  v_pk_add_f32 v[26:27], v[26:27], v[32:33] op_sel_hi:[1,0]
  v_pk_add_f32 v[28:29], v[28:29], v[32:33] op_sel_hi:[1,0]
  v_pk_add_f32 v[30:31], v[30:31], v[32:33] op_sel_hi:[1,0]
  v_rcp_f32 v0, v0
  v_rcp_f32 v1, v1
  v_rcp_f32 v2, v2
  v_rcp_f32 v3, v3
  v_rcp_f32 v4, v4
  v_rcp_f32 v5, v5
  v_rcp_f32 v6, v6
  v_rcp_f32 v7, v7
  v_rcp_f32 v8, v8
  v_rcp_f32 v9, v9
  v_rcp_f32 v10, v10
  v_rcp_f32 v11, v11
  v_rcp_f32 v12, v12
  v_rcp_f32 v13, v13
  v_rcp_f32 v14, v14
  v_rcp_f32 v15, v15
  v_rcp_f32 v16, v16
  v_rcp_f32 v17, v17
  v_rcp_f32 v18, v18
  v_rcp_f32 v19, v19
  v_rcp_f32 v20, v20
  v_rcp_f32 v21, v21
  v_rcp_f32 v22, v22
  v_rcp_f32 v23, v23
  v_rcp_f32 v24, v24
  v_rcp_f32 v25, v25
  v_rcp_f32 v26, v26
  v_rcp_f32 v27, v27
  v_rcp_f32 v28, v28
  v_rcp_f32 v29, v29
  v_rcp_f32 v30, v30
  v_rcp_f32 v31, v31
  v_pk_mul_f32 v[64:65], v[0:1], v[64:65]
  v_pk_mul_f32 v[66:67], v[2:3], v[66:67]
  v_pk_mul_f32 v[68:69], v[4:5], v[68:69]
  v_pk_mul_f32 v[70:71], v[6:7], v[70:71]
  v_pk_mul_f32 v[72:73], v[8:9], v[72:73]
  v_pk_mul_f32 v[74:75], v[10:11], v[74:75]
  v_pk_mul_f32 v[76:77], v[12:13], v[76:77]
  v_pk_mul_f32 v[78:79], v[14:15], v[78:79]
  v_pk_mul_f32 v[80:81], v[16:17], v[80:81]
  v_pk_mul_f32 v[82:83], v[18:19], v[82:83]
  v_pk_mul_f32 v[84:85], v[20:21], v[84:85]
  v_pk_mul_f32 v[86:87], v[22:23], v[86:87]
  v_pk_mul_f32 v[88:89], v[24:25], v[88:89]
  v_pk_mul_f32 v[90:91], v[26:27], v[90:91]
  v_pk_mul_f32 v[92:93], v[28:29], v[92:93]
  v_pk_mul_f32 v[94:95], v[30:31], v[94:95]
  v_pk_add_f32 v[4:5], v[64:65], v[66:67]
  v_pk_mul_f32 v[6:7], v[64:65], v[64:65]
  v_pk_add_f32 v[8:9], v[80:81], v[82:83]
  v_pk_mul_f32 v[10:11], v[80:81], v[80:81]
  v_pk_fma_f32 v[6:7], v[66:67], v[66:67], v[6:7]
  v_pk_fma_f32 v[10:11], v[82:83], v[82:83], v[10:11]
  v_pk_add_f32 v[4:5], v[4:5], v[68:69]
  v_pk_fma_f32 v[6:7], v[68:69], v[68:69], v[6:7]
  v_pk_add_f32 v[8:9], v[8:9], v[84:85]
  v_pk_fma_f32 v[10:11], v[84:85], v[84:85], v[10:11]
  v_pk_add_f32 v[4:5], v[4:5], v[70:71]
  v_pk_fma_f32 v[6:7], v[70:71], v[70:71], v[6:7]
  v_pk_add_f32 v[8:9], v[8:9], v[86:87]
  v_pk_fma_f32 v[10:11], v[86:87], v[86:87], v[10:11]
  v_pk_add_f32 v[4:5], v[4:5], v[72:73]
  v_pk_fma_f32 v[6:7], v[72:73], v[72:73], v[6:7]
  v_pk_add_f32 v[8:9], v[8:9], v[88:89]
  v_pk_fma_f32 v[10:11], v[88:89], v[88:89], v[10:11]
  v_pk_add_f32 v[4:5], v[4:5], v[74:75]
  v_pk_fma_f32 v[6:7], v[74:75], v[74:75], v[6:7]
  v_pk_add_f32 v[8:9], v[8:9], v[90:91]
  v_pk_fma_f32 v[10:11], v[90:91], v[90:91], v[10:11]
  v_pk_add_f32 v[4:5], v[4:5], v[76:77]
  v_pk_fma_f32 v[6:7], v[76:77], v[76:77], v[6:7]
  v_pk_add_f32 v[8:9], v[8:9], v[92:93]
  v_pk_fma_f32 v[10:11], v[92:93], v[92:93], v[10:11]
  v_pk_add_f32 v[4:5], v[4:5], v[78:79]
  v_pk_fma_f32 v[6:7], v[78:79], v[78:79], v[6:7]
  v_pk_add_f32 v[8:9], v[8:9], v[94:95]
  v_pk_fma_f32 v[10:11], v[94:95], v[94:95], v[10:11]
  v_add_f32 v0, v4, v5
  v_add_f32 v1, v6, v7
  v_add_f32 v2, v8, v9
  v_add_f32 v3, v10, v11
  s_nop 0
  v_permlane32_swap_b32 v0, v2
  v_permlane32_swap_b32 v1, v3
  v_add_f32 v0, v0, v2
  v_add_f32 v1, v1, v3
  s_lshl_b32 s58, s34, 3
  s_add_u32 s58, s58, s35
  s_lshl_b32 s58, s58, 2
  s_add_u32 s58, s58, s56
  s_lshl_b32 s58, s58, 9
  s_add_u32 s58, s58, 6881280
  v_lshlrev_b32 v118, 3, v123
  buffer_store_dwordx2 v[0:1], v118, s[40:43], s58 offen sc1
  s_mov_b32 s78, s66
  s_cmp_lt_u32 s56, s38
  s_cselect_b32 s66, 1, 0
  s_lshl_b32 s58, s37, 6
  s_and_b32 s58, s58, 64
  s_lshl_b32 s59, s56, 6
  s_add_u32 s58, s58, s59
  v_lshl_add_u32 v61, v60, 3, s58
  v_lshlrev_b32 v62, 6, v58
  v_xor_b32 v61, v61, v62
  v_lshl_add_u32 v52, v59, 8, v61
  v_add_u32 v52, 81920, v52
  s_movk_i32 s63, 16384
  s_lshl_b32 s69, s34, 2
  s_add_u32 s69, s69, s56
  s_lshl_b32 s69, s69, 12
  s_add_u32 s69, s69, 6881280
  s_cmp_eq_u32 s66, 0
  s_cbranch_scc1 L_kg_B_idle
  s_waitcnt lgkmcnt(0)
  s_barrier
  ds_read_b64_tr_b16 a[0:1], v52 offset:0
  ds_read_b64_tr_b16 a[2:3], v52 offset:1024
  ds_read_b128 a[4:7], v48 offset:0
  ds_read_b128 a[8:11], v48 offset:4096
  ds_read_b64_tr_b16 a[12:13], v52 offset:4096
  ds_read_b64_tr_b16 a[14:15], v52 offset:5120
  ds_read_b128 a[16:19], v49 offset:0
  ds_read_b128 a[20:23], v49 offset:4096
  ds_read_b64_tr_b16 a[24:25], v52 offset:8192
  ds_read_b64_tr_b16 a[26:27], v52 offset:9216
  ds_read_b128 a[28:31], v50 offset:0
  ds_read_b128 a[32:35], v50 offset:4096
  ds_read_b64_tr_b16 a[36:37], v52 offset:12288
  ds_read_b64_tr_b16 a[38:39], v52 offset:13312
  ds_read_b128 a[40:43], v51 offset:0
  ds_read_b128 a[44:47], v51 offset:4096
  v_cvt_pk_bf16_f32 v96, v64, v65
  v_cvt_pk_bf16_f32 v97, v66, v67
  v_cvt_pk_bf16_f32 v98, v68, v69
  v_cvt_pk_bf16_f32 v99, v70, v71
  v_cvt_pk_bf16_f32 v100, v72, v73
  v_cvt_pk_bf16_f32 v101, v74, v75
  v_cvt_pk_bf16_f32 v102, v76, v77
  v_cvt_pk_bf16_f32 v103, v78, v79
  v_cvt_pk_bf16_f32 v104, v80, v81
  v_cvt_pk_bf16_f32 v105, v82, v83
  v_cvt_pk_bf16_f32 v106, v84, v85
  v_cvt_pk_bf16_f32 v107, v86, v87
  v_cvt_pk_bf16_f32 v108, v88, v89
  v_cvt_pk_bf16_f32 v109, v90, v91
  v_cvt_pk_bf16_f32 v110, v92, v93
  v_cvt_pk_bf16_f32 v111, v94, v95
  s_waitcnt lgkmcnt(0)
  s_barrier
  v_mfma_f32_32x32x16_bf16 v[64:79], a[0:3], a[4:7], 0
  ds_read_b64_tr_b16 a[48:49], v52 offset:18432
  ds_read_b64_tr_b16 a[50:51], v52 offset:19456
  ds_read_b128 a[52:55], v48 offset:8192
  v_mfma_f32_32x32x16_bf16 v[80:95], a[0:3], a[8:11], 0
  ds_read_b128 a[56:59], v48 offset:12288
  ds_read_b64_tr_b16 a[60:61], v52 offset:22528
  ds_read_b64_tr_b16 a[62:63], v52 offset:23552
  v_mfma_f32_32x32x16_bf16 v[64:79], a[12:15], a[16:19], v[64:79]
  ds_read_b128 a[64:67], v49 offset:8192
  ds_read_b128 a[68:71], v49 offset:12288
  ds_read_b64_tr_b16 a[72:73], v52 offset:26624
  v_mfma_f32_32x32x16_bf16 v[80:95], a[12:15], a[20:23], v[80:95]
  ds_read_b64_tr_b16 a[74:75], v52 offset:27648
  ds_read_b128 a[76:79], v50 offset:8192
  ds_read_b128 a[80:83], v50 offset:12288
  v_mfma_f32_32x32x16_bf16 v[64:79], a[24:27], a[28:31], v[64:79]
  ds_read_b64_tr_b16 a[84:85], v52 offset:30720
  ds_read_b64_tr_b16 a[86:87], v52 offset:31744
  ds_read_b128 a[88:91], v51 offset:8192
  v_mfma_f32_32x32x16_bf16 v[80:95], a[24:27], a[32:35], v[80:95]
  ds_read_b128 a[92:95], v51 offset:12288
  s_cmp_eq_u32 s74, 4
  s_cselect_b32 s59, 4294901760, s63
  v_mfma_f32_32x32x16_bf16 v[64:79], a[36:39], a[40:43], v[64:79]
  v_add_u32 v48, s59, v48
  v_add_u32 v49, s59, v49
  v_add_u32 v50, s59, v50
  v_add_u32 v51, s59, v51
  v_mfma_f32_32x32x16_bf16 v[80:95], a[36:39], a[44:47], v[80:95]
  s_waitcnt lgkmcnt(0)
  s_barrier
  v_mfma_f32_32x32x16_bf16 v[64:79], a[48:51], a[52:55], v[64:79]
  ds_read_b64_tr_b16 a[0:1], v52 offset:36864
  ds_read_b64_tr_b16 a[2:3], v52 offset:37888
  ds_read_b128 a[4:7], v48 offset:0
  v_mfma_f32_32x32x16_bf16 v[80:95], a[48:51], a[56:59], v[80:95]
  ds_read_b128 a[8:11], v48 offset:4096
  ds_read_b64_tr_b16 a[12:13], v52 offset:40960
  ds_read_b64_tr_b16 a[14:15], v52 offset:41984
  v_mfma_f32_32x32x16_bf16 v[64:79], a[60:63], a[64:67], v[64:79]
  ds_read_b128 a[16:19], v49 offset:0
  ds_read_b128 a[20:23], v49 offset:4096
  ds_read_b64_tr_b16 a[24:25], v52 offset:45056
  v_mfma_f32_32x32x16_bf16 v[80:95], a[60:63], a[68:71], v[80:95]
  ds_read_b64_tr_b16 a[26:27], v52 offset:46080
  ds_read_b128 a[28:31], v50 offset:0
  ds_read_b128 a[32:35], v50 offset:4096
  v_mfma_f32_32x32x16_bf16 v[64:79], a[72:75], a[76:79], v[64:79]
  ds_read_b64_tr_b16 a[36:37], v52 offset:49152
  ds_read_b64_tr_b16 a[38:39], v52 offset:50176
  ds_read_b128 a[40:43], v51 offset:0
  v_mfma_f32_32x32x16_bf16 v[80:95], a[72:75], a[80:83], v[80:95]
  ds_read_b128 a[44:47], v51 offset:4096
  v_mfma_f32_32x32x16_bf16 v[64:79], a[84:87], a[88:91], v[64:79]
  v_mfma_f32_32x32x16_bf16 v[80:95], a[84:87], a[92:95], v[80:95]
  s_mov_b32 s80, 0x200000
  L_kg_d_12:
  s_waitcnt vmcnt(0)
  v_cmp_gt_u32 vcc, 32, v116
  s_nop 4
  s_cbranch_vccz L_kg_d_12_d
  s_sleep 3
  buffer_load_dword v116, v117, s[52:55], 0 offen offset:0 sc1
  s_sub_u32 s80, s80, 1
  s_cbranch_scc0 L_kg_d_12
  L_kg_d_12_d:
  s_waitcnt lgkmcnt(0)
  s_barrier
  v_mfma_f32_32x32x16_bf16 v[64:79], a[0:3], a[4:7], v[64:79]
  ds_read_b64_tr_b16 a[48:49], v52 offset:0
  ds_read_b64_tr_b16 a[50:51], v52 offset:1024
  ds_read_b128 a[52:55], v48 offset:8192
  v_mfma_f32_32x32x16_bf16 v[80:95], a[0:3], a[8:11], v[80:95]
  ds_read_b128 a[56:59], v48 offset:12288
  ds_read_b64_tr_b16 a[60:61], v52 offset:4096
  ds_read_b64_tr_b16 a[62:63], v52 offset:5120
  v_mfma_f32_32x32x16_bf16 v[64:79], a[12:15], a[16:19], v[64:79]
  ds_read_b128 a[64:67], v49 offset:8192
  ds_read_b128 a[68:71], v49 offset:12288
  ds_read_b64_tr_b16 a[72:73], v52 offset:8192
  v_mfma_f32_32x32x16_bf16 v[80:95], a[12:15], a[20:23], v[80:95]
  ds_read_b64_tr_b16 a[74:75], v52 offset:9216
  ds_read_b128 a[76:79], v50 offset:8192
  ds_read_b128 a[80:83], v50 offset:12288
  v_mfma_f32_32x32x16_bf16 v[64:79], a[24:27], a[28:31], v[64:79]
  ds_read_b64_tr_b16 a[84:85], v52 offset:12288
  ds_read_b64_tr_b16 a[86:87], v52 offset:13312
  ds_read_b128 a[88:91], v51 offset:8192
  v_mfma_f32_32x32x16_bf16 v[80:95], a[24:27], a[32:35], v[80:95]
  ds_read_b128 a[92:95], v51 offset:12288
  s_cmp_eq_u32 s74, 3
  s_cselect_b32 s59, 4294901760, s63
  v_mfma_f32_32x32x16_bf16 v[64:79], a[36:39], a[40:43], v[64:79]
  v_add_u32 v48, s59, v48
  v_add_u32 v49, s59, v49
  v_add_u32 v50, s59, v50
  v_add_u32 v51, s59, v51
  v_mfma_f32_32x32x16_bf16 v[80:95], a[36:39], a[44:47], v[80:95]
  s_waitcnt lgkmcnt(0)
  s_barrier
  v_mfma_f32_32x32x16_bf16 v[64:79], a[48:51], a[52:55], v[64:79]
  ds_read_b64_tr_b16 a[0:1], v52 offset:18432
  ds_read_b64_tr_b16 a[2:3], v52 offset:19456
  ds_read_b128 a[4:7], v48 offset:0
  v_mfma_f32_32x32x16_bf16 v[80:95], a[48:51], a[56:59], v[80:95]
  ds_read_b128 a[8:11], v48 offset:4096
  ds_read_b64_tr_b16 a[12:13], v52 offset:22528
  ds_read_b64_tr_b16 a[14:15], v52 offset:23552
  v_mfma_f32_32x32x16_bf16 v[64:79], a[60:63], a[64:67], v[64:79]
  ds_read_b128 a[16:19], v49 offset:0
  ds_read_b128 a[20:23], v49 offset:4096
  ds_read_b64_tr_b16 a[24:25], v52 offset:26624
  v_mfma_f32_32x32x16_bf16 v[80:95], a[60:63], a[68:71], v[80:95]
  ds_read_b64_tr_b16 a[26:27], v52 offset:27648
  ds_read_b128 a[28:31], v50 offset:0
  ds_read_b128 a[32:35], v50 offset:4096
  v_mfma_f32_32x32x16_bf16 v[64:79], a[72:75], a[76:79], v[64:79]
  ds_read_b64_tr_b16 a[36:37], v52 offset:30720
  ds_read_b64_tr_b16 a[38:39], v52 offset:31744
  ds_read_b128 a[40:43], v51 offset:0
  v_mfma_f32_32x32x16_bf16 v[80:95], a[72:75], a[80:83], v[80:95]
  ds_read_b128 a[44:47], v51 offset:4096
  v_mfma_f32_32x32x16_bf16 v[64:79], a[84:87], a[88:91], v[64:79]
  v_mfma_f32_32x32x16_bf16 v[80:95], a[84:87], a[92:95], v[80:95]
  s_waitcnt lgkmcnt(0)
  s_barrier
  v_mfma_f32_32x32x16_bf16 v[64:79], a[0:3], a[4:7], v[64:79]
  ds_read_b64_tr_b16 a[48:49], v52 offset:36864
  ds_read_b64_tr_b16 a[50:51], v52 offset:37888
  ds_read_b128 a[52:55], v48 offset:8192
  v_mfma_f32_32x32x16_bf16 v[80:95], a[0:3], a[8:11], v[80:95]
  ds_read_b128 a[56:59], v48 offset:12288
  ds_read_b64_tr_b16 a[60:61], v52 offset:40960
  ds_read_b64_tr_b16 a[62:63], v52 offset:41984
  v_mfma_f32_32x32x16_bf16 v[64:79], a[12:15], a[16:19], v[64:79]
  ds_read_b128 a[64:67], v49 offset:8192
  ds_read_b128 a[68:71], v49 offset:12288
  ds_read_b64_tr_b16 a[72:73], v52 offset:45056
  v_mfma_f32_32x32x16_bf16 v[80:95], a[12:15], a[20:23], v[80:95]
  ds_read_b64_tr_b16 a[74:75], v52 offset:46080
  ds_read_b128 a[76:79], v50 offset:8192
  ds_read_b128 a[80:83], v50 offset:12288
  v_mfma_f32_32x32x16_bf16 v[64:79], a[24:27], a[28:31], v[64:79]
  ds_read_b64_tr_b16 a[84:85], v52 offset:49152
  ds_read_b64_tr_b16 a[86:87], v52 offset:50176
  ds_read_b128 a[88:91], v51 offset:8192
  v_mfma_f32_32x32x16_bf16 v[80:95], a[24:27], a[32:35], v[80:95]
  ds_read_b128 a[92:95], v51 offset:12288
  s_cmp_eq_u32 s74, 2
  s_cselect_b32 s59, 4294901760, s63
  v_mfma_f32_32x32x16_bf16 v[64:79], a[36:39], a[40:43], v[64:79]
  v_add_u32 v48, s59, v48
  v_add_u32 v49, s59, v49
  v_add_u32 v50, s59, v50
  v_add_u32 v51, s59, v51
  v_mfma_f32_32x32x16_bf16 v[80:95], a[36:39], a[44:47], v[80:95]
  s_waitcnt lgkmcnt(0)
  s_barrier
  v_mfma_f32_32x32x16_bf16 v[64:79], a[48:51], a[52:55], v[64:79]
  ds_read_b64_tr_b16 a[0:1], v52 offset:0
  ds_read_b64_tr_b16 a[2:3], v52 offset:1024
  ds_read_b128 a[4:7], v48 offset:0
  v_mfma_f32_32x32x16_bf16 v[80:95], a[48:51], a[56:59], v[80:95]
  ds_read_b128 a[8:11], v48 offset:4096
  ds_read_b64_tr_b16 a[12:13], v52 offset:4096
  ds_read_b64_tr_b16 a[14:15], v52 offset:5120
  v_mfma_f32_32x32x16_bf16 v[64:79], a[60:63], a[64:67], v[64:79]
  ds_read_b128 a[16:19], v49 offset:0
  ds_read_b128 a[20:23], v49 offset:4096
  ds_read_b64_tr_b16 a[24:25], v52 offset:8192
  v_mfma_f32_32x32x16_bf16 v[80:95], a[60:63], a[68:71], v[80:95]
  ds_read_b64_tr_b16 a[26:27], v52 offset:9216
  ds_read_b128 a[28:31], v50 offset:0
  ds_read_b128 a[32:35], v50 offset:4096
  v_mfma_f32_32x32x16_bf16 v[64:79], a[72:75], a[76:79], v[64:79]
  ds_read_b64_tr_b16 a[36:37], v52 offset:12288
  ds_read_b64_tr_b16 a[38:39], v52 offset:13312
  ds_read_b128 a[40:43], v51 offset:0
  v_mfma_f32_32x32x16_bf16 v[80:95], a[72:75], a[80:83], v[80:95]
  ds_read_b128 a[44:47], v51 offset:4096
  v_mfma_f32_32x32x16_bf16 v[64:79], a[84:87], a[88:91], v[64:79]
  v_mfma_f32_32x32x16_bf16 v[80:95], a[84:87], a[92:95], v[80:95]
  s_waitcnt lgkmcnt(0)
  s_barrier
  v_mfma_f32_32x32x16_bf16 v[64:79], a[0:3], a[4:7], v[64:79]
  ds_read_b64_tr_b16 a[48:49], v52 offset:18432
  ds_read_b64_tr_b16 a[50:51], v52 offset:19456
  ds_read_b128 a[52:55], v48 offset:8192
  v_mfma_f32_32x32x16_bf16 v[80:95], a[0:3], a[8:11], v[80:95]
  ds_read_b128 a[56:59], v48 offset:12288
  ds_read_b64_tr_b16 a[60:61], v52 offset:22528
  ds_read_b64_tr_b16 a[62:63], v52 offset:23552
  v_mfma_f32_32x32x16_bf16 v[64:79], a[12:15], a[16:19], v[64:79]
  ds_read_b128 a[64:67], v49 offset:8192
  ds_read_b128 a[68:71], v49 offset:12288
  ds_read_b64_tr_b16 a[72:73], v52 offset:26624
  v_mfma_f32_32x32x16_bf16 v[80:95], a[12:15], a[20:23], v[80:95]
  ds_read_b64_tr_b16 a[74:75], v52 offset:27648
  ds_read_b128 a[76:79], v50 offset:8192
  ds_read_b128 a[80:83], v50 offset:12288
  v_mfma_f32_32x32x16_bf16 v[64:79], a[24:27], a[28:31], v[64:79]
  ds_read_b64_tr_b16 a[84:85], v52 offset:30720
  ds_read_b64_tr_b16 a[86:87], v52 offset:31744
  ds_read_b128 a[88:91], v51 offset:8192
  v_mfma_f32_32x32x16_bf16 v[80:95], a[24:27], a[32:35], v[80:95]
  ds_read_b128 a[92:95], v51 offset:12288
  s_cmp_eq_u32 s74, 1
  s_cselect_b32 s59, 4294901760, s63
  v_mfma_f32_32x32x16_bf16 v[64:79], a[36:39], a[40:43], v[64:79]
  v_add_u32 v48, s59, v48
  v_add_u32 v49, s59, v49
  v_add_u32 v50, s59, v50
  v_add_u32 v51, s59, v51
  v_mfma_f32_32x32x16_bf16 v[80:95], a[36:39], a[44:47], v[80:95]
  buffer_load_dwordx2 v[32:33], v118, s[40:43], s69 offen offset:0 sc1
  buffer_load_dwordx2 v[34:35], v118, s[40:43], s69 offen offset:512 sc1
  buffer_load_dwordx2 v[36:37], v118, s[40:43], s69 offen offset:1024 sc1
  buffer_load_dwordx2 v[38:39], v118, s[40:43], s69 offen offset:1536 sc1
  buffer_load_dwordx2 v[40:41], v118, s[40:43], s69 offen offset:2048 sc1
  buffer_load_dwordx2 v[42:43], v118, s[40:43], s69 offen offset:2560 sc1
  buffer_load_dwordx2 v[44:45], v118, s[40:43], s69 offen offset:3072 sc1
  buffer_load_dwordx2 v[46:47], v118, s[40:43], s69 offen offset:3584 sc1
  s_waitcnt lgkmcnt(0)
  s_barrier
  v_mfma_f32_32x32x16_bf16 v[64:79], a[48:51], a[52:55], v[64:79]
  ds_read_b64_tr_b16 a[0:1], v52 offset:36864
  ds_read_b64_tr_b16 a[2:3], v52 offset:37888
  ds_read_b128 a[4:7], v48 offset:0
  v_mfma_f32_32x32x16_bf16 v[80:95], a[48:51], a[56:59], v[80:95]
  ds_read_b128 a[8:11], v48 offset:4096
  ds_read_b64_tr_b16 a[12:13], v52 offset:40960
  ds_read_b64_tr_b16 a[14:15], v52 offset:41984
  v_mfma_f32_32x32x16_bf16 v[64:79], a[60:63], a[64:67], v[64:79]
  ds_read_b128 a[16:19], v49 offset:0
  ds_read_b128 a[20:23], v49 offset:4096
  ds_read_b64_tr_b16 a[24:25], v52 offset:45056
  v_mfma_f32_32x32x16_bf16 v[80:95], a[60:63], a[68:71], v[80:95]
  ds_read_b64_tr_b16 a[26:27], v52 offset:46080
  ds_read_b128 a[28:31], v50 offset:0
  ds_read_b128 a[32:35], v50 offset:4096
  v_mfma_f32_32x32x16_bf16 v[64:79], a[72:75], a[76:79], v[64:79]
  ds_read_b64_tr_b16 a[36:37], v52 offset:49152
  ds_read_b64_tr_b16 a[38:39], v52 offset:50176
  ds_read_b128 a[40:43], v51 offset:0
  v_mfma_f32_32x32x16_bf16 v[80:95], a[72:75], a[80:83], v[80:95]
  ds_read_b128 a[44:47], v51 offset:4096
  v_mfma_f32_32x32x16_bf16 v[64:79], a[84:87], a[88:91], v[64:79]
  v_mfma_f32_32x32x16_bf16 v[80:95], a[84:87], a[92:95], v[80:95]
  s_waitcnt lgkmcnt(0)
  s_barrier
  v_mfma_f32_32x32x16_bf16 v[64:79], a[0:3], a[4:7], v[64:79]
  ds_read_b64_tr_b16 a[48:49], v52 offset:0
  ds_read_b64_tr_b16 a[50:51], v52 offset:1024
  ds_read_b128 a[52:55], v48 offset:8192
  v_mfma_f32_32x32x16_bf16 v[80:95], a[0:3], a[8:11], v[80:95]
  ds_read_b128 a[56:59], v48 offset:12288
  ds_read_b64_tr_b16 a[60:61], v52 offset:4096
  ds_read_b64_tr_b16 a[62:63], v52 offset:5120
  v_mfma_f32_32x32x16_bf16 v[64:79], a[12:15], a[16:19], v[64:79]
  ds_read_b128 a[64:67], v49 offset:8192
  ds_read_b128 a[68:71], v49 offset:12288
  ds_read_b64_tr_b16 a[72:73], v52 offset:8192
  v_mfma_f32_32x32x16_bf16 v[80:95], a[12:15], a[20:23], v[80:95]
  ds_read_b64_tr_b16 a[74:75], v52 offset:9216
  ds_read_b128 a[76:79], v50 offset:8192
  ds_read_b128 a[80:83], v50 offset:12288
  v_mfma_f32_32x32x16_bf16 v[64:79], a[24:27], a[28:31], v[64:79]
  ds_read_b64_tr_b16 a[84:85], v52 offset:12288
  ds_read_b64_tr_b16 a[86:87], v52 offset:13312
  ds_read_b128 a[88:91], v51 offset:8192
  v_mfma_f32_32x32x16_bf16 v[80:95], a[24:27], a[32:35], v[80:95]
  ds_read_b128 a[92:95], v51 offset:12288
  v_mfma_f32_32x32x16_bf16 v[64:79], a[36:39], a[40:43], v[64:79]
  v_mfma_f32_32x32x16_bf16 v[80:95], a[36:39], a[44:47], v[80:95]
  s_branch L_kg_B_end
L_kg_B_idle:
  v_cvt_pk_bf16_f32 v96, v64, v65
  v_cvt_pk_bf16_f32 v97, v66, v67
  v_cvt_pk_bf16_f32 v98, v68, v69
  v_cvt_pk_bf16_f32 v99, v70, v71
  v_cvt_pk_bf16_f32 v100, v72, v73
  v_cvt_pk_bf16_f32 v101, v74, v75
  v_cvt_pk_bf16_f32 v102, v76, v77
  v_cvt_pk_bf16_f32 v103, v78, v79
  v_cvt_pk_bf16_f32 v104, v80, v81
  v_cvt_pk_bf16_f32 v105, v82, v83
  v_cvt_pk_bf16_f32 v106, v84, v85
  v_cvt_pk_bf16_f32 v107, v86, v87
  v_cvt_pk_bf16_f32 v108, v88, v89
  v_cvt_pk_bf16_f32 v109, v90, v91
  v_cvt_pk_bf16_f32 v110, v92, v93
  v_cvt_pk_bf16_f32 v111, v94, v95
  s_barrier
  s_barrier
  s_barrier
  s_mov_b32 s80, 0x200000
  L_kg_d_13:
  s_waitcnt vmcnt(0)
  v_cmp_gt_u32 vcc, 32, v116
  s_nop 4
  s_cbranch_vccz L_kg_d_13_d
  s_sleep 3
  buffer_load_dword v116, v117, s[52:55], 0 offen offset:0 sc1
  s_sub_u32 s80, s80, 1
  s_cbranch_scc0 L_kg_d_13
  L_kg_d_13_d:
  s_barrier
  s_barrier
  s_barrier
  s_barrier
  s_barrier
  buffer_load_dwordx2 v[32:33], v118, s[40:43], s69 offen offset:0 sc1
  buffer_load_dwordx2 v[34:35], v118, s[40:43], s69 offen offset:512 sc1
  buffer_load_dwordx2 v[36:37], v118, s[40:43], s69 offen offset:1024 sc1
  buffer_load_dwordx2 v[38:39], v118, s[40:43], s69 offen offset:1536 sc1
  buffer_load_dwordx2 v[40:41], v118, s[40:43], s69 offen offset:2048 sc1
  buffer_load_dwordx2 v[42:43], v118, s[40:43], s69 offen offset:2560 sc1
  buffer_load_dwordx2 v[44:45], v118, s[40:43], s69 offen offset:3072 sc1
  buffer_load_dwordx2 v[46:47], v118, s[40:43], s69 offen offset:3584 sc1
  s_barrier
  s_barrier
  L_kg_B_end:
  s_waitcnt lgkmcnt(0)
  s_barrier
  s_setprio 3
  s_lshl_b32 s58, s56, 9
  s_add_u32 s58, s58, 157696
  v_add_u32 v5, s58, v118
  v_add_u32 v6, 157696, v118
  s_mov_b32 s80, 0x200000
  L_kg_B_chk:
  s_waitcnt vmcnt(0)
  v_max_u32 v8, v33, v35
  v_max3_u32 v8, v8, v37, v39
  v_max3_u32 v8, v8, v41, v43
  v_max3_u32 v8, v8, v45, v47
  v_cmp_eq_u32 vcc, -1, v8
  s_nop 4
  s_cbranch_vccz L_kg_B_ok
  buffer_load_dwordx2 v[32:33], v118, s[40:43], s69 offen offset:0 sc1
  buffer_load_dwordx2 v[34:35], v118, s[40:43], s69 offen offset:512 sc1
  buffer_load_dwordx2 v[36:37], v118, s[40:43], s69 offen offset:1024 sc1
  buffer_load_dwordx2 v[38:39], v118, s[40:43], s69 offen offset:1536 sc1
  buffer_load_dwordx2 v[40:41], v118, s[40:43], s69 offen offset:2048 sc1
  buffer_load_dwordx2 v[42:43], v118, s[40:43], s69 offen offset:2560 sc1
  buffer_load_dwordx2 v[44:45], v118, s[40:43], s69 offen offset:3072 sc1
  buffer_load_dwordx2 v[46:47], v118, s[40:43], s69 offen offset:3584 sc1
  s_sub_u32 s80, s80, 1
  s_cbranch_scc0 L_kg_B_chk
  L_kg_B_ok:
  v_add_f32 v32, v32, v34
  v_add_f32 v33, v33, v35
  v_add_f32 v32, v32, v36
  v_add_f32 v33, v33, v37
  v_add_f32 v32, v32, v38
  v_add_f32 v33, v33, v39
  v_add_f32 v32, v32, v40
  v_add_f32 v33, v33, v41
  v_add_f32 v32, v32, v42
  v_add_f32 v33, v33, v43
  v_add_f32 v32, v32, v44
  v_add_f32 v33, v33, v45
  v_add_f32 v32, v32, v46
  v_add_f32 v33, v33, v47
  ds_write_b64 v5, v[32:33]
  s_mov_b64 exec, 1
  v_mov_b32 v121, 1
  ds_add_u32 v120, v121 offset:0
  s_mov_b64 exec, -1
  v_mfma_f32_32x32x16_bf16 v[64:79], a[48:51], a[52:55], v[64:79]
  v_mfma_f32_32x32x16_bf16 v[80:95], a[48:51], a[56:59], v[80:95]
  v_mfma_f32_32x32x16_bf16 v[64:79], a[60:63], a[64:67], v[64:79]
  v_mfma_f32_32x32x16_bf16 v[80:95], a[60:63], a[68:71], v[80:95]
  v_mfma_f32_32x32x16_bf16 v[64:79], a[72:75], a[76:79], v[64:79]
  v_mfma_f32_32x32x16_bf16 v[80:95], a[72:75], a[80:83], v[80:95]
  v_mfma_f32_32x32x16_bf16 v[64:79], a[84:87], a[88:91], v[64:79]
  v_mfma_f32_32x32x16_bf16 v[80:95], a[84:87], a[92:95], v[80:95]
  s_mov_b32 s80, 0x8000000
L_kg_w_14:
  ds_read_b32 v122, v120 offset:0
  s_waitcnt lgkmcnt(0)
  v_readfirstlane_b32 s58, v122
  s_nop 0
  s_cmp_ge_u32 s58, 4
  s_cbranch_scc1 L_kg_w_14_d
  s_sleep 1
  s_sub_u32 s80, s80, 1
  s_cbranch_scc0 L_kg_w_14
L_kg_w_14_d:
  ds_read_b64 v[32:33], v6 offset:0
  ds_read_b64 v[34:35], v6 offset:512
  ds_read_b64 v[36:37], v6 offset:1024
  ds_read_b64 v[38:39], v6 offset:1536
  s_add_u32 s48, s32, 10420224
  s_addc_u32 s49, s33, 0
  s_and_b32 s49, s49, 0xffff
  s_mov_b32 s50, 3538944
  s_mov_b32 s51, 0x20000
  s_setprio 3
  s_lshl_b32 s65, s56, 14
  v_mov_b32 v0, v123
  v_and_b32 v115, 31, v0
  v_lshrrev_b32 v114, 5, v0
  s_add_u32 s57, s65, 8192
  v_mul_u32_u24 v7, 72, v115
  v_lshl_add_u32 v7, v114, 3, v7
  v_add_u32 v7, s57, v7
  v_bfe_u32 v8, v0, 2, 2
  v_lshl_add_u32 v8, v114, 3, v8
  v_mul_u32_u24 v8, 72, v8
  v_bfe_u32 v9, v0, 4, 1
  v_lshl_add_u32 v8, v9, 5, v8
  v_and_b32 v9, 3, v0
  v_lshl_add_u32 v8, v9, 3, v8
  v_add_u32 v8, s57, v8
  v_lshlrev_b32 v116, 4, v0
  s_mov_b32 s57, 0x3a97b426
  s_waitcnt lgkmcnt(0)
  v_add_f32 v32, v32, v34
  v_add_f32 v33, v33, v35
  v_add_f32 v36, v36, v38
  v_add_f32 v37, v37, v39
  v_add_f32 v32, v32, v36
  v_add_f32 v33, v33, v37
  v_mul_f32 v32, s57, v32
  v_mul_f32 v33, s57, v33
  v_fma_f32 v33, -v32, v32, v33
  v_max_f32 v33, 0, v33
  v_add_f32 v33, 0x3727c5ac, v33
  v_rsq_f32 v34, v33
  s_cmp_eq_u32 s78, 0
  v_mul_f32 v35, -v32, v34
  v_mov_b32 v36, v34
  v_mov_b32 v37, v35
  s_cbranch_scc1 L_kg_h_nonorm
  v_permlane32_swap_b32 v34, v36
  v_permlane32_swap_b32 v35, v37
  v_mov_b32 v38, v35
  v_mov_b32 v40, v37
  v_lshlrev_b32 v48, 16, v96
  v_and_b32 v49, s75, v96
  v_lshlrev_b32 v50, 16, v97
  v_and_b32 v51, s75, v97
  v_lshlrev_b32 v52, 16, v98
  v_and_b32 v53, s75, v98
  v_lshlrev_b32 v54, 16, v99
  v_and_b32 v55, s75, v99
  v_lshlrev_b32 v56, 16, v100
  v_and_b32 v57, s75, v100
  v_lshlrev_b32 v58, 16, v101
  v_and_b32 v59, s75, v101
  v_lshlrev_b32 v60, 16, v102
  v_and_b32 v61, s75, v102
  v_lshlrev_b32 v62, 16, v103
  v_and_b32 v63, s75, v103
  v_pk_fma_f32 v[48:49], v[48:49], v[34:35], v[38:39] op_sel_hi:[1,0,0]
  v_pk_fma_f32 v[50:51], v[50:51], v[34:35], v[38:39] op_sel_hi:[1,0,0]
  v_pk_fma_f32 v[52:53], v[52:53], v[34:35], v[38:39] op_sel_hi:[1,0,0]
  v_pk_fma_f32 v[54:55], v[54:55], v[34:35], v[38:39] op_sel_hi:[1,0,0]
  v_pk_fma_f32 v[56:57], v[56:57], v[34:35], v[38:39] op_sel_hi:[1,0,0]
  v_pk_fma_f32 v[58:59], v[58:59], v[34:35], v[38:39] op_sel_hi:[1,0,0]
  v_pk_fma_f32 v[60:61], v[60:61], v[34:35], v[38:39] op_sel_hi:[1,0,0]
  v_pk_fma_f32 v[62:63], v[62:63], v[34:35], v[38:39] op_sel_hi:[1,0,0]
  v_cvt_pk_bf16_f32 v16, v48, v49
  v_cvt_pk_bf16_f32 v17, v50, v51
  v_cvt_pk_bf16_f32 v18, v52, v53
  v_cvt_pk_bf16_f32 v19, v54, v55
  v_cvt_pk_bf16_f32 v20, v56, v57
  v_cvt_pk_bf16_f32 v21, v58, v59
  v_cvt_pk_bf16_f32 v22, v60, v61
  v_cvt_pk_bf16_f32 v23, v62, v63
  ds_write_b64 v7, v[16:17] offset:0
  ds_write_b64 v7, v[18:19] offset:16
  ds_write_b64 v7, v[20:21] offset:32
  ds_write_b64 v7, v[22:23] offset:48
  v_lshlrev_b32 v48, 16, v104
  v_and_b32 v49, s75, v104
  v_lshlrev_b32 v50, 16, v105
  v_and_b32 v51, s75, v105
  v_lshlrev_b32 v52, 16, v106
  v_and_b32 v53, s75, v106
  v_lshlrev_b32 v54, 16, v107
  v_and_b32 v55, s75, v107
  v_lshlrev_b32 v56, 16, v108
  v_and_b32 v57, s75, v108
  v_lshlrev_b32 v58, 16, v109
  v_and_b32 v59, s75, v109
  v_lshlrev_b32 v60, 16, v110
  v_and_b32 v61, s75, v110
  v_lshlrev_b32 v62, 16, v111
  v_and_b32 v63, s75, v111
  v_pk_fma_f32 v[48:49], v[48:49], v[36:37], v[40:41] op_sel_hi:[1,0,0]
  v_pk_fma_f32 v[50:51], v[50:51], v[36:37], v[40:41] op_sel_hi:[1,0,0]
  v_pk_fma_f32 v[52:53], v[52:53], v[36:37], v[40:41] op_sel_hi:[1,0,0]
  v_pk_fma_f32 v[54:55], v[54:55], v[36:37], v[40:41] op_sel_hi:[1,0,0]
  v_pk_fma_f32 v[56:57], v[56:57], v[36:37], v[40:41] op_sel_hi:[1,0,0]
  v_pk_fma_f32 v[58:59], v[58:59], v[36:37], v[40:41] op_sel_hi:[1,0,0]
  v_pk_fma_f32 v[60:61], v[60:61], v[36:37], v[40:41] op_sel_hi:[1,0,0]
  v_pk_fma_f32 v[62:63], v[62:63], v[36:37], v[40:41] op_sel_hi:[1,0,0]
  v_cvt_pk_bf16_f32 v24, v48, v49
  v_cvt_pk_bf16_f32 v25, v50, v51
  v_cvt_pk_bf16_f32 v26, v52, v53
  v_cvt_pk_bf16_f32 v27, v54, v55
  v_cvt_pk_bf16_f32 v28, v56, v57
  v_cvt_pk_bf16_f32 v29, v58, v59
  v_cvt_pk_bf16_f32 v30, v60, v61
  v_cvt_pk_bf16_f32 v31, v62, v63
  ds_write_b64 v7, v[24:25] offset:2304
  ds_write_b64 v7, v[26:27] offset:2320
  ds_write_b64 v7, v[28:29] offset:2336
  ds_write_b64 v7, v[30:31] offset:2352
  s_mul_i32 s57, s34, 108
  s_add_u32 s57, s57, s79
  s_add_u32 s57, s57, s56
  s_lshl_b32 s57, s57, 10
  s_waitcnt lgkmcnt(0)
  ds_read_b64_tr_b16 v[48:49], v8 offset:0
  ds_read_b64_tr_b16 v[50:51], v8 offset:288
  ds_read_b64_tr_b16 v[52:53], v8 offset:1152
  ds_read_b64_tr_b16 v[54:55], v8 offset:1440
  ds_read_b64_tr_b16 v[56:57], v8 offset:2304
  ds_read_b64_tr_b16 v[58:59], v8 offset:2592
  ds_read_b64_tr_b16 v[60:61], v8 offset:3456
  ds_read_b64_tr_b16 v[62:63], v8 offset:3744
  s_waitcnt lgkmcnt(6)
  buffer_store_dwordx4 v[48:51], v116, s[48:51], s57 offen sc1
  s_add_u32 s57, s57, 27648
  s_waitcnt lgkmcnt(4)
  buffer_store_dwordx4 v[52:55], v116, s[48:51], s57 offen sc1
  s_add_u32 s57, s57, 27648
  s_waitcnt lgkmcnt(2)
  buffer_store_dwordx4 v[56:59], v116, s[48:51], s57 offen sc1
  s_add_u32 s57, s57, 27648
  s_waitcnt lgkmcnt(0)
  buffer_store_dwordx4 v[60:63], v116, s[48:51], s57 offen sc1
L_kg_h_nonorm:
  v_lshrrev_b32 v2, 3, v0
  v_and_b32 v3, 7, v0
  v_lshrrev_b32 v4, 4, v0
  v_xor_b32 v4, v4, v3
  v_lshlrev_b32 v4, 4, v4
  v_lshl_add_u32 v48, v2, 12, v4
  v_xor_b32 v4, 64, v48
  v_add_u32 v49, 31744, v4
  v_add_u32 v50, 63488, v48
  v_add_u32 v51, 95232, v4
  v_add_u32 v52, 131072, v48
  v_add_u32 v53, 131072, v49
  v_add_u32 v54, 131072, v50
  v_add_u32 v55, 131072, v51
  v_bfe_u32 v4, v0, 1, 3
  v_xor_b32 v4, v4, v114
  v_lshlrev_b32 v4, 4, v4
  v_lshl_add_u32 v4, v115, 7, v4
  v_add_u32 v56, s65, v4
  v_xor_b32 v57, 32, v56
  v_xor_b32 v58, 64, v56
  v_xor_b32 v59, 96, v56
  s_lshl_b32 s57, s34, 18
  s_add_u32 s44, s22, s57
  s_addc_u32 s45, s23, 0
  s_and_b32 s45, s45, 0xffff
  s_mov_b32 s46, 262144
  s_mov_b32 s47, 0x20000
  s_lshl_b32 s74, s81, 10
  s_add_u32 s74, s74, 22142208
  s_lshr_b32 s57, s34, 3
  s_lshl_b32 s57, s57, 13
  s_add_u32 s74, s74, s57
  s_and_b32 s57, s34, 7
  s_lshl_b32 s57, s57, 2
  s_add_u32 s74, s74, s57
  s_add_u32 s74, s74, 32
  s_lshl_b32 s78, s34, 3
  s_add_u32 s78, s78, s35
  s_lshl_b32 s78, s78, 10
  s_add_u32 s78, s78, 22143232
  s_lshl_b32 s61, s56, 10
  s_waitcnt vmcnt(0)
  s_mov_b64 exec, 1
  v_mov_b32 v121, 1
  ds_add_rtn_u32 v122, v120, v121 offset:4
  s_mov_b64 exec, -1
  s_waitcnt lgkmcnt(0)
  v_readfirstlane_b32 s57, v122
  s_nop 0
  s_cmp_eq_u32 s57, 3
  s_cbranch_scc0 L_kg_p_15
  v_bfe_u32 v122, v0, 3, 1
  v_xor_b32 v122, 1, v122
  v_and_b32 v121, 7, v0
  v_lshlrev_b32 v121, 15, v121
  v_mul_u32_u24 v122, 992, v122
  v_add_u32 v121, v122, v121
  v_mov_b32 v122, 1
  s_sub_u32 s57, s81, 1
  s_cmp_lt_u32 s57, 3
  s_movk_i32 s57, 0xff
  s_cselect_b32 exec_lo, 0xffff, s57
  s_mov_b32 exec_hi, 0
  buffer_store_dword v122, v121, s[40:43], s74 offen sc1
  s_mov_b64 exec, -1
L_kg_p_15:
  s_lshl_b32 s66, s2, 2
  s_add_u32 s66, s66, s56
  s_min_u32 s57, s66, 939
  s_mul_i32 s63, s57, 6554
  s_lshr_b32 s63, s63, 16
  s_mul_i32 s67, s63, 10
  s_sub_u32 s67, s57, s67
  s_sub_u32 s57, s63, 40
  s_cmp_lt_u32 s63, 40
  s_cselect_b32 s57, s63, s57
  s_cselect_b32 s52, s16, s26
  s_cselect_b32 s53, s17, s27
  s_mov_b32 s54, 1105920
  s_cselect_b32 s54, 819200, s54
  s_and_b32 s53, s53, 0xffff
  s_mov_b32 s55, 0x20000
  s_lshl_b32 s57, s57, 4
  s_mul_i32 s74, s63, 205
  s_lshr_b32 s74, s74, 10
  s_mul_i32 s75, s74, 5
  s_sub_u32 s75, s63, s75
  s_lshl_b32 s58, s75, 2
  s_add_u32 s58, s58, s57
  s_mul_i32 s74, s74, 80
  s_add_u32 s74, s74, 16
  s_cmp_eq_u32 s75, 4
  s_cselect_b32 s58, s74, s58
  s_cselect_b32 s75, 36, 0
  s_cselect_b32 s74, 20, 8
  s_cmp_lt_u32 s63, 40
  s_cselect_b32 s57, s58, s57
  s_cselect_b32 s75, s75, 0
  s_cselect_b32 s74, s74, 8
  s_mul_i32 s57, s57, 1280
  s_lshl_b32 s58, s67, 7
  s_add_u32 s57, s57, s58
  s_mul_i32 s74, s74, 1280
  s_sub_u32 s74, s74, 1024
  v_bfe_u32 v2, v0, 4, 1
  v_lshlrev_b32 v2, 2, v2
  v_and_b32 v3, 7, v0
  v_xor_b32 v2, v2, v3
  v_lshrrev_b32 v3, 3, v0
  v_mad_u32_u24 v3, v114, s75, v3
  v_mul_u32_u24 v3, 1280, v3
  v_lshl_add_u32 v2, v2, 4, v3
  v_add_u32 v3, s74, v2
  s_add_u32 m0, s65, 14336
  s_nop 0
  buffer_load_dwordx4 v2, s[52:55], s57 offen lds
  buffer_load_dwordx4 v3, s[52:55], s57 offen offset:1024 lds
  v_lshlrev_b32 v2, 1, v115
  s_lshl_b32 s74, s34, 7
  s_mov_b32 s52, s24
  s_and_b32 s53, s25, 0xffff
  s_mov_b32 s54, 4096
  s_mov_b32 s55, 0x20000
  buffer_load_ushort v112, v2, s[52:55], s74 offen
  buffer_load_ushort v113, v2, s[52:55], s74 offen offset:64
  s_mov_b32 s62, 0
  s_and_b32 s74, s34, 3
  s_lshl_b32 s74, s74, 1
  s_add_u32 s74, s74, s35
  s_and_b32 s74, s74, 0
  s_mov_b32 s70, s61
  s_add_u32 s71, s61, 1024
  s_lshl_b32 s75, s74, 7
  s_add_u32 s61, s61, s75
  s_mov_b32 s72, s65
  s_add_u32 s73, s65, 16384
  s_add_u32 m0, s72, 0
  s_nop 0
  buffer_load_dwordx4 v48, s[44:47], s61 offen offset:0 lds
  buffer_load_dwordx4 v49, s[44:47], s61 offen offset:1024 lds
  buffer_load_dwordx4 v50, s[44:47], s61 offen offset:2048 lds
  buffer_load_dwordx4 v51, s[44:47], s61 offen offset:3072 lds
  s_add_u32 m0, s72, 4096
  s_nop 0
  buffer_load_dwordx4 v52, s[44:47], s61 offen offset:0 lds
  buffer_load_dwordx4 v53, s[44:47], s61 offen offset:1024 lds
  buffer_load_dwordx4 v54, s[44:47], s61 offen offset:2048 lds
  buffer_load_dwordx4 v55, s[44:47], s61 offen offset:3072 lds
  s_add_u32 s61, s61, 128
  s_xor_b32 s72, s72, 8192
  s_setprio 3
  v_mov_b32 v62, 0xc0135761
  v_mov_b32 v34, 0xbdd2d3e8
  v_mov_b32 v32, 1.0
  v_pk_mul_f32 v[0:1], v[64:65], v[64:65]
  v_pk_mul_f32 v[2:3], v[66:67], v[66:67]
  v_pk_mul_f32 v[4:5], v[68:69], v[68:69]
  v_pk_mul_f32 v[6:7], v[70:71], v[70:71]
  v_pk_mul_f32 v[8:9], v[72:73], v[72:73]
  v_pk_mul_f32 v[10:11], v[74:75], v[74:75]
  v_pk_mul_f32 v[12:13], v[76:77], v[76:77]
  v_pk_mul_f32 v[14:15], v[78:79], v[78:79]
  v_pk_mul_f32 v[16:17], v[80:81], v[80:81]
  v_pk_mul_f32 v[18:19], v[82:83], v[82:83]
  v_pk_mul_f32 v[20:21], v[84:85], v[84:85]
  v_pk_mul_f32 v[22:23], v[86:87], v[86:87]
  v_pk_mul_f32 v[24:25], v[88:89], v[88:89]
  v_pk_mul_f32 v[26:27], v[90:91], v[90:91]
  v_pk_mul_f32 v[28:29], v[92:93], v[92:93]
  v_pk_mul_f32 v[30:31], v[94:95], v[94:95]
  v_pk_fma_f32 v[0:1], v[0:1], v[34:35], v[62:63] op_sel_hi:[1,0,0]
  v_pk_fma_f32 v[2:3], v[2:3], v[34:35], v[62:63] op_sel_hi:[1,0,0]
  v_pk_fma_f32 v[4:5], v[4:5], v[34:35], v[62:63] op_sel_hi:[1,0,0]
  v_pk_fma_f32 v[6:7], v[6:7], v[34:35], v[62:63] op_sel_hi:[1,0,0]
  v_pk_fma_f32 v[8:9], v[8:9], v[34:35], v[62:63] op_sel_hi:[1,0,0]
  v_pk_fma_f32 v[10:11], v[10:11], v[34:35], v[62:63] op_sel_hi:[1,0,0]
  v_pk_fma_f32 v[12:13], v[12:13], v[34:35], v[62:63] op_sel_hi:[1,0,0]
  v_pk_fma_f32 v[14:15], v[14:15], v[34:35], v[62:63] op_sel_hi:[1,0,0]
  v_pk_fma_f32 v[16:17], v[16:17], v[34:35], v[62:63] op_sel_hi:[1,0,0]
  v_pk_fma_f32 v[18:19], v[18:19], v[34:35], v[62:63] op_sel_hi:[1,0,0]
  v_pk_fma_f32 v[20:21], v[20:21], v[34:35], v[62:63] op_sel_hi:[1,0,0]
  v_pk_fma_f32 v[22:23], v[22:23], v[34:35], v[62:63] op_sel_hi:[1,0,0]
  v_pk_fma_f32 v[24:25], v[24:25], v[34:35], v[62:63] op_sel_hi:[1,0,0]
  v_pk_fma_f32 v[26:27], v[26:27], v[34:35], v[62:63] op_sel_hi:[1,0,0]
  v_pk_fma_f32 v[28:29], v[28:29], v[34:35], v[62:63] op_sel_hi:[1,0,0]
  v_pk_fma_f32 v[30:31], v[30:31], v[34:35], v[62:63] op_sel_hi:[1,0,0]
  v_pk_mul_f32 v[0:1], v[0:1], v[64:65]
  v_pk_mul_f32 v[2:3], v[2:3], v[66:67]
  v_pk_mul_f32 v[4:5], v[4:5], v[68:69]
  v_pk_mul_f32 v[6:7], v[6:7], v[70:71]
  v_pk_mul_f32 v[8:9], v[8:9], v[72:73]
  v_pk_mul_f32 v[10:11], v[10:11], v[74:75]
  v_pk_mul_f32 v[12:13], v[12:13], v[76:77]
  v_pk_mul_f32 v[14:15], v[14:15], v[78:79]
  v_pk_mul_f32 v[16:17], v[16:17], v[80:81]
  v_pk_mul_f32 v[18:19], v[18:19], v[82:83]
  v_pk_mul_f32 v[20:21], v[20:21], v[84:85]
  v_pk_mul_f32 v[22:23], v[22:23], v[86:87]
  v_pk_mul_f32 v[24:25], v[24:25], v[88:89]
  v_pk_mul_f32 v[26:27], v[26:27], v[90:91]
  v_pk_mul_f32 v[28:29], v[28:29], v[92:93]
  v_pk_mul_f32 v[30:31], v[30:31], v[94:95]
  v_exp_f32 v0, v0
  v_exp_f32 v1, v1
  v_exp_f32 v2, v2
  v_exp_f32 v3, v3
  v_exp_f32 v4, v4
  v_exp_f32 v5, v5
  v_exp_f32 v6, v6
  v_exp_f32 v7, v7
  v_exp_f32 v8, v8
  v_exp_f32 v9, v9
  v_exp_f32 v10, v10
  v_exp_f32 v11, v11
  v_exp_f32 v12, v12
  v_exp_f32 v13, v13
  v_exp_f32 v14, v14
  v_exp_f32 v15, v15
  v_exp_f32 v16, v16
  v_exp_f32 v17, v17
  v_exp_f32 v18, v18
  v_exp_f32 v19, v19
  v_exp_f32 v20, v20
  v_exp_f32 v21, v21
  v_exp_f32 v22, v22
  v_exp_f32 v23, v23
  v_exp_f32 v24, v24
  v_exp_f32 v25, v25
  v_exp_f32 v26, v26
  v_exp_f32 v27, v27
  v_exp_f32 v28, v28
  v_exp_f32 v29, v29
  v_exp_f32 v30, v30
  v_exp_f32 v31, v31
  v_pk_add_f32 v[0:1], v[0:1], v[32:33] op_sel_hi:[1,0]
  v_pk_add_f32 v[2:3], v[2:3], v[32:33] op_sel_hi:[1,0]
  v_pk_add_f32 v[4:5], v[4:5], v[32:33] op_sel_hi:[1,0]
  v_pk_add_f32 v[6:7], v[6:7], v[32:33] op_sel_hi:[1,0]
  v_pk_add_f32 v[8:9], v[8:9], v[32:33] op_sel_hi:[1,0]
  v_pk_add_f32 v[10:11], v[10:11], v[32:33] op_sel_hi:[1,0]
  v_pk_add_f32 v[12:13], v[12:13], v[32:33] op_sel_hi:[1,0]
  v_pk_add_f32 v[14:15], v[14:15], v[32:33] op_sel_hi:[1,0]
  v_pk_add_f32 v[16:17], v[16:17], v[32:33] op_sel_hi:[1,0]
  v_pk_add_f32 v[18:19], v[18:19], v[32:33] op_sel_hi:[1,0]
  v_pk_add_f32 v[20:21], v[20:21], v[32:33] op_sel_hi:[1,0]
  v_pk_add_f32 v[22:23], v[22:23], v[32:33] op_sel_hi:[1,0]
  v_pk_add_f32 v[24:25], v[24:25], v[32:33] op_sel_hi:[1,0]
  v_pk_add_f32 v[26:27], v[26:27], v[32:33] op_sel_hi:[1,0]
  v_pk_add_f32 v[28:29], v[28:29], v[32:33] op_sel_hi:[1,0]
  v_pk_add_f32 v[30:31], v[30:31], v[32:33] op_sel_hi:[1,0]
  v_rcp_f32 v0, v0
  v_rcp_f32 v1, v1
  v_rcp_f32 v2, v2
  v_rcp_f32 v3, v3
  v_rcp_f32 v4, v4
  v_rcp_f32 v5, v5
  v_rcp_f32 v6, v6
  v_rcp_f32 v7, v7
  v_rcp_f32 v8, v8
  v_rcp_f32 v9, v9
  v_rcp_f32 v10, v10
  v_rcp_f32 v11, v11
  v_rcp_f32 v12, v12
  v_rcp_f32 v13, v13
  v_rcp_f32 v14, v14
  v_rcp_f32 v15, v15
  v_rcp_f32 v16, v16
  v_rcp_f32 v17, v17
  v_rcp_f32 v18, v18
  v_rcp_f32 v19, v19
  v_rcp_f32 v20, v20
  v_rcp_f32 v21, v21
  v_rcp_f32 v22, v22
  v_rcp_f32 v23, v23
  v_rcp_f32 v24, v24
  v_rcp_f32 v25, v25
  v_rcp_f32 v26, v26
  v_rcp_f32 v27, v27
  v_rcp_f32 v28, v28
  v_rcp_f32 v29, v29
  v_rcp_f32 v30, v30
  v_rcp_f32 v31, v31
  v_pk_mul_f32 v[64:65], v[0:1], v[64:65]
  v_pk_mul_f32 v[66:67], v[2:3], v[66:67]
  v_pk_mul_f32 v[68:69], v[4:5], v[68:69]
  v_pk_mul_f32 v[70:71], v[6:7], v[70:71]
  v_pk_mul_f32 v[72:73], v[8:9], v[72:73]
  v_pk_mul_f32 v[74:75], v[10:11], v[74:75]
  v_pk_mul_f32 v[76:77], v[12:13], v[76:77]
  v_pk_mul_f32 v[78:79], v[14:15], v[78:79]
  v_pk_mul_f32 v[80:81], v[16:17], v[80:81]
  v_pk_mul_f32 v[82:83], v[18:19], v[82:83]
  v_pk_mul_f32 v[84:85], v[20:21], v[84:85]
  v_pk_mul_f32 v[86:87], v[22:23], v[86:87]
  v_pk_mul_f32 v[88:89], v[24:25], v[88:89]
  v_pk_mul_f32 v[90:91], v[26:27], v[90:91]
  v_pk_mul_f32 v[92:93], v[28:29], v[92:93]
  v_pk_mul_f32 v[94:95], v[30:31], v[94:95]
  v_cvt_pk_bf16_f32 v96, v64, v65
  v_cvt_pk_bf16_f32 v97, v66, v67
  v_cvt_pk_bf16_f32 v98, v68, v69
  v_cvt_pk_bf16_f32 v99, v70, v71
  v_cvt_pk_bf16_f32 v100, v72, v73
  v_cvt_pk_bf16_f32 v101, v74, v75
  v_cvt_pk_bf16_f32 v102, v76, v77
  v_cvt_pk_bf16_f32 v103, v78, v79
  v_cvt_pk_bf16_f32 v104, v80, v81
  v_cvt_pk_bf16_f32 v105, v82, v83
  v_cvt_pk_bf16_f32 v106, v84, v85
  v_cvt_pk_bf16_f32 v107, v86, v87
  v_cvt_pk_bf16_f32 v108, v88, v89
  v_cvt_pk_bf16_f32 v109, v90, v91
  v_cvt_pk_bf16_f32 v110, v92, v93
  v_cvt_pk_bf16_f32 v111, v94, v95
  v_mov_b32 v12, 0
  v_mov_b32 v13, 0
  v_mov_b32 v14, 0
  v_mov_b32 v15, 0
  s_nop 1
  v_mfma_f32_32x32x16_bf16 a[0:15], v[12:15], v[12:15], 0
  v_mfma_f32_32x32x16_bf16 a[16:31], v[12:15], v[12:15], 0
  v_mfma_f32_32x32x16_bf16 a[32:47], v[12:15], v[12:15], 0
  v_mfma_f32_32x32x16_bf16 a[48:63], v[12:15], v[12:15], 0
  v_mfma_f32_32x32x16_bf16 a[64:79], v[12:15], v[12:15], 0
  v_mfma_f32_32x32x16_bf16 a[80:95], v[12:15], v[12:15], 0
  v_mfma_f32_32x32x16_bf16 a[96:111], v[12:15], v[12:15], 0
  v_mfma_f32_32x32x16_bf16 a[112:127], v[12:15], v[12:15], 0
  v_mov_b32 v0, v123
  s_waitcnt vmcnt(8)
  v_lshlrev_b32 v112, 16, v112
  v_lshlrev_b32 v113, 16, v113
  s_cmp_ge_u32 s66, 940
  s_cbranch_scc1 L_kg_h_notr
  v_bfe_u32 v5, v0, 2, 2
  v_lshl_add_u32 v4, v114, 2, v5
  v_lshlrev_b32 v4, 7, v4
  v_bfe_u32 v5, v0, 4, 1
  v_lshl_add_u32 v4, v5, 5, v4
  v_and_b32 v5, 3, v0
  v_lshl_add_u32 v4, v5, 3, v4
  v_bfe_u32 v5, v0, 3, 1
  v_lshl_add_u32 v4, v5, 6, v4
  s_add_u32 s58, s65, 14336
  v_add_u32 v4, s58, v4
  v_xor_b32 v5, 64, v4
  ds_read_b64_tr_b16 v[32:33], v4
  ds_read_b64_tr_b16 v[34:35], v4 offset:1024
  ds_read_b64_tr_b16 v[36:37], v5
  ds_read_b64_tr_b16 v[38:39], v5 offset:1024
  s_mul_i32 s57, s67, 188
  s_add_u32 s57, s57, s63
  s_lshl_b32 s57, s57, 10
  s_add_u32 s57, s57, 20119552
  s_add_u32 s58, s57, 96256
  s_waitcnt lgkmcnt(2)
  buffer_store_dwordx4 v[32:35], v116, s[40:43], s57 offen sc1
  s_waitcnt lgkmcnt(0)
  buffer_store_dwordx4 v[36:39], v116, s[40:43], s58 offen sc1
  L_kg_h_notr:
  s_add_u32 s66, s37, s56
  s_mul_i32 s68, s56, 864
  s_add_u32 s68, s68, s37
  s_lshl_b32 s68, s68, 10
  s_add_u32 s69, s68, 884736
  s_mul_i32 s75, s74, 110592
  s_add_u32 s60, s68, s75
  s_cmp_lt_u32 s35, 3
  s_cselect_b32 s64, 15, 7
  v_and_b32 v60, s64, v0
  v_lshlrev_b32 v60, 2, v60
  s_and_b32 s59, s34, 3
  s_sub_u32 s59, s59, s56
  s_lshl_b32 s59, s59, 13
  s_sub_u32 s59, s78, s59
  s_mov_b32 s80, 0x200000
  L_kg_g_16:
  buffer_load_dword v122, v60, s[40:43], s59 offen sc1
  s_waitcnt vmcnt(0)
  v_cmp_gt_u32 vcc, 1, v122
  s_nop 4
  s_cbranch_vccz L_kg_g_16_d
  s_sleep 1
  s_sub_u32 s80, s80, 1
  s_cbranch_scc0 L_kg_g_16
  L_kg_g_16_d:
  s_mov_b64 exec, 1
  v_mov_b32 v121, 1
  ds_add_rtn_u32 v122, v120, v121 offset:44
  s_mov_b64 exec, -1
  s_waitcnt lgkmcnt(0)
  v_readfirstlane_b32 s57, v122
  s_nop 0
  s_cmp_eq_u32 s57, 3
  s_cbranch_scc0 L_kg_p_17
  s_mov_b32 s52, s30
  s_and_b32 s53, s31, 0xffff
  s_mov_b32 s54, 256
  s_mov_b32 s55, 0x20000
  s_and_b32 s57, s2, 3
  s_bfe_u32 s58, s2, 0x10002
  s_lshl_b32 s58, s58, 5
  s_add_u32 s57, s57, s58
  s_lshl_b32 s57, s57, 2
  s_mov_b64 exec, 1
  v_mov_b32 v121, 0
  v_mov_b32 v122, 1
  buffer_atomic_add v122, v121, s[52:55], s57 offen offset:32 sc1
  s_mov_b64 exec, -1
L_kg_p_17:
  s_setprio 0
  s_and_b32 s59, s34, 7
  s_lshl_b32 s59, s59, 2
  s_add_u32 s59, s59, s56
  s_lshl_b32 s59, s59, 11
  s_mul_i32 s57, s76, 96256
  s_add_u32 s57, s57, 20119552
  s_add_u32 s59, s59, s57
  s_mul_i32 s63, s77, 96256
  s_add_u32 s63, s63, s57
  v_lshlrev_b32 v92, 7, v0
  v_mov_b32 v80, v48
  v_mov_b32 v81, v49
  v_mov_b32 v82, v50
  v_mov_b32 v83, v51
  v_mov_b32 v84, v52
  v_mov_b32 v85, v53
  v_mov_b32 v86, v54
  v_mov_b32 v87, v55
  v_mov_b32 v88, v56
  v_mov_b32 v89, v57
  v_mov_b32 v90, v58
  v_mov_b32 v91, v59
  s_cmp_eq_u32 s38, 3
  s_cbranch_scc1 L_kg_h_main3
L_kg_h_main4:
  buffer_load_dwordx4 v[0:3], v116, s[48:51], s60 offen offset:0 sc1
  buffer_load_dwordx4 v[4:7], v116, s[48:51], s60 offen offset:1024 sc1
  buffer_load_dwordx4 v[8:11], v116, s[48:51], s60 offen offset:2048 sc1
  buffer_load_dwordx4 v[12:15], v116, s[48:51], s60 offen offset:3072 sc1
  s_add_u32 s60, s60, 27648
  buffer_load_dwordx4 v[16:19], v116, s[48:51], s60 offen offset:0 sc1
  buffer_load_dwordx4 v[20:23], v116, s[48:51], s60 offen offset:1024 sc1
  buffer_load_dwordx4 v[24:27], v116, s[48:51], s60 offen offset:2048 sc1
  buffer_load_dwordx4 v[28:31], v116, s[48:51], s60 offen offset:3072 sc1
  s_add_u32 s60, s60, 27648
  buffer_load_dwordx4 v[32:35], v116, s[48:51], s60 offen offset:0 sc1
  buffer_load_dwordx4 v[36:39], v116, s[48:51], s60 offen offset:1024 sc1
  buffer_load_dwordx4 v[40:43], v116, s[48:51], s60 offen offset:2048 sc1
  buffer_load_dwordx4 v[44:47], v116, s[48:51], s60 offen offset:3072 sc1
  s_add_u32 s60, s60, 27648
  s_add_u32 m0, s72, 0
  s_nop 0
  buffer_load_dwordx4 v80, s[44:47], s61 offen offset:0 lds
  buffer_load_dwordx4 v81, s[44:47], s61 offen offset:1024 lds
  buffer_load_dwordx4 v82, s[44:47], s61 offen offset:2048 lds
  buffer_load_dwordx4 v83, s[44:47], s61 offen offset:3072 lds
  ds_read_b128 v[64:67], v88 offset:0
  ds_read_b128 v[68:71], v88 offset:4096
  v_xor_b32 v88, 8192, v88
L_kg_h_loop4:
  s_cmp_ge_u32 s62, 2
  s_cbranch_scc1 L_kg_h_tw4
L_kg_h_twr4:
  s_waitcnt vmcnt(12) lgkmcnt(0)
  v_mfma_f32_32x32x16_bf16 a[0:15], v[0:3], v[64:67], a[0:15]
  ds_read_b128 v[72:75], v89 offset:0
  ds_read_b128 v[76:79], v89 offset:4096
  v_mfma_f32_32x32x16_bf16 a[16:31], v[0:3], v[68:71], a[16:31]
  v_xor_b32 v89, 8192, v89
  buffer_load_dwordx4 v[48:51], v116, s[48:51], s60 offen offset:0 sc1
  v_mfma_f32_32x32x16_bf16 a[32:47], v[4:7], v[64:67], a[32:47]
  buffer_load_dwordx4 v[52:55], v116, s[48:51], s60 offen offset:1024 sc1
  buffer_load_dwordx4 v[56:59], v116, s[48:51], s60 offen offset:2048 sc1
  v_mfma_f32_32x32x16_bf16 a[48:63], v[4:7], v[68:71], a[48:63]
  buffer_load_dwordx4 v[60:63], v116, s[48:51], s60 offen offset:3072 sc1
  s_add_u32 s60, s60, 27648
  v_mfma_f32_32x32x16_bf16 a[64:79], v[8:11], v[64:67], a[64:79]
  s_add_u32 m0, s72, 4096
  s_nop 0
  buffer_load_dwordx4 v84, s[44:47], s61 offen offset:0 lds
  v_mfma_f32_32x32x16_bf16 a[80:95], v[8:11], v[68:71], a[80:95]
  buffer_load_dwordx4 v85, s[44:47], s61 offen offset:1024 lds
  buffer_load_dwordx4 v86, s[44:47], s61 offen offset:2048 lds
  v_mfma_f32_32x32x16_bf16 a[96:111], v[12:15], v[64:67], a[96:111]
  buffer_load_dwordx4 v87, s[44:47], s61 offen offset:3072 lds
  s_add_u32 s61, s61, 128
  v_mfma_f32_32x32x16_bf16 a[112:127], v[12:15], v[68:71], a[112:127]
  s_xor_b32 s72, s72, 8192
  s_cmp_ge_u32 s62, 7
  s_cselect_b32 s50, 0, s50
  s_waitcnt vmcnt(16) lgkmcnt(0)
  v_mfma_f32_32x32x16_bf16 a[0:15], v[16:19], v[72:75], a[0:15]
  ds_read_b128 v[64:67], v90 offset:0
  v_mfma_f32_32x32x16_bf16 a[16:31], v[16:19], v[76:79], a[16:31]
  ds_read_b128 v[68:71], v90 offset:4096
  v_mfma_f32_32x32x16_bf16 a[32:47], v[20:23], v[72:75], a[32:47]
  v_xor_b32 v90, 8192, v90
  v_mfma_f32_32x32x16_bf16 a[48:63], v[20:23], v[76:79], a[48:63]
  buffer_load_dwordx4 v[0:3], v116, s[48:51], s60 offen offset:0 sc1
  v_mfma_f32_32x32x16_bf16 a[64:79], v[24:27], v[72:75], a[64:79]
  buffer_load_dwordx4 v[4:7], v116, s[48:51], s60 offen offset:1024 sc1
  v_mfma_f32_32x32x16_bf16 a[80:95], v[24:27], v[76:79], a[80:95]
  buffer_load_dwordx4 v[8:11], v116, s[48:51], s60 offen offset:2048 sc1
  v_mfma_f32_32x32x16_bf16 a[96:111], v[28:31], v[72:75], a[96:111]
  buffer_load_dwordx4 v[12:15], v116, s[48:51], s60 offen offset:3072 sc1
  v_mfma_f32_32x32x16_bf16 a[112:127], v[28:31], v[76:79], a[112:127]
  s_add_u32 s60, s60, 27648
  s_waitcnt vmcnt(16) lgkmcnt(0)
  v_mfma_f32_32x32x16_bf16 a[0:15], v[32:35], v[64:67], a[0:15]
  ds_read_b128 v[72:75], v91 offset:0
  v_mfma_f32_32x32x16_bf16 a[16:31], v[32:35], v[68:71], a[16:31]
  ds_read_b128 v[76:79], v91 offset:4096
  v_mfma_f32_32x32x16_bf16 a[32:47], v[36:39], v[64:67], a[32:47]
  v_xor_b32 v91, 8192, v91
  v_mfma_f32_32x32x16_bf16 a[48:63], v[36:39], v[68:71], a[48:63]
  buffer_load_dwordx4 v[16:19], v116, s[48:51], s60 offen offset:0 sc1
  v_mfma_f32_32x32x16_bf16 a[64:79], v[40:43], v[64:67], a[64:79]
  buffer_load_dwordx4 v[20:23], v116, s[48:51], s60 offen offset:1024 sc1
  v_mfma_f32_32x32x16_bf16 a[80:95], v[40:43], v[68:71], a[80:95]
  buffer_load_dwordx4 v[24:27], v116, s[48:51], s60 offen offset:2048 sc1
  v_mfma_f32_32x32x16_bf16 a[96:111], v[44:47], v[64:67], a[96:111]
  buffer_load_dwordx4 v[28:31], v116, s[48:51], s60 offen offset:3072 sc1
  v_mfma_f32_32x32x16_bf16 a[112:127], v[44:47], v[68:71], a[112:127]
  s_add_u32 s60, s60, 27648
  s_add_u32 s62, s62, 1
  s_cmp_ge_u32 s62, 7
  s_cselect_b32 s46, 0, s46
  s_waitcnt vmcnt(8) lgkmcnt(0)
  v_mfma_f32_32x32x16_bf16 a[0:15], v[48:51], v[72:75], a[0:15]
  ds_read_b128 v[64:67], v88 offset:0
  ds_read_b128 v[68:71], v88 offset:4096
  v_mfma_f32_32x32x16_bf16 a[16:31], v[48:51], v[76:79], a[16:31]
  v_xor_b32 v88, 8192, v88
  buffer_load_dwordx4 v[32:35], v116, s[48:51], s60 offen offset:0 sc1
  v_mfma_f32_32x32x16_bf16 a[32:47], v[52:55], v[72:75], a[32:47]
  buffer_load_dwordx4 v[36:39], v116, s[48:51], s60 offen offset:1024 sc1
  v_mfma_f32_32x32x16_bf16 a[48:63], v[52:55], v[76:79], a[48:63]
  buffer_load_dwordx4 v[40:43], v116, s[48:51], s60 offen offset:2048 sc1
  buffer_load_dwordx4 v[44:47], v116, s[48:51], s60 offen offset:3072 sc1
  v_mfma_f32_32x32x16_bf16 a[64:79], v[56:59], v[72:75], a[64:79]
  s_add_u32 s60, s60, 27648
  s_add_u32 m0, s72, 0
  v_mfma_f32_32x32x16_bf16 a[80:95], v[56:59], v[76:79], a[80:95]
  buffer_load_dwordx4 v80, s[44:47], s61 offen offset:0 lds
  v_mfma_f32_32x32x16_bf16 a[96:111], v[60:63], v[72:75], a[96:111]
  buffer_load_dwordx4 v81, s[44:47], s61 offen offset:1024 lds
  buffer_load_dwordx4 v82, s[44:47], s61 offen offset:2048 lds
  v_mfma_f32_32x32x16_bf16 a[112:127], v[60:63], v[76:79], a[112:127]
  buffer_load_dwordx4 v83, s[44:47], s61 offen offset:3072 lds
  s_cmp_lt_u32 s62, 8
  s_cbranch_scc1 L_kg_h_loop4
  s_branch L_kg_h_epi
L_kg_h_tw4:
  s_cmp_eq_u32 s62, 2
  s_cbranch_scc0 L_kg_h_tw4a
  s_mov_b32 s52, s30
  s_and_b32 s53, s31, 0xffff
  s_mov_b32 s54, 256
  s_mov_b32 s55, 0x20000
  v_and_b32 v121, 3, v123
  v_bfe_u32 v122, v123, 2, 1
  v_lshl_add_u32 v121, v122, 5, v121
  v_lshlrev_b32 v119, 2, v121
  buffer_load_dword v118, v119, s[52:55], 0 offen offset:32 sc1
  s_branch L_kg_h_twr4
  L_kg_h_tw4a:
  v_cmp_gt_u32 vcc, 32, v118
  s_sub_u32 s57, s62, 3
  s_cmp_ge_u32 s57, 5
  s_cbranch_scc1 L_kg_h_twr4
  s_cbranch_vccnz L_kg_h_twr4
  s_cmp_ge_u32 s59, s63
  s_cbranch_scc1 L_kg_h_twr4
  s_mov_b64 exec, 0xffff
  buffer_load_dword v117, v92, s[40:43], s59 offen sc1
  s_mov_b64 exec, -1
  s_add_u32 s59, s59, 65536
  s_branch L_kg_h_twr4
L_kg_h_main3:
  buffer_load_dwordx4 v[0:3], v116, s[48:51], s60 offen offset:0 sc1
  buffer_load_dwordx4 v[4:7], v116, s[48:51], s60 offen offset:1024 sc1
  buffer_load_dwordx4 v[8:11], v116, s[48:51], s60 offen offset:2048 sc1
  s_add_u32 s60, s60, 27648
  buffer_load_dwordx4 v[16:19], v116, s[48:51], s60 offen offset:0 sc1
  buffer_load_dwordx4 v[20:23], v116, s[48:51], s60 offen offset:1024 sc1
  buffer_load_dwordx4 v[24:27], v116, s[48:51], s60 offen offset:2048 sc1
  s_add_u32 s60, s60, 27648
  buffer_load_dwordx4 v[32:35], v116, s[48:51], s60 offen offset:0 sc1
  buffer_load_dwordx4 v[36:39], v116, s[48:51], s60 offen offset:1024 sc1
  buffer_load_dwordx4 v[40:43], v116, s[48:51], s60 offen offset:2048 sc1
  s_add_u32 s60, s60, 27648
  s_add_u32 m0, s72, 0
  s_nop 0
  buffer_load_dwordx4 v80, s[44:47], s61 offen offset:0 lds
  buffer_load_dwordx4 v81, s[44:47], s61 offen offset:1024 lds
  buffer_load_dwordx4 v82, s[44:47], s61 offen offset:2048 lds
  buffer_load_dwordx4 v83, s[44:47], s61 offen offset:3072 lds
  ds_read_b128 v[64:67], v88 offset:0
  ds_read_b128 v[68:71], v88 offset:4096
  v_xor_b32 v88, 8192, v88
L_kg_h_loop3:
  s_cmp_ge_u32 s62, 2
  s_cbranch_scc1 L_kg_h_tw3
L_kg_h_twr3:
  s_waitcnt vmcnt(10) lgkmcnt(0)
  v_mfma_f32_32x32x16_bf16 a[0:15], v[0:3], v[64:67], a[0:15]
  ds_read_b128 v[72:75], v89 offset:0
  ds_read_b128 v[76:79], v89 offset:4096
  v_xor_b32 v89, 8192, v89
  v_mfma_f32_32x32x16_bf16 a[16:31], v[0:3], v[68:71], a[16:31]
  buffer_load_dwordx4 v[48:51], v116, s[48:51], s60 offen offset:0 sc1
  buffer_load_dwordx4 v[52:55], v116, s[48:51], s60 offen offset:1024 sc1
  v_mfma_f32_32x32x16_bf16 a[32:47], v[4:7], v[64:67], a[32:47]
  buffer_load_dwordx4 v[56:59], v116, s[48:51], s60 offen offset:2048 sc1
  s_add_u32 s60, s60, 27648
  v_mfma_f32_32x32x16_bf16 a[48:63], v[4:7], v[68:71], a[48:63]
  s_add_u32 m0, s72, 4096
  s_nop 0
  buffer_load_dwordx4 v84, s[44:47], s61 offen offset:0 lds
  buffer_load_dwordx4 v85, s[44:47], s61 offen offset:1024 lds
  v_mfma_f32_32x32x16_bf16 a[64:79], v[8:11], v[64:67], a[64:79]
  buffer_load_dwordx4 v86, s[44:47], s61 offen offset:2048 lds
  buffer_load_dwordx4 v87, s[44:47], s61 offen offset:3072 lds
  v_mfma_f32_32x32x16_bf16 a[80:95], v[8:11], v[68:71], a[80:95]
  s_add_u32 s61, s61, 128
  s_xor_b32 s72, s72, 8192
  s_cmp_ge_u32 s62, 7
  s_cselect_b32 s50, 0, s50
  s_waitcnt vmcnt(14) lgkmcnt(0)
  v_mfma_f32_32x32x16_bf16 a[0:15], v[16:19], v[72:75], a[0:15]
  ds_read_b128 v[64:67], v90 offset:0
  ds_read_b128 v[68:71], v90 offset:4096
  v_mfma_f32_32x32x16_bf16 a[16:31], v[16:19], v[76:79], a[16:31]
  v_xor_b32 v90, 8192, v90
  v_mfma_f32_32x32x16_bf16 a[32:47], v[20:23], v[72:75], a[32:47]
  buffer_load_dwordx4 v[0:3], v116, s[48:51], s60 offen offset:0 sc1
  v_mfma_f32_32x32x16_bf16 a[48:63], v[20:23], v[76:79], a[48:63]
  buffer_load_dwordx4 v[4:7], v116, s[48:51], s60 offen offset:1024 sc1
  v_mfma_f32_32x32x16_bf16 a[64:79], v[24:27], v[72:75], a[64:79]
  buffer_load_dwordx4 v[8:11], v116, s[48:51], s60 offen offset:2048 sc1
  v_mfma_f32_32x32x16_bf16 a[80:95], v[24:27], v[76:79], a[80:95]
  s_add_u32 s60, s60, 27648
  s_waitcnt vmcnt(14) lgkmcnt(0)
  v_mfma_f32_32x32x16_bf16 a[0:15], v[32:35], v[64:67], a[0:15]
  ds_read_b128 v[72:75], v91 offset:0
  ds_read_b128 v[76:79], v91 offset:4096
  v_mfma_f32_32x32x16_bf16 a[16:31], v[32:35], v[68:71], a[16:31]
  v_xor_b32 v91, 8192, v91
  v_mfma_f32_32x32x16_bf16 a[32:47], v[36:39], v[64:67], a[32:47]
  buffer_load_dwordx4 v[16:19], v116, s[48:51], s60 offen offset:0 sc1
  v_mfma_f32_32x32x16_bf16 a[48:63], v[36:39], v[68:71], a[48:63]
  buffer_load_dwordx4 v[20:23], v116, s[48:51], s60 offen offset:1024 sc1
  v_mfma_f32_32x32x16_bf16 a[64:79], v[40:43], v[64:67], a[64:79]
  buffer_load_dwordx4 v[24:27], v116, s[48:51], s60 offen offset:2048 sc1
  v_mfma_f32_32x32x16_bf16 a[80:95], v[40:43], v[68:71], a[80:95]
  s_add_u32 s60, s60, 27648
  s_add_u32 s62, s62, 1
  s_cmp_ge_u32 s62, 7
  s_cselect_b32 s46, 0, s46
  s_waitcnt vmcnt(6) lgkmcnt(0)
  v_mfma_f32_32x32x16_bf16 a[0:15], v[48:51], v[72:75], a[0:15]
  ds_read_b128 v[64:67], v88 offset:0
  ds_read_b128 v[68:71], v88 offset:4096
  v_mfma_f32_32x32x16_bf16 a[16:31], v[48:51], v[76:79], a[16:31]
  v_xor_b32 v88, 8192, v88
  buffer_load_dwordx4 v[32:35], v116, s[48:51], s60 offen offset:0 sc1
  v_mfma_f32_32x32x16_bf16 a[32:47], v[52:55], v[72:75], a[32:47]
  buffer_load_dwordx4 v[36:39], v116, s[48:51], s60 offen offset:1024 sc1
  buffer_load_dwordx4 v[40:43], v116, s[48:51], s60 offen offset:2048 sc1
  v_mfma_f32_32x32x16_bf16 a[48:63], v[52:55], v[76:79], a[48:63]
  s_add_u32 s60, s60, 27648
  s_add_u32 m0, s72, 0
  v_mfma_f32_32x32x16_bf16 a[64:79], v[56:59], v[72:75], a[64:79]
  buffer_load_dwordx4 v80, s[44:47], s61 offen offset:0 lds
  buffer_load_dwordx4 v81, s[44:47], s61 offen offset:1024 lds
  v_mfma_f32_32x32x16_bf16 a[80:95], v[56:59], v[76:79], a[80:95]
  buffer_load_dwordx4 v82, s[44:47], s61 offen offset:2048 lds
  buffer_load_dwordx4 v83, s[44:47], s61 offen offset:3072 lds
  s_cmp_lt_u32 s62, 8
  s_cbranch_scc1 L_kg_h_loop3
  s_branch L_kg_h_epi
L_kg_h_tw3:
  s_cmp_eq_u32 s62, 2
  s_cbranch_scc0 L_kg_h_tw3a
  s_mov_b32 s52, s30
  s_and_b32 s53, s31, 0xffff
  s_mov_b32 s54, 256
  s_mov_b32 s55, 0x20000
  v_and_b32 v121, 3, v123
  v_bfe_u32 v122, v123, 2, 1
  v_lshl_add_u32 v121, v122, 5, v121
  v_lshlrev_b32 v119, 2, v121
  buffer_load_dword v118, v119, s[52:55], 0 offen offset:32 sc1
  s_branch L_kg_h_twr3
  L_kg_h_tw3a:
  v_cmp_gt_u32 vcc, 32, v118
  s_sub_u32 s57, s62, 3
  s_cmp_ge_u32 s57, 5
  s_cbranch_scc1 L_kg_h_twr3
  s_cbranch_vccnz L_kg_h_twr3
  s_cmp_ge_u32 s59, s63
  s_cbranch_scc1 L_kg_h_twr3
  s_mov_b64 exec, 0xffff
  buffer_load_dword v117, v92, s[40:43], s59 offen sc1
  s_mov_b64 exec, -1
  s_add_u32 s59, s59, 65536
  s_branch L_kg_h_twr3
L_kg_h_epi:
  s_setprio 2
  s_waitcnt vmcnt(0) lgkmcnt(0)
  v_add_u32 v2, s65, v116
  s_add_u32 s44, s32, 20119552
  s_addc_u32 s45, s33, 0
  s_and_b32 s45, s45, 0xffff
  s_mov_b32 s46, 1925120
  s_mov_b32 s47, 0x20000
  s_mov_b32 s52, s30
  s_and_b32 s53, s31, 0xffff
  s_mov_b32 s54, 256
  s_mov_b32 s55, 0x20000
  v_and_b32 v121, 3, v123
  v_bfe_u32 v122, v123, 2, 1
  v_lshl_add_u32 v121, v122, 5, v121
  v_lshlrev_b32 v119, 2, v121
  buffer_load_dword v118, v119, s[52:55], 0 offen offset:32 sc1
  s_lshl_b32 s57, s56, 12
  v_add_u32 v0, s57, v116
  s_mul_i32 s58, s34, 108
  s_lshl_b32 s66, s66, 1
  s_add_u32 s66, s66, s58
  s_lshl_b32 s66, s66, 10
  s_add_u32 s66, s66, 13959168
  s_mov_b32 s75, 0xffff0000
  ds_write_b128 v2, a[0:3] offset:0
  ds_write_b128 v2, a[4:7] offset:1024
  ds_write_b128 v2, a[8:11] offset:2048
  ds_write_b128 v2, a[12:15] offset:3072
  ds_write_b128 v2, a[32:35] offset:4096
  ds_write_b128 v2, a[36:39] offset:5120
  ds_write_b128 v2, a[40:43] offset:6144
  ds_write_b128 v2, a[44:47] offset:7168
  ds_write_b128 v2, a[64:67] offset:8192
  ds_write_b128 v2, a[68:71] offset:9216
  ds_write_b128 v2, a[72:75] offset:10240
  ds_write_b128 v2, a[76:79] offset:11264
  s_cmp_eq_u32 s38, 3
  s_cbranch_scc1 L_kg_pw_18
  ds_write_b128 v2, a[96:99] offset:12288
  ds_write_b128 v2, a[100:103] offset:13312
  ds_write_b128 v2, a[104:107] offset:14336
  ds_write_b128 v2, a[108:111] offset:15360
L_kg_pw_18:
  s_mov_b64 exec, 1
  v_mov_b32 v121, 1
  ds_add_u32 v120, v121 offset:8
  s_mov_b64 exec, -1
  s_mov_b32 s80, 0x200000
  L_kg_d_19:
  s_waitcnt vmcnt(0)
  v_cmp_gt_u32 vcc, 32, v118
  s_nop 4
  s_cbranch_vccz L_kg_d_19_d
  s_sleep 3
  buffer_load_dword v118, v119, s[52:55], 0 offen offset:32 sc1
  s_sub_u32 s80, s80, 1
  s_cbranch_scc0 L_kg_d_19
  L_kg_d_19_d:
  s_mov_b32 s80, 0x8000000
L_kg_w_20:
  ds_read_b32 v122, v120 offset:8
  s_waitcnt lgkmcnt(0)
  v_readfirstlane_b32 s57, v122
  s_nop 0
  s_cmp_ge_u32 s57, 4
  s_cbranch_scc1 L_kg_w_20_d
  s_sleep 1
  s_sub_u32 s80, s80, 1
  s_cbranch_scc0 L_kg_w_20
L_kg_w_20_d:
  s_cmp_ge_u32 s56, s38
  s_cbranch_scc1 L_kg_h_idle
  ds_read_b128 v[16:19], v0 offset:0
  ds_read_b128 v[20:23], v0 offset:1024
  ds_read_b128 v[24:27], v0 offset:2048
  ds_read_b128 v[28:31], v0 offset:3072
  ds_read_b128 v[32:35], v0 offset:16384
  ds_read_b128 v[36:39], v0 offset:17408
  ds_read_b128 v[40:43], v0 offset:18432
  ds_read_b128 v[44:47], v0 offset:19456
  ds_read_b128 v[48:51], v0 offset:32768
  ds_read_b128 v[52:55], v0 offset:33792
  ds_read_b128 v[56:59], v0 offset:34816
  ds_read_b128 v[60:63], v0 offset:35840
  ds_read_b128 v[64:67], v0 offset:49152
  ds_read_b128 v[68:71], v0 offset:50176
  ds_read_b128 v[72:75], v0 offset:51200
  ds_read_b128 v[76:79], v0 offset:52224
  s_waitcnt lgkmcnt(8)
  v_pk_add_f32 v[16:17], v[16:17], v[32:33]
  v_pk_add_f32 v[18:19], v[18:19], v[34:35]
  v_pk_add_f32 v[20:21], v[20:21], v[36:37]
  v_pk_add_f32 v[22:23], v[22:23], v[38:39]
  v_pk_add_f32 v[24:25], v[24:25], v[40:41]
  v_pk_add_f32 v[26:27], v[26:27], v[42:43]
  v_pk_add_f32 v[28:29], v[28:29], v[44:45]
  v_pk_add_f32 v[30:31], v[30:31], v[46:47]
  s_waitcnt lgkmcnt(4)
  v_pk_add_f32 v[16:17], v[16:17], v[48:49]
  v_pk_add_f32 v[18:19], v[18:19], v[50:51]
  v_pk_add_f32 v[20:21], v[20:21], v[52:53]
  v_pk_add_f32 v[22:23], v[22:23], v[54:55]
  v_pk_add_f32 v[24:25], v[24:25], v[56:57]
  v_pk_add_f32 v[26:27], v[26:27], v[58:59]
  v_pk_add_f32 v[28:29], v[28:29], v[60:61]
  v_pk_add_f32 v[30:31], v[30:31], v[62:63]
  s_waitcnt lgkmcnt(0)
  s_mov_b64 exec, 1
  v_mov_b32 v121, 1
  ds_add_u32 v120, v121 offset:48
  s_mov_b64 exec, -1
  v_pk_add_f32 v[16:17], v[16:17], v[64:65]
  v_pk_add_f32 v[18:19], v[18:19], v[66:67]
  v_pk_add_f32 v[20:21], v[20:21], v[68:69]
  v_pk_add_f32 v[22:23], v[22:23], v[70:71]
  v_pk_add_f32 v[24:25], v[24:25], v[72:73]
  v_pk_add_f32 v[26:27], v[26:27], v[74:75]
  v_pk_add_f32 v[28:29], v[28:29], v[76:77]
  v_pk_add_f32 v[30:31], v[30:31], v[78:79]
  s_mov_b32 s80, 0x8000000
L_kg_w_21:
  ds_read_b32 v122, v120 offset:48
  s_waitcnt lgkmcnt(0)
  v_readfirstlane_b32 s57, v122
  s_nop 0
  s_cmp_ge_u32 s57, 4
  s_cbranch_scc1 L_kg_w_21_d
  s_sleep 1
  s_sub_u32 s80, s80, 1
  s_cbranch_scc0 L_kg_w_21
L_kg_w_21_d:
  ds_write_b128 v2, a[16:19] offset:0
  ds_write_b128 v2, a[20:23] offset:1024
  ds_write_b128 v2, a[24:27] offset:2048
  ds_write_b128 v2, a[28:31] offset:3072
  ds_write_b128 v2, a[48:51] offset:4096
  ds_write_b128 v2, a[52:55] offset:5120
  ds_write_b128 v2, a[56:59] offset:6144
  ds_write_b128 v2, a[60:63] offset:7168
  ds_write_b128 v2, a[80:83] offset:8192
  ds_write_b128 v2, a[84:87] offset:9216
  ds_write_b128 v2, a[88:91] offset:10240
  ds_write_b128 v2, a[92:95] offset:11264
  s_cmp_eq_u32 s38, 3
  s_cbranch_scc1 L_kg_pw_22
  ds_write_b128 v2, a[112:115] offset:12288
  ds_write_b128 v2, a[116:119] offset:13312
  ds_write_b128 v2, a[120:123] offset:14336
  ds_write_b128 v2, a[124:127] offset:15360
L_kg_pw_22:
  s_mov_b64 exec, 1
  v_mov_b32 v121, 1
  ds_add_u32 v120, v121 offset:52
  s_mov_b64 exec, -1
  v_pk_add_f32 v[16:17], v[16:17], v[112:113] op_sel_hi:[1,0]
  v_pk_add_f32 v[18:19], v[18:19], v[112:113] op_sel_hi:[1,0]
  v_pk_add_f32 v[20:21], v[20:21], v[112:113] op_sel_hi:[1,0]
  v_pk_add_f32 v[22:23], v[22:23], v[112:113] op_sel_hi:[1,0]
  v_pk_add_f32 v[24:25], v[24:25], v[112:113] op_sel_hi:[1,0]
  v_pk_add_f32 v[26:27], v[26:27], v[112:113] op_sel_hi:[1,0]
  v_pk_add_f32 v[28:29], v[28:29], v[112:113] op_sel_hi:[1,0]
  v_pk_add_f32 v[30:31], v[30:31], v[112:113] op_sel_hi:[1,0]
  v_mov_b32 v112, v113
  v_lshlrev_b32 v32, 16, v96
  v_and_b32 v33, s75, v96
  v_lshlrev_b32 v34, 16, v97
  v_and_b32 v35, s75, v97
  v_lshlrev_b32 v36, 16, v98
  v_and_b32 v37, s75, v98
  v_lshlrev_b32 v38, 16, v99
  v_and_b32 v39, s75, v99
  v_lshlrev_b32 v40, 16, v100
  v_and_b32 v41, s75, v100
  v_lshlrev_b32 v42, 16, v101
  v_and_b32 v43, s75, v101
  v_lshlrev_b32 v44, 16, v102
  v_and_b32 v45, s75, v102
  v_lshlrev_b32 v46, 16, v103
  v_and_b32 v47, s75, v103
  v_pk_mul_f32 v[16:17], v[16:17], v[32:33]
  v_pk_mul_f32 v[18:19], v[18:19], v[34:35]
  v_pk_mul_f32 v[20:21], v[20:21], v[36:37]
  v_pk_mul_f32 v[22:23], v[22:23], v[38:39]
  v_pk_mul_f32 v[24:25], v[24:25], v[40:41]
  v_pk_mul_f32 v[26:27], v[26:27], v[42:43]
  v_pk_mul_f32 v[28:29], v[28:29], v[44:45]
  v_pk_mul_f32 v[30:31], v[30:31], v[46:47]
  v_cvt_pk_bf16_f32 v4, v16, v17
  v_cvt_pk_bf16_f32 v5, v18, v19
  v_cvt_pk_bf16_f32 v6, v20, v21
  v_cvt_pk_bf16_f32 v7, v22, v23
  v_cvt_pk_bf16_f32 v8, v24, v25
  v_cvt_pk_bf16_f32 v9, v26, v27
  v_cvt_pk_bf16_f32 v10, v28, v29
  v_cvt_pk_bf16_f32 v11, v30, v31
  buffer_store_dwordx4 v[4:7], v116, s[40:43], s66 offen sc1
  buffer_store_dwordx4 v[8:11], v116, s[40:43], s66 offen offset:1024 sc1
  s_add_u32 s66, s66, 55296
  s_mov_b32 s80, 0x8000000
L_kg_w_23:
  ds_read_b32 v122, v120 offset:52
  s_waitcnt lgkmcnt(0)
  v_readfirstlane_b32 s57, v122
  s_nop 0
  s_cmp_ge_u32 s57, 4
  s_cbranch_scc1 L_kg_w_23_d
  s_sleep 1
  s_sub_u32 s80, s80, 1
  s_cbranch_scc0 L_kg_w_23
L_kg_w_23_d:
  ds_read_b128 v[16:19], v0 offset:0
  ds_read_b128 v[20:23], v0 offset:1024
  ds_read_b128 v[24:27], v0 offset:2048
  ds_read_b128 v[28:31], v0 offset:3072
  ds_read_b128 v[32:35], v0 offset:16384
  ds_read_b128 v[36:39], v0 offset:17408
  ds_read_b128 v[40:43], v0 offset:18432
  ds_read_b128 v[44:47], v0 offset:19456
  ds_read_b128 v[48:51], v0 offset:32768
  ds_read_b128 v[52:55], v0 offset:33792
  ds_read_b128 v[56:59], v0 offset:34816
  ds_read_b128 v[60:63], v0 offset:35840
  ds_read_b128 v[64:67], v0 offset:49152
  ds_read_b128 v[68:71], v0 offset:50176
  ds_read_b128 v[72:75], v0 offset:51200
  ds_read_b128 v[76:79], v0 offset:52224
  s_waitcnt lgkmcnt(8)
  v_pk_add_f32 v[16:17], v[16:17], v[32:33]
  v_pk_add_f32 v[18:19], v[18:19], v[34:35]
  v_pk_add_f32 v[20:21], v[20:21], v[36:37]
  v_pk_add_f32 v[22:23], v[22:23], v[38:39]
  v_pk_add_f32 v[24:25], v[24:25], v[40:41]
  v_pk_add_f32 v[26:27], v[26:27], v[42:43]
  v_pk_add_f32 v[28:29], v[28:29], v[44:45]
  v_pk_add_f32 v[30:31], v[30:31], v[46:47]
  s_waitcnt lgkmcnt(4)
  v_pk_add_f32 v[16:17], v[16:17], v[48:49]
  v_pk_add_f32 v[18:19], v[18:19], v[50:51]
  v_pk_add_f32 v[20:21], v[20:21], v[52:53]
  v_pk_add_f32 v[22:23], v[22:23], v[54:55]
  v_pk_add_f32 v[24:25], v[24:25], v[56:57]
  v_pk_add_f32 v[26:27], v[26:27], v[58:59]
  v_pk_add_f32 v[28:29], v[28:29], v[60:61]
  v_pk_add_f32 v[30:31], v[30:31], v[62:63]
  s_waitcnt lgkmcnt(0)
  s_mov_b64 exec, 1
  v_mov_b32 v121, 1
  ds_add_u32 v120, v121 offset:12
  s_mov_b64 exec, -1
  v_pk_add_f32 v[16:17], v[16:17], v[64:65]
  v_pk_add_f32 v[18:19], v[18:19], v[66:67]
  v_pk_add_f32 v[20:21], v[20:21], v[68:69]
  v_pk_add_f32 v[22:23], v[22:23], v[70:71]
  v_pk_add_f32 v[24:25], v[24:25], v[72:73]
  v_pk_add_f32 v[26:27], v[26:27], v[74:75]
  v_pk_add_f32 v[28:29], v[28:29], v[76:77]
  v_pk_add_f32 v[30:31], v[30:31], v[78:79]
  v_pk_add_f32 v[16:17], v[16:17], v[112:113] op_sel_hi:[1,0]
  v_pk_add_f32 v[18:19], v[18:19], v[112:113] op_sel_hi:[1,0]
  v_pk_add_f32 v[20:21], v[20:21], v[112:113] op_sel_hi:[1,0]
  v_pk_add_f32 v[22:23], v[22:23], v[112:113] op_sel_hi:[1,0]
  v_pk_add_f32 v[24:25], v[24:25], v[112:113] op_sel_hi:[1,0]
  v_pk_add_f32 v[26:27], v[26:27], v[112:113] op_sel_hi:[1,0]
  v_pk_add_f32 v[28:29], v[28:29], v[112:113] op_sel_hi:[1,0]
  v_pk_add_f32 v[30:31], v[30:31], v[112:113] op_sel_hi:[1,0]
  v_lshlrev_b32 v32, 16, v104
  v_and_b32 v33, s75, v104
  v_lshlrev_b32 v34, 16, v105
  v_and_b32 v35, s75, v105
  v_lshlrev_b32 v36, 16, v106
  v_and_b32 v37, s75, v106
  v_lshlrev_b32 v38, 16, v107
  v_and_b32 v39, s75, v107
  v_lshlrev_b32 v40, 16, v108
  v_and_b32 v41, s75, v108
  v_lshlrev_b32 v42, 16, v109
  v_and_b32 v43, s75, v109
  v_lshlrev_b32 v44, 16, v110
  v_and_b32 v45, s75, v110
  v_lshlrev_b32 v46, 16, v111
  v_and_b32 v47, s75, v111
  v_pk_mul_f32 v[16:17], v[16:17], v[32:33]
  v_pk_mul_f32 v[18:19], v[18:19], v[34:35]
  v_pk_mul_f32 v[20:21], v[20:21], v[36:37]
  v_pk_mul_f32 v[22:23], v[22:23], v[38:39]
  v_pk_mul_f32 v[24:25], v[24:25], v[40:41]
  v_pk_mul_f32 v[26:27], v[26:27], v[42:43]
  v_pk_mul_f32 v[28:29], v[28:29], v[44:45]
  v_pk_mul_f32 v[30:31], v[30:31], v[46:47]
  v_cvt_pk_bf16_f32 v4, v16, v17
  v_cvt_pk_bf16_f32 v5, v18, v19
  v_cvt_pk_bf16_f32 v6, v20, v21
  v_cvt_pk_bf16_f32 v7, v22, v23
  v_cvt_pk_bf16_f32 v8, v24, v25
  v_cvt_pk_bf16_f32 v9, v26, v27
  v_cvt_pk_bf16_f32 v10, v28, v29
  v_cvt_pk_bf16_f32 v11, v30, v31
  buffer_store_dwordx4 v[4:7], v116, s[40:43], s66 offen sc1
  buffer_store_dwordx4 v[8:11], v116, s[40:43], s66 offen offset:1024 sc1
  s_add_u32 s66, s66, 55296
  s_branch L_kg_h_pub
L_kg_h_idle:
  s_mov_b64 exec, 1
  v_mov_b32 v121, 1
  ds_add_u32 v120, v121 offset:48
  s_mov_b64 exec, -1
  s_mov_b32 s80, 0x8000000
L_kg_w_24:
  ds_read_b32 v122, v120 offset:48
  s_waitcnt lgkmcnt(0)
  v_readfirstlane_b32 s57, v122
  s_nop 0
  s_cmp_ge_u32 s57, 4
  s_cbranch_scc1 L_kg_w_24_d
  s_sleep 1
  s_sub_u32 s80, s80, 1
  s_cbranch_scc0 L_kg_w_24
L_kg_w_24_d:
  ds_write_b128 v2, a[16:19] offset:0
  ds_write_b128 v2, a[20:23] offset:1024
  ds_write_b128 v2, a[24:27] offset:2048
  ds_write_b128 v2, a[28:31] offset:3072
  ds_write_b128 v2, a[48:51] offset:4096
  ds_write_b128 v2, a[52:55] offset:5120
  ds_write_b128 v2, a[56:59] offset:6144
  ds_write_b128 v2, a[60:63] offset:7168
  ds_write_b128 v2, a[80:83] offset:8192
  ds_write_b128 v2, a[84:87] offset:9216
  ds_write_b128 v2, a[88:91] offset:10240
  ds_write_b128 v2, a[92:95] offset:11264
  s_cmp_eq_u32 s38, 3
  s_cbranch_scc1 L_kg_pw_25
  ds_write_b128 v2, a[112:115] offset:12288
  ds_write_b128 v2, a[116:119] offset:13312
  ds_write_b128 v2, a[120:123] offset:14336
  ds_write_b128 v2, a[124:127] offset:15360
L_kg_pw_25:
  s_mov_b64 exec, 1
  v_mov_b32 v121, 1
  ds_add_u32 v120, v121 offset:52
  s_mov_b64 exec, -1
  s_mov_b64 exec, 1
  v_mov_b32 v121, 1
  ds_add_u32 v120, v121 offset:12
  s_mov_b64 exec, -1
L_kg_h_pub:
  s_lshl_b32 s72, s34, 13
  s_lshl_b32 s57, s35, 2
  s_add_u32 s73, s72, s57
  s_add_u32 s73, s73, 22143616
  s_add_u32 s72, s78, 384
  s_lshl_b32 s57, s56, 3
  v_add_u32 v80, s57, v115
  v_and_b32 v80, 31, v80
  v_lshl_add_u32 v80, v114, 5, v80
  v_lshlrev_b32 v95, 4, v80
  v_and_b32 v81, 7, v115
  v_mov_b32 v88, v116
  v_lshlrev_b32 v92, 2, v81
  v_min_u32 v87, 2, v81
  v_lshlrev_b32 v87, 2, v87
  v_max_u32 v81, 3, v81
  v_lshlrev_b32 v81, 2, v81
  s_lshl_b32 s68, s56, 13
  s_add_u32 s68, s68, 24576
  s_mul_i32 s64, s56, 2048
  s_add_u32 s64, s64, 24576
  s_mul_i32 s57, s76, 96256
  s_add_u32 s69, s57, s68
  s_add_u32 s69, s69, 40960
  s_add_u32 s70, s69, 96256
  s_add_u32 s71, s69, 192512
  s_mul_i32 s57, s34, 110592
  s_add_u32 s57, s57, 13959168
  s_add_u32 s58, s57, 55296
  s_add_u32 s48, s32, s57
  s_addc_u32 s49, s33, 0
  s_and_b32 s49, s49, 0xffff
  s_mov_b32 s50, 55296
  s_mov_b32 s51, 0x20000
  s_add_u32 s52, s32, s58
  s_addc_u32 s53, s33, 0
  s_and_b32 s53, s53, 0xffff
  s_mov_b32 s54, 55296
  s_mov_b32 s55, 0x20000
  s_add_u32 s57, s56, 1
  s_and_b32 s57, s57, 3
  s_mul_i32 s57, s57, 18432
  s_add_u32 s57, s57, 0
  v_add_u32 v82, s57, v116
  s_add_u32 s57, s56, 2
  s_and_b32 s57, s57, 3
  s_mul_i32 s57, s57, 18432
  s_add_u32 s57, s57, 6144
  v_add_u32 v83, s57, v116
  s_add_u32 s57, s56, 3
  s_and_b32 s57, s57, 3
  s_mul_i32 s57, s57, 18432
  s_add_u32 s57, s57, 12288
  v_add_u32 v84, s57, v116
  s_mul_i32 s57, s56, 18432
  s_add_u32 s57, s57, 0
  v_add_u32 v85, s57, v116
  v_mul_u32_u24 v86, 48, v115
  v_lshl_add_u32 v86, v114, 3, v86
  s_mul_i32 s57, s56, 18496
  s_add_u32 s57, s57, 0
  v_add_u32 v86, s57, v86
  s_waitcnt vmcnt(0)
  s_mov_b64 exec, 1
  v_mov_b32 v121, 1
  ds_add_rtn_u32 v122, v120, v121 offset:24
  s_mov_b64 exec, -1
  s_waitcnt lgkmcnt(0)
  v_readfirstlane_b32 s57, v122
  s_nop 0
  s_cmp_eq_u32 s57, 3
  s_cbranch_scc0 L_kg_p_26
  v_lshlrev_b32 v121, 10, v115
  v_mov_b32 v122, 1
  s_mov_b32 exec_lo, 0xff
  s_mov_b32 exec_hi, 0
  buffer_store_dword v122, v121, s[40:43], s73 offen sc1
  s_mov_b64 exec, -1
L_kg_p_26:
  s_setprio 2
  s_mov_b32 s60, 0
  s_mov_b32 s61, 0
  s_mov_b32 s62, s60
  s_mov_b32 s63, s61
  s_cmp_eq_u32 s77, 2
  s_cbranch_scc1 L_kg_g2
  buffer_load_dword v91, v81, s[40:43], s72 offen sc1
  v_add_u32 v89, s60, v95
  s_add_u32 s60, s60, 1024
  s_cmp_eq_u32 s60, 8192
  s_cselect_b32 s60, 0, s60
  buffer_load_dwordx4 v[32:35], v89, s[44:47], s69 offen sc1
  buffer_load_dwordx4 v[36:39], v89, s[44:47], s70 offen sc1
  buffer_load_dwordx4 v[40:43], v89, s[44:47], s71 offen sc1
  v_add_u32 v89, s60, v95
  s_add_u32 s60, s60, 1024
  s_cmp_eq_u32 s60, 8192
  s_cselect_b32 s60, 0, s60
  buffer_load_dwordx4 v[44:47], v89, s[44:47], s69 offen sc1
  buffer_load_dwordx4 v[48:51], v89, s[44:47], s70 offen sc1
  buffer_load_dwordx4 v[52:55], v89, s[44:47], s71 offen sc1
  v_add_u32 v89, s60, v95
  s_add_u32 s60, s60, 1024
  s_cmp_eq_u32 s60, 8192
  s_cselect_b32 s60, 0, s60
  buffer_load_dwordx4 v[56:59], v89, s[44:47], s69 offen sc1
  buffer_load_dwordx4 v[60:63], v89, s[44:47], s70 offen sc1
  buffer_load_dwordx4 v[64:67], v89, s[44:47], s71 offen sc1
  v_add_u32 v89, s60, v95
  s_add_u32 s60, s60, 1024
  s_cmp_eq_u32 s60, 8192
  s_cselect_b32 s60, 0, s60
  buffer_load_dwordx4 v[68:71], v89, s[44:47], s69 offen sc1
  buffer_load_dwordx4 v[72:75], v89, s[44:47], s70 offen sc1
  buffer_load_dwordx4 v[76:79], v89, s[44:47], s71 offen sc1
  s_waitcnt vmcnt(12)
  v_cmp_eq_u32 vcc, 0, v91
  s_nop 4
  s_cbranch_vccz L_kg_fast_270
  s_mov_b32 s80, 0x200000
  L_kg_g_28:
  buffer_load_dword v122, v81, s[40:43], s72 offen sc1
  s_waitcnt vmcnt(0)
  v_cmp_gt_u32 vcc, 1, v122
  s_nop 4
  s_cbranch_vccz L_kg_g_28_d
  s_sleep 1
  s_sub_u32 s80, s80, 1
  s_cbranch_scc0 L_kg_g_28
  L_kg_g_28_d:
L_kg_fast_270:
  v_add_u32 v90, s62, v88
  s_add_u32 s62, s62, 1024
  s_cmp_eq_u32 s62, 8192
  s_cselect_b32 s62, 0, s62
  buffer_load_dwordx4 v[0:3], v90, s[48:51], s68 offen sc1
  buffer_load_dwordx4 v[4:7], v90, s[52:55], s68 offen sc1
  v_add_u32 v90, s62, v88
  s_add_u32 s62, s62, 1024
  s_cmp_eq_u32 s62, 8192
  s_cselect_b32 s62, 0, s62
  buffer_load_dwordx4 v[8:11], v90, s[48:51], s68 offen sc1
  buffer_load_dwordx4 v[12:15], v90, s[52:55], s68 offen sc1
  v_add_u32 v90, s62, v88
  s_add_u32 s62, s62, 1024
  s_cmp_eq_u32 s62, 8192
  s_cselect_b32 s62, 0, s62
  buffer_load_dwordx4 v[16:19], v90, s[48:51], s68 offen sc1
  buffer_load_dwordx4 v[20:23], v90, s[52:55], s68 offen sc1
  v_add_u32 v90, s62, v88
  s_add_u32 s62, s62, 1024
  s_cmp_eq_u32 s62, 8192
  s_cselect_b32 s62, 0, s62
  buffer_load_dwordx4 v[24:27], v90, s[48:51], s68 offen sc1
  buffer_load_dwordx4 v[28:31], v90, s[52:55], s68 offen sc1
  s_waitcnt vmcnt(6)
  v_mfma_f32_32x32x16_bf16 a[0:15], v[32:35], v[0:3], 0
  v_mfma_f32_32x32x16_bf16 a[16:31], v[32:35], v[4:7], 0
  v_mfma_f32_32x32x16_bf16 a[32:47], v[36:39], v[0:3], 0
  v_mfma_f32_32x32x16_bf16 a[48:63], v[36:39], v[4:7], 0
  v_mfma_f32_32x32x16_bf16 a[64:79], v[40:43], v[0:3], 0
  v_mfma_f32_32x32x16_bf16 a[80:95], v[40:43], v[4:7], 0
  v_add_u32 v90, s62, v88
  s_add_u32 s62, s62, 1024
  s_cmp_eq_u32 s62, 8192
  s_cselect_b32 s62, 0, s62
  buffer_load_dwordx4 v[0:3], v90, s[48:51], s68 offen sc1
  buffer_load_dwordx4 v[4:7], v90, s[52:55], s68 offen sc1
  v_add_u32 v89, s60, v95
  s_add_u32 s60, s60, 1024
  s_cmp_eq_u32 s60, 8192
  s_cselect_b32 s60, 0, s60
  buffer_load_dwordx4 v[96:99], v89, s[44:47], s69 offen sc1
  buffer_load_dwordx4 v[100:103], v89, s[44:47], s70 offen sc1
  buffer_load_dwordx4 v[104:107], v89, s[44:47], s71 offen sc1
  s_waitcnt vmcnt(9)
  v_mfma_f32_32x32x16_bf16 a[0:15], v[44:47], v[8:11], a[0:15]
  v_mfma_f32_32x32x16_bf16 a[16:31], v[44:47], v[12:15], a[16:31]
  v_mfma_f32_32x32x16_bf16 a[32:47], v[48:51], v[8:11], a[32:47]
  v_mfma_f32_32x32x16_bf16 a[48:63], v[48:51], v[12:15], a[48:63]
  v_mfma_f32_32x32x16_bf16 a[64:79], v[52:55], v[8:11], a[64:79]
  v_mfma_f32_32x32x16_bf16 a[80:95], v[52:55], v[12:15], a[80:95]
  v_add_u32 v90, s62, v88
  s_add_u32 s62, s62, 1024
  s_cmp_eq_u32 s62, 8192
  s_cselect_b32 s62, 0, s62
  buffer_load_dwordx4 v[8:11], v90, s[48:51], s68 offen sc1
  buffer_load_dwordx4 v[12:15], v90, s[52:55], s68 offen sc1
  v_add_u32 v89, s60, v95
  s_add_u32 s60, s60, 1024
  s_cmp_eq_u32 s60, 8192
  s_cselect_b32 s60, 0, s60
  buffer_load_dwordx4 v[108:111], v89, s[44:47], s69 offen sc1
  buffer_load_dwordx4 v[112:115], v89, s[44:47], s70 offen sc1
  buffer_load_dwordx4 v[116:119], v89, s[44:47], s71 offen sc1
  s_waitcnt vmcnt(12)
  v_mfma_f32_32x32x16_bf16 a[0:15], v[56:59], v[16:19], a[0:15]
  v_mfma_f32_32x32x16_bf16 a[16:31], v[56:59], v[20:23], a[16:31]
  v_mfma_f32_32x32x16_bf16 a[32:47], v[60:63], v[16:19], a[32:47]
  v_mfma_f32_32x32x16_bf16 a[48:63], v[60:63], v[20:23], a[48:63]
  v_mfma_f32_32x32x16_bf16 a[64:79], v[64:67], v[16:19], a[64:79]
  v_mfma_f32_32x32x16_bf16 a[80:95], v[64:67], v[20:23], a[80:95]
  buffer_load_dword v91, v87, s[40:43], s72 offen sc1
  v_add_u32 v90, s62, v88
  s_add_u32 s62, s62, 1024
  s_cmp_eq_u32 s62, 8192
  s_cselect_b32 s62, 0, s62
  buffer_load_dwordx4 v[16:19], v90, s[48:51], s68 offen sc1
  buffer_load_dwordx4 v[20:23], v90, s[52:55], s68 offen sc1
  v_add_u32 v89, s60, v95
  s_add_u32 s60, s60, 1024
  s_cmp_eq_u32 s60, 8192
  s_cselect_b32 s60, 0, s60
  buffer_load_dwordx4 a[96:99], v89, s[44:47], s69 offen sc1
  buffer_load_dwordx4 a[100:103], v89, s[44:47], s70 offen sc1
  buffer_load_dwordx4 a[104:107], v89, s[44:47], s71 offen sc1
  s_waitcnt vmcnt(16)
  v_mfma_f32_32x32x16_bf16 a[0:15], v[68:71], v[24:27], a[0:15]
  v_mfma_f32_32x32x16_bf16 a[16:31], v[68:71], v[28:31], a[16:31]
  v_mfma_f32_32x32x16_bf16 a[32:47], v[72:75], v[24:27], a[32:47]
  v_mfma_f32_32x32x16_bf16 a[48:63], v[72:75], v[28:31], a[48:63]
  v_mfma_f32_32x32x16_bf16 a[64:79], v[76:79], v[24:27], a[64:79]
  v_mfma_f32_32x32x16_bf16 a[80:95], v[76:79], v[28:31], a[80:95]
  v_add_u32 v90, s62, v88
  s_add_u32 s62, s62, 1024
  s_cmp_eq_u32 s62, 8192
  s_cselect_b32 s62, 0, s62
  buffer_load_dwordx4 v[24:27], v90, s[48:51], s68 offen sc1
  buffer_load_dwordx4 v[28:31], v90, s[52:55], s68 offen sc1
  v_add_u32 v89, s60, v95
  s_add_u32 s60, s60, 1024
  s_cmp_eq_u32 s60, 8192
  s_cselect_b32 s60, 0, s60
  buffer_load_dwordx4 a[108:111], v89, s[44:47], s69 offen sc1
  buffer_load_dwordx4 a[112:115], v89, s[44:47], s70 offen sc1
  buffer_load_dwordx4 a[116:119], v89, s[44:47], s71 offen sc1
  s_waitcnt vmcnt(10)
  v_cmp_eq_u32 vcc, 0, v91
  s_nop 4
  s_cbranch_vccz L_kg_fast_27
  v_mfma_f32_32x32x16_bf16 a[0:15], v[96:99], v[0:3], a[0:15]
  v_mfma_f32_32x32x16_bf16 a[16:31], v[96:99], v[4:7], a[16:31]
  v_mfma_f32_32x32x16_bf16 a[32:47], v[100:103], v[0:3], a[32:47]
  v_mfma_f32_32x32x16_bf16 a[48:63], v[100:103], v[4:7], a[48:63]
  v_mfma_f32_32x32x16_bf16 a[64:79], v[104:107], v[0:3], a[64:79]
  v_mfma_f32_32x32x16_bf16 a[80:95], v[104:107], v[4:7], a[80:95]
  s_sub_u32 s69, s69, s64
  s_sub_u32 s70, s70, s64
  s_sub_u32 s71, s71, s64
  v_add_u32 v89, s61, v95
  s_add_u32 s61, s61, 1024
  s_cmp_eq_u32 s61, 6144
  s_cselect_b32 s61, 0, s61
  buffer_load_dwordx4 v[32:35], v89, s[44:47], s69 offen sc1
  buffer_load_dwordx4 v[36:39], v89, s[44:47], s70 offen sc1
  buffer_load_dwordx4 v[40:43], v89, s[44:47], s71 offen sc1
  v_mfma_f32_32x32x16_bf16 a[0:15], v[108:111], v[8:11], a[0:15]
  v_mfma_f32_32x32x16_bf16 a[16:31], v[108:111], v[12:15], a[16:31]
  v_mfma_f32_32x32x16_bf16 a[32:47], v[112:115], v[8:11], a[32:47]
  v_mfma_f32_32x32x16_bf16 a[48:63], v[112:115], v[12:15], a[48:63]
  v_mfma_f32_32x32x16_bf16 a[64:79], v[116:119], v[8:11], a[64:79]
  v_mfma_f32_32x32x16_bf16 a[80:95], v[116:119], v[12:15], a[80:95]
  v_add_u32 v89, s61, v95
  s_add_u32 s61, s61, 1024
  s_cmp_eq_u32 s61, 6144
  s_cselect_b32 s61, 0, s61
  buffer_load_dwordx4 v[44:47], v89, s[44:47], s69 offen sc1
  buffer_load_dwordx4 v[48:51], v89, s[44:47], s70 offen sc1
  buffer_load_dwordx4 v[52:55], v89, s[44:47], s71 offen sc1
  s_waitcnt vmcnt(11)
  v_mfma_f32_32x32x16_bf16 a[0:15], a[96:99], v[16:19], a[0:15]
  v_mfma_f32_32x32x16_bf16 a[16:31], a[96:99], v[20:23], a[16:31]
  v_mfma_f32_32x32x16_bf16 a[32:47], a[100:103], v[16:19], a[32:47]
  v_mfma_f32_32x32x16_bf16 a[48:63], a[100:103], v[20:23], a[48:63]
  v_mfma_f32_32x32x16_bf16 a[64:79], a[104:107], v[16:19], a[64:79]
  v_mfma_f32_32x32x16_bf16 a[80:95], a[104:107], v[20:23], a[80:95]
  v_add_u32 v89, s61, v95
  s_add_u32 s61, s61, 1024
  s_cmp_eq_u32 s61, 6144
  s_cselect_b32 s61, 0, s61
  buffer_load_dwordx4 v[56:59], v89, s[44:47], s69 offen sc1
  buffer_load_dwordx4 v[60:63], v89, s[44:47], s70 offen sc1
  buffer_load_dwordx4 v[64:67], v89, s[44:47], s71 offen sc1
  s_waitcnt vmcnt(9)
  v_mfma_f32_32x32x16_bf16 a[0:15], a[108:111], v[24:27], a[0:15]
  v_mfma_f32_32x32x16_bf16 a[16:31], a[108:111], v[28:31], a[16:31]
  v_mfma_f32_32x32x16_bf16 a[32:47], a[112:115], v[24:27], a[32:47]
  v_mfma_f32_32x32x16_bf16 a[48:63], a[112:115], v[28:31], a[48:63]
  v_mfma_f32_32x32x16_bf16 a[64:79], a[116:119], v[24:27], a[64:79]
  v_mfma_f32_32x32x16_bf16 a[80:95], a[116:119], v[28:31], a[80:95]
  v_add_u32 v89, s61, v95
  s_add_u32 s61, s61, 1024
  s_cmp_eq_u32 s61, 6144
  s_cselect_b32 s61, 0, s61
  buffer_load_dwordx4 v[68:71], v89, s[44:47], s69 offen sc1
  buffer_load_dwordx4 v[72:75], v89, s[44:47], s70 offen sc1
  buffer_load_dwordx4 v[76:79], v89, s[44:47], s71 offen sc1
  s_mov_b32 s80, 0x200000
  L_kg_g_29:
  buffer_load_dword v122, v87, s[40:43], s72 offen sc1
  s_waitcnt vmcnt(0)
  v_cmp_gt_u32 vcc, 1, v122
  s_nop 4
  s_cbranch_vccz L_kg_g_29_d
  s_sleep 1
  s_sub_u32 s80, s80, 1
  s_cbranch_scc0 L_kg_g_29
  L_kg_g_29_d:
  s_sub_u32 s68, s68, s64
  v_add_u32 v90, s63, v88
  s_add_u32 s63, s63, 1024
  s_cmp_eq_u32 s63, 6144
  s_cselect_b32 s63, 0, s63
  buffer_load_dwordx4 v[0:3], v90, s[48:51], s68 offen sc1
  buffer_load_dwordx4 v[4:7], v90, s[52:55], s68 offen sc1
  v_add_u32 v90, s63, v88
  s_add_u32 s63, s63, 1024
  s_cmp_eq_u32 s63, 6144
  s_cselect_b32 s63, 0, s63
  buffer_load_dwordx4 v[8:11], v90, s[48:51], s68 offen sc1
  buffer_load_dwordx4 v[12:15], v90, s[52:55], s68 offen sc1
  v_add_u32 v90, s63, v88
  s_add_u32 s63, s63, 1024
  s_cmp_eq_u32 s63, 6144
  s_cselect_b32 s63, 0, s63
  buffer_load_dwordx4 v[16:19], v90, s[48:51], s68 offen sc1
  buffer_load_dwordx4 v[20:23], v90, s[52:55], s68 offen sc1
  v_add_u32 v90, s63, v88
  s_add_u32 s63, s63, 1024
  s_cmp_eq_u32 s63, 6144
  s_cselect_b32 s63, 0, s63
  buffer_load_dwordx4 v[24:27], v90, s[48:51], s68 offen sc1
  buffer_load_dwordx4 v[28:31], v90, s[52:55], s68 offen sc1
  s_waitcnt vmcnt(6)
  v_mfma_f32_32x32x16_bf16 a[0:15], v[32:35], v[0:3], a[0:15]
  v_mfma_f32_32x32x16_bf16 a[16:31], v[32:35], v[4:7], a[16:31]
  v_mfma_f32_32x32x16_bf16 a[32:47], v[36:39], v[0:3], a[32:47]
  v_mfma_f32_32x32x16_bf16 a[48:63], v[36:39], v[4:7], a[48:63]
  v_mfma_f32_32x32x16_bf16 a[64:79], v[40:43], v[0:3], a[64:79]
  v_mfma_f32_32x32x16_bf16 a[80:95], v[40:43], v[4:7], a[80:95]
  v_add_u32 v90, s63, v88
  s_add_u32 s63, s63, 1024
  s_cmp_eq_u32 s63, 6144
  s_cselect_b32 s63, 0, s63
  buffer_load_dwordx4 v[0:3], v90, s[48:51], s68 offen sc1
  buffer_load_dwordx4 v[4:7], v90, s[52:55], s68 offen sc1
  v_add_u32 v89, s61, v95
  s_add_u32 s61, s61, 1024
  s_cmp_eq_u32 s61, 6144
  s_cselect_b32 s61, 0, s61
  buffer_load_dwordx4 v[96:99], v89, s[44:47], s69 offen sc1
  buffer_load_dwordx4 v[100:103], v89, s[44:47], s70 offen sc1
  buffer_load_dwordx4 v[104:107], v89, s[44:47], s71 offen sc1
  s_waitcnt vmcnt(9)
  v_mfma_f32_32x32x16_bf16 a[0:15], v[44:47], v[8:11], a[0:15]
  v_mfma_f32_32x32x16_bf16 a[16:31], v[44:47], v[12:15], a[16:31]
  v_mfma_f32_32x32x16_bf16 a[32:47], v[48:51], v[8:11], a[32:47]
  v_mfma_f32_32x32x16_bf16 a[48:63], v[48:51], v[12:15], a[48:63]
  v_mfma_f32_32x32x16_bf16 a[64:79], v[52:55], v[8:11], a[64:79]
  v_mfma_f32_32x32x16_bf16 a[80:95], v[52:55], v[12:15], a[80:95]
  v_add_u32 v90, s63, v88
  s_add_u32 s63, s63, 1024
  s_cmp_eq_u32 s63, 6144
  s_cselect_b32 s63, 0, s63
  buffer_load_dwordx4 v[8:11], v90, s[48:51], s68 offen sc1
  buffer_load_dwordx4 v[12:15], v90, s[52:55], s68 offen sc1
  v_add_u32 v89, s61, v95
  s_add_u32 s61, s61, 1024
  s_cmp_eq_u32 s61, 6144
  s_cselect_b32 s61, 0, s61
  buffer_load_dwordx4 v[108:111], v89, s[44:47], s69 offen sc1
  buffer_load_dwordx4 v[112:115], v89, s[44:47], s70 offen sc1
  buffer_load_dwordx4 v[116:119], v89, s[44:47], s71 offen sc1
  s_waitcnt vmcnt(12)
  v_mfma_f32_32x32x16_bf16 a[0:15], v[56:59], v[16:19], a[0:15]
  v_mfma_f32_32x32x16_bf16 a[16:31], v[56:59], v[20:23], a[16:31]
  v_mfma_f32_32x32x16_bf16 a[32:47], v[60:63], v[16:19], a[32:47]
  v_mfma_f32_32x32x16_bf16 a[48:63], v[60:63], v[20:23], a[48:63]
  v_mfma_f32_32x32x16_bf16 a[64:79], v[64:67], v[16:19], a[64:79]
  v_mfma_f32_32x32x16_bf16 a[80:95], v[64:67], v[20:23], a[80:95]
  s_waitcnt vmcnt(10)
  v_mfma_f32_32x32x16_bf16 a[0:15], v[68:71], v[24:27], a[0:15]
  v_mfma_f32_32x32x16_bf16 a[16:31], v[68:71], v[28:31], a[16:31]
  v_mfma_f32_32x32x16_bf16 a[32:47], v[72:75], v[24:27], a[32:47]
  v_mfma_f32_32x32x16_bf16 a[48:63], v[72:75], v[28:31], a[48:63]
  v_mfma_f32_32x32x16_bf16 a[64:79], v[76:79], v[24:27], a[64:79]
  v_mfma_f32_32x32x16_bf16 a[80:95], v[76:79], v[28:31], a[80:95]
  s_waitcnt vmcnt(5)
  v_mfma_f32_32x32x16_bf16 a[0:15], v[96:99], v[0:3], a[0:15]
  v_mfma_f32_32x32x16_bf16 a[16:31], v[96:99], v[4:7], a[16:31]
  v_mfma_f32_32x32x16_bf16 a[32:47], v[100:103], v[0:3], a[32:47]
  v_mfma_f32_32x32x16_bf16 a[48:63], v[100:103], v[4:7], a[48:63]
  v_mfma_f32_32x32x16_bf16 a[64:79], v[104:107], v[0:3], a[64:79]
  v_mfma_f32_32x32x16_bf16 a[80:95], v[104:107], v[4:7], a[80:95]
  s_waitcnt vmcnt(0)
  v_mfma_f32_32x32x16_bf16 a[0:15], v[108:111], v[8:11], a[0:15]
  v_mfma_f32_32x32x16_bf16 a[16:31], v[108:111], v[12:15], a[16:31]
  v_mfma_f32_32x32x16_bf16 a[32:47], v[112:115], v[8:11], a[32:47]
  v_mfma_f32_32x32x16_bf16 a[48:63], v[112:115], v[12:15], a[48:63]
  v_mfma_f32_32x32x16_bf16 a[64:79], v[116:119], v[8:11], a[64:79]
  v_mfma_f32_32x32x16_bf16 a[80:95], v[116:119], v[12:15], a[80:95]
  s_branch L_kg_fast_27e
L_kg_fast_27:
  v_mfma_f32_32x32x16_bf16 a[0:15], v[96:99], v[0:3], a[0:15]
  v_mfma_f32_32x32x16_bf16 a[16:31], v[96:99], v[4:7], a[16:31]
  v_mfma_f32_32x32x16_bf16 a[32:47], v[100:103], v[0:3], a[32:47]
  v_mfma_f32_32x32x16_bf16 a[48:63], v[100:103], v[4:7], a[48:63]
  v_mfma_f32_32x32x16_bf16 a[64:79], v[104:107], v[0:3], a[64:79]
  v_mfma_f32_32x32x16_bf16 a[80:95], v[104:107], v[4:7], a[80:95]
  s_sub_u32 s68, s68, s64
  v_add_u32 v90, s63, v88
  s_add_u32 s63, s63, 1024
  s_cmp_eq_u32 s63, 6144
  s_cselect_b32 s63, 0, s63
  buffer_load_dwordx4 v[0:3], v90, s[48:51], s68 offen sc1
  buffer_load_dwordx4 v[4:7], v90, s[52:55], s68 offen sc1
  s_sub_u32 s69, s69, s64
  s_sub_u32 s70, s70, s64
  s_sub_u32 s71, s71, s64
  v_add_u32 v89, s61, v95
  s_add_u32 s61, s61, 1024
  s_cmp_eq_u32 s61, 6144
  s_cselect_b32 s61, 0, s61
  buffer_load_dwordx4 v[32:35], v89, s[44:47], s69 offen sc1
  buffer_load_dwordx4 v[36:39], v89, s[44:47], s70 offen sc1
  buffer_load_dwordx4 v[40:43], v89, s[44:47], s71 offen sc1
  v_mfma_f32_32x32x16_bf16 a[0:15], v[108:111], v[8:11], a[0:15]
  v_mfma_f32_32x32x16_bf16 a[16:31], v[108:111], v[12:15], a[16:31]
  v_mfma_f32_32x32x16_bf16 a[32:47], v[112:115], v[8:11], a[32:47]
  v_mfma_f32_32x32x16_bf16 a[48:63], v[112:115], v[12:15], a[48:63]
  v_mfma_f32_32x32x16_bf16 a[64:79], v[116:119], v[8:11], a[64:79]
  v_mfma_f32_32x32x16_bf16 a[80:95], v[116:119], v[12:15], a[80:95]
  v_add_u32 v90, s63, v88
  s_add_u32 s63, s63, 1024
  s_cmp_eq_u32 s63, 6144
  s_cselect_b32 s63, 0, s63
  buffer_load_dwordx4 v[8:11], v90, s[48:51], s68 offen sc1
  buffer_load_dwordx4 v[12:15], v90, s[52:55], s68 offen sc1
  v_add_u32 v89, s61, v95
  s_add_u32 s61, s61, 1024
  s_cmp_eq_u32 s61, 6144
  s_cselect_b32 s61, 0, s61
  buffer_load_dwordx4 v[44:47], v89, s[44:47], s69 offen sc1
  buffer_load_dwordx4 v[48:51], v89, s[44:47], s70 offen sc1
  buffer_load_dwordx4 v[52:55], v89, s[44:47], s71 offen sc1
  s_waitcnt vmcnt(15)
  v_mfma_f32_32x32x16_bf16 a[0:15], a[96:99], v[16:19], a[0:15]
  v_mfma_f32_32x32x16_bf16 a[16:31], a[96:99], v[20:23], a[16:31]
  v_mfma_f32_32x32x16_bf16 a[32:47], a[100:103], v[16:19], a[32:47]
  v_mfma_f32_32x32x16_bf16 a[48:63], a[100:103], v[20:23], a[48:63]
  v_mfma_f32_32x32x16_bf16 a[64:79], a[104:107], v[16:19], a[64:79]
  v_mfma_f32_32x32x16_bf16 a[80:95], a[104:107], v[20:23], a[80:95]
  v_add_u32 v90, s63, v88
  s_add_u32 s63, s63, 1024
  s_cmp_eq_u32 s63, 6144
  s_cselect_b32 s63, 0, s63
  buffer_load_dwordx4 v[16:19], v90, s[48:51], s68 offen sc1
  buffer_load_dwordx4 v[20:23], v90, s[52:55], s68 offen sc1
  v_add_u32 v89, s61, v95
  s_add_u32 s61, s61, 1024
  s_cmp_eq_u32 s61, 6144
  s_cselect_b32 s61, 0, s61
  buffer_load_dwordx4 v[56:59], v89, s[44:47], s69 offen sc1
  buffer_load_dwordx4 v[60:63], v89, s[44:47], s70 offen sc1
  buffer_load_dwordx4 v[64:67], v89, s[44:47], s71 offen sc1
  s_waitcnt vmcnt(15)
  v_mfma_f32_32x32x16_bf16 a[0:15], a[108:111], v[24:27], a[0:15]
  v_mfma_f32_32x32x16_bf16 a[16:31], a[108:111], v[28:31], a[16:31]
  v_mfma_f32_32x32x16_bf16 a[32:47], a[112:115], v[24:27], a[32:47]
  v_mfma_f32_32x32x16_bf16 a[48:63], a[112:115], v[28:31], a[48:63]
  v_mfma_f32_32x32x16_bf16 a[64:79], a[116:119], v[24:27], a[64:79]
  v_mfma_f32_32x32x16_bf16 a[80:95], a[116:119], v[28:31], a[80:95]
  v_add_u32 v90, s63, v88
  s_add_u32 s63, s63, 1024
  s_cmp_eq_u32 s63, 6144
  s_cselect_b32 s63, 0, s63
  buffer_load_dwordx4 v[24:27], v90, s[48:51], s68 offen sc1
  buffer_load_dwordx4 v[28:31], v90, s[52:55], s68 offen sc1
  v_add_u32 v89, s61, v95
  s_add_u32 s61, s61, 1024
  s_cmp_eq_u32 s61, 6144
  s_cselect_b32 s61, 0, s61
  buffer_load_dwordx4 v[68:71], v89, s[44:47], s69 offen sc1
  buffer_load_dwordx4 v[72:75], v89, s[44:47], s70 offen sc1
  buffer_load_dwordx4 v[76:79], v89, s[44:47], s71 offen sc1
  s_waitcnt vmcnt(15)
  v_mfma_f32_32x32x16_bf16 a[0:15], v[32:35], v[0:3], a[0:15]
  v_mfma_f32_32x32x16_bf16 a[16:31], v[32:35], v[4:7], a[16:31]
  v_mfma_f32_32x32x16_bf16 a[32:47], v[36:39], v[0:3], a[32:47]
  v_mfma_f32_32x32x16_bf16 a[48:63], v[36:39], v[4:7], a[48:63]
  v_mfma_f32_32x32x16_bf16 a[64:79], v[40:43], v[0:3], a[64:79]
  v_mfma_f32_32x32x16_bf16 a[80:95], v[40:43], v[4:7], a[80:95]
  v_add_u32 v90, s63, v88
  s_add_u32 s63, s63, 1024
  s_cmp_eq_u32 s63, 6144
  s_cselect_b32 s63, 0, s63
  buffer_load_dwordx4 v[0:3], v90, s[48:51], s68 offen sc1
  buffer_load_dwordx4 v[4:7], v90, s[52:55], s68 offen sc1
  v_add_u32 v89, s61, v95
  s_add_u32 s61, s61, 1024
  s_cmp_eq_u32 s61, 6144
  s_cselect_b32 s61, 0, s61
  buffer_load_dwordx4 v[96:99], v89, s[44:47], s69 offen sc1
  buffer_load_dwordx4 v[100:103], v89, s[44:47], s70 offen sc1
  buffer_load_dwordx4 v[104:107], v89, s[44:47], s71 offen sc1
  s_waitcnt vmcnt(15)
  v_mfma_f32_32x32x16_bf16 a[0:15], v[44:47], v[8:11], a[0:15]
  v_mfma_f32_32x32x16_bf16 a[16:31], v[44:47], v[12:15], a[16:31]
  v_mfma_f32_32x32x16_bf16 a[32:47], v[48:51], v[8:11], a[32:47]
  v_mfma_f32_32x32x16_bf16 a[48:63], v[48:51], v[12:15], a[48:63]
  v_mfma_f32_32x32x16_bf16 a[64:79], v[52:55], v[8:11], a[64:79]
  v_mfma_f32_32x32x16_bf16 a[80:95], v[52:55], v[12:15], a[80:95]
  v_add_u32 v90, s63, v88
  s_add_u32 s63, s63, 1024
  s_cmp_eq_u32 s63, 6144
  s_cselect_b32 s63, 0, s63
  buffer_load_dwordx4 v[8:11], v90, s[48:51], s68 offen sc1
  buffer_load_dwordx4 v[12:15], v90, s[52:55], s68 offen sc1
  v_add_u32 v89, s61, v95
  s_add_u32 s61, s61, 1024
  s_cmp_eq_u32 s61, 6144
  s_cselect_b32 s61, 0, s61
  buffer_load_dwordx4 v[108:111], v89, s[44:47], s69 offen sc1
  buffer_load_dwordx4 v[112:115], v89, s[44:47], s70 offen sc1
  buffer_load_dwordx4 v[116:119], v89, s[44:47], s71 offen sc1
  s_waitcnt vmcnt(15)
  v_mfma_f32_32x32x16_bf16 a[0:15], v[56:59], v[16:19], a[0:15]
  v_mfma_f32_32x32x16_bf16 a[16:31], v[56:59], v[20:23], a[16:31]
  v_mfma_f32_32x32x16_bf16 a[32:47], v[60:63], v[16:19], a[32:47]
  v_mfma_f32_32x32x16_bf16 a[48:63], v[60:63], v[20:23], a[48:63]
  v_mfma_f32_32x32x16_bf16 a[64:79], v[64:67], v[16:19], a[64:79]
  v_mfma_f32_32x32x16_bf16 a[80:95], v[64:67], v[20:23], a[80:95]
  s_waitcnt vmcnt(10)
  v_mfma_f32_32x32x16_bf16 a[0:15], v[68:71], v[24:27], a[0:15]
  v_mfma_f32_32x32x16_bf16 a[16:31], v[68:71], v[28:31], a[16:31]
  v_mfma_f32_32x32x16_bf16 a[32:47], v[72:75], v[24:27], a[32:47]
  v_mfma_f32_32x32x16_bf16 a[48:63], v[72:75], v[28:31], a[48:63]
  v_mfma_f32_32x32x16_bf16 a[64:79], v[76:79], v[24:27], a[64:79]
  v_mfma_f32_32x32x16_bf16 a[80:95], v[76:79], v[28:31], a[80:95]
  s_waitcnt vmcnt(5)
  v_mfma_f32_32x32x16_bf16 a[0:15], v[96:99], v[0:3], a[0:15]
  v_mfma_f32_32x32x16_bf16 a[16:31], v[96:99], v[4:7], a[16:31]
  v_mfma_f32_32x32x16_bf16 a[32:47], v[100:103], v[0:3], a[32:47]
  v_mfma_f32_32x32x16_bf16 a[48:63], v[100:103], v[4:7], a[48:63]
  v_mfma_f32_32x32x16_bf16 a[64:79], v[104:107], v[0:3], a[64:79]
  v_mfma_f32_32x32x16_bf16 a[80:95], v[104:107], v[4:7], a[80:95]
  s_waitcnt vmcnt(0)
  v_mfma_f32_32x32x16_bf16 a[0:15], v[108:111], v[8:11], a[0:15]
  v_mfma_f32_32x32x16_bf16 a[16:31], v[108:111], v[12:15], a[16:31]
  v_mfma_f32_32x32x16_bf16 a[32:47], v[112:115], v[8:11], a[32:47]
  v_mfma_f32_32x32x16_bf16 a[48:63], v[112:115], v[12:15], a[48:63]
  v_mfma_f32_32x32x16_bf16 a[64:79], v[116:119], v[8:11], a[64:79]
  v_mfma_f32_32x32x16_bf16 a[80:95], v[116:119], v[12:15], a[80:95]
L_kg_fast_27e:
  s_mov_b32 s80, 0x8000000
L_kg_w_30:
  ds_read_b32 v122, v120 offset:12
  s_waitcnt lgkmcnt(0)
  v_readfirstlane_b32 s57, v122
  s_nop 0
  s_cmp_ge_u32 s57, 4
  s_cbranch_scc1 L_kg_w_30_d
  s_sleep 1
  s_sub_u32 s80, s80, 1
  s_cbranch_scc0 L_kg_w_30
L_kg_w_30_d:
  ds_write_b128 v82, a[4:7] offset:0
  ds_write_b128 v82, a[20:23] offset:1024
  ds_write_b128 v82, a[36:39] offset:2048
  ds_write_b128 v82, a[52:55] offset:3072
  ds_write_b128 v82, a[68:71] offset:4096
  ds_write_b128 v82, a[84:87] offset:5120
  ds_write_b128 v83, a[8:11] offset:0
  ds_write_b128 v83, a[24:27] offset:1024
  ds_write_b128 v83, a[40:43] offset:2048
  ds_write_b128 v83, a[56:59] offset:3072
  ds_write_b128 v83, a[72:75] offset:4096
  ds_write_b128 v83, a[88:91] offset:5120
  ds_write_b128 v84, a[12:15] offset:0
  ds_write_b128 v84, a[28:31] offset:1024
  ds_write_b128 v84, a[44:47] offset:2048
  ds_write_b128 v84, a[60:63] offset:3072
  ds_write_b128 v84, a[76:79] offset:4096
  ds_write_b128 v84, a[92:95] offset:5120
  s_mov_b64 exec, 1
  v_mov_b32 v121, 1
  ds_add_u32 v120, v121 offset:28
  s_mov_b64 exec, -1
  v_accvgpr_read_b32 v96, a0
  v_accvgpr_read_b32 v97, a1
  v_accvgpr_read_b32 v98, a2
  v_accvgpr_read_b32 v99, a3
  v_accvgpr_read_b32 v100, a16
  v_accvgpr_read_b32 v101, a17
  v_accvgpr_read_b32 v102, a18
  v_accvgpr_read_b32 v103, a19
  v_accvgpr_read_b32 v104, a32
  v_accvgpr_read_b32 v105, a33
  v_accvgpr_read_b32 v106, a34
  v_accvgpr_read_b32 v107, a35
  v_accvgpr_read_b32 v108, a48
  v_accvgpr_read_b32 v109, a49
  v_accvgpr_read_b32 v110, a50
  v_accvgpr_read_b32 v111, a51
  v_accvgpr_read_b32 v112, a64
  v_accvgpr_read_b32 v113, a65
  v_accvgpr_read_b32 v114, a66
  v_accvgpr_read_b32 v115, a67
  v_accvgpr_read_b32 v116, a80
  v_accvgpr_read_b32 v117, a81
  v_accvgpr_read_b32 v118, a82
  v_accvgpr_read_b32 v119, a83
  s_mov_b32 s80, 0x8000000
L_kg_w_31:
  ds_read_b32 v122, v120 offset:28
  s_waitcnt lgkmcnt(0)
  v_readfirstlane_b32 s57, v122
  s_nop 0
  s_cmp_ge_u32 s57, 4
  s_cbranch_scc1 L_kg_w_31_d
  s_sleep 1
  s_sub_u32 s80, s80, 1
  s_cbranch_scc0 L_kg_w_31
L_kg_w_31_d:
  ds_read_b128 v[0:3], v85 offset:0
  ds_read_b128 v[4:7], v85 offset:1024
  ds_read_b128 v[8:11], v85 offset:2048
  ds_read_b128 v[12:15], v85 offset:3072
  ds_read_b128 v[16:19], v85 offset:4096
  ds_read_b128 v[20:23], v85 offset:5120
  ds_read_b128 v[24:27], v85 offset:6144
  ds_read_b128 v[28:31], v85 offset:7168
  ds_read_b128 v[32:35], v85 offset:8192
  ds_read_b128 v[36:39], v85 offset:9216
  ds_read_b128 v[40:43], v85 offset:10240
  ds_read_b128 v[44:47], v85 offset:11264
  ds_read_b128 v[48:51], v85 offset:12288
  ds_read_b128 v[52:55], v85 offset:13312
  ds_read_b128 v[56:59], v85 offset:14336
  ds_read_b128 v[60:63], v85 offset:15360
  ds_read_b128 v[64:67], v85 offset:16384
  ds_read_b128 v[68:71], v85 offset:17408
  s_waitcnt lgkmcnt(12)
  v_pk_add_f32 v[96:97], v[96:97], v[0:1]
  v_pk_add_f32 v[98:99], v[98:99], v[2:3]
  v_pk_add_f32 v[100:101], v[100:101], v[4:5]
  v_pk_add_f32 v[102:103], v[102:103], v[6:7]
  v_pk_add_f32 v[104:105], v[104:105], v[8:9]
  v_pk_add_f32 v[106:107], v[106:107], v[10:11]
  v_pk_add_f32 v[108:109], v[108:109], v[12:13]
  v_pk_add_f32 v[110:111], v[110:111], v[14:15]
  v_pk_add_f32 v[112:113], v[112:113], v[16:17]
  v_pk_add_f32 v[114:115], v[114:115], v[18:19]
  v_pk_add_f32 v[116:117], v[116:117], v[20:21]
  v_pk_add_f32 v[118:119], v[118:119], v[22:23]
  s_waitcnt lgkmcnt(6)
  v_pk_add_f32 v[96:97], v[96:97], v[24:25]
  v_pk_add_f32 v[98:99], v[98:99], v[26:27]
  v_pk_add_f32 v[100:101], v[100:101], v[28:29]
  v_pk_add_f32 v[102:103], v[102:103], v[30:31]
  v_pk_add_f32 v[104:105], v[104:105], v[32:33]
  v_pk_add_f32 v[106:107], v[106:107], v[34:35]
  v_pk_add_f32 v[108:109], v[108:109], v[36:37]
  v_pk_add_f32 v[110:111], v[110:111], v[38:39]
  v_pk_add_f32 v[112:113], v[112:113], v[40:41]
  v_pk_add_f32 v[114:115], v[114:115], v[42:43]
  v_pk_add_f32 v[116:117], v[116:117], v[44:45]
  v_pk_add_f32 v[118:119], v[118:119], v[46:47]
  s_waitcnt lgkmcnt(0)
  v_pk_add_f32 v[96:97], v[96:97], v[48:49]
  v_pk_add_f32 v[98:99], v[98:99], v[50:51]
  v_pk_add_f32 v[100:101], v[100:101], v[52:53]
  v_pk_add_f32 v[102:103], v[102:103], v[54:55]
  v_pk_add_f32 v[104:105], v[104:105], v[56:57]
  v_pk_add_f32 v[106:107], v[106:107], v[58:59]
  v_pk_add_f32 v[108:109], v[108:109], v[60:61]
  v_pk_add_f32 v[110:111], v[110:111], v[62:63]
  v_pk_add_f32 v[112:113], v[112:113], v[64:65]
  v_pk_add_f32 v[114:115], v[114:115], v[66:67]
  v_pk_add_f32 v[116:117], v[116:117], v[68:69]
  v_pk_add_f32 v[118:119], v[118:119], v[70:71]
  v_mov_b32 v72, 0xbfb8aa3b
  v_mov_b32 v74, 1.0
  v_pk_mul_f32 v[0:1], v[96:97], v[72:73] op_sel_hi:[1,0]
  v_pk_mul_f32 v[2:3], v[98:99], v[72:73] op_sel_hi:[1,0]
  v_pk_mul_f32 v[4:5], v[100:101], v[72:73] op_sel_hi:[1,0]
  v_pk_mul_f32 v[6:7], v[102:103], v[72:73] op_sel_hi:[1,0]
  v_pk_mul_f32 v[8:9], v[104:105], v[72:73] op_sel_hi:[1,0]
  v_pk_mul_f32 v[10:11], v[106:107], v[72:73] op_sel_hi:[1,0]
  v_pk_mul_f32 v[12:13], v[108:109], v[72:73] op_sel_hi:[1,0]
  v_pk_mul_f32 v[14:15], v[110:111], v[72:73] op_sel_hi:[1,0]
  v_pk_mul_f32 v[16:17], v[112:113], v[72:73] op_sel_hi:[1,0]
  v_pk_mul_f32 v[18:19], v[114:115], v[72:73] op_sel_hi:[1,0]
  v_pk_mul_f32 v[20:21], v[116:117], v[72:73] op_sel_hi:[1,0]
  v_pk_mul_f32 v[22:23], v[118:119], v[72:73] op_sel_hi:[1,0]
  v_exp_f32 v0, v0
  v_exp_f32 v1, v1
  v_exp_f32 v2, v2
  v_exp_f32 v3, v3
  v_exp_f32 v4, v4
  v_exp_f32 v5, v5
  v_exp_f32 v6, v6
  v_exp_f32 v7, v7
  v_exp_f32 v8, v8
  v_exp_f32 v9, v9
  v_exp_f32 v10, v10
  v_exp_f32 v11, v11
  v_exp_f32 v12, v12
  v_exp_f32 v13, v13
  v_exp_f32 v14, v14
  v_exp_f32 v15, v15
  v_exp_f32 v16, v16
  v_exp_f32 v17, v17
  v_exp_f32 v18, v18
  v_exp_f32 v19, v19
  v_exp_f32 v20, v20
  v_exp_f32 v21, v21
  v_exp_f32 v22, v22
  v_exp_f32 v23, v23
  v_pk_add_f32 v[0:1], v[0:1], v[74:75] op_sel_hi:[1,0]
  v_pk_add_f32 v[2:3], v[2:3], v[74:75] op_sel_hi:[1,0]
  v_pk_add_f32 v[4:5], v[4:5], v[74:75] op_sel_hi:[1,0]
  v_pk_add_f32 v[6:7], v[6:7], v[74:75] op_sel_hi:[1,0]
  v_pk_add_f32 v[8:9], v[8:9], v[74:75] op_sel_hi:[1,0]
  v_pk_add_f32 v[10:11], v[10:11], v[74:75] op_sel_hi:[1,0]
  v_pk_add_f32 v[12:13], v[12:13], v[74:75] op_sel_hi:[1,0]
  v_pk_add_f32 v[14:15], v[14:15], v[74:75] op_sel_hi:[1,0]
  v_pk_add_f32 v[16:17], v[16:17], v[74:75] op_sel_hi:[1,0]
  v_pk_add_f32 v[18:19], v[18:19], v[74:75] op_sel_hi:[1,0]
  v_pk_add_f32 v[20:21], v[20:21], v[74:75] op_sel_hi:[1,0]
  v_pk_add_f32 v[22:23], v[22:23], v[74:75] op_sel_hi:[1,0]
  v_rcp_f32 v0, v0
  v_rcp_f32 v1, v1
  v_rcp_f32 v2, v2
  v_rcp_f32 v3, v3
  v_rcp_f32 v4, v4
  v_rcp_f32 v5, v5
  v_rcp_f32 v6, v6
  v_rcp_f32 v7, v7
  v_rcp_f32 v8, v8
  v_rcp_f32 v9, v9
  v_rcp_f32 v10, v10
  v_rcp_f32 v11, v11
  v_rcp_f32 v12, v12
  v_rcp_f32 v13, v13
  v_rcp_f32 v14, v14
  v_rcp_f32 v15, v15
  v_rcp_f32 v16, v16
  v_rcp_f32 v17, v17
  v_rcp_f32 v18, v18
  v_rcp_f32 v19, v19
  v_rcp_f32 v20, v20
  v_rcp_f32 v21, v21
  v_rcp_f32 v22, v22
  v_rcp_f32 v23, v23
  v_pk_mul_f32 v[0:1], v[0:1], v[96:97]
  v_pk_mul_f32 v[2:3], v[2:3], v[98:99]
  v_pk_mul_f32 v[4:5], v[4:5], v[100:101]
  v_pk_mul_f32 v[6:7], v[6:7], v[102:103]
  v_pk_mul_f32 v[8:9], v[8:9], v[104:105]
  v_pk_mul_f32 v[10:11], v[10:11], v[106:107]
  v_pk_mul_f32 v[12:13], v[12:13], v[108:109]
  v_pk_mul_f32 v[14:15], v[14:15], v[110:111]
  v_pk_mul_f32 v[16:17], v[16:17], v[112:113]
  v_pk_mul_f32 v[18:19], v[18:19], v[114:115]
  v_pk_mul_f32 v[20:21], v[20:21], v[116:117]
  v_pk_mul_f32 v[22:23], v[22:23], v[118:119]
  v_cvt_pk_bf16_f32 v32, v0, v1
  v_cvt_pk_bf16_f32 v33, v2, v3
  v_cvt_pk_bf16_f32 v34, v4, v5
  v_cvt_pk_bf16_f32 v35, v6, v7
  v_cvt_pk_bf16_f32 v36, v8, v9
  v_cvt_pk_bf16_f32 v37, v10, v11
  v_cvt_pk_bf16_f32 v38, v12, v13
  v_cvt_pk_bf16_f32 v39, v14, v15
  v_cvt_pk_bf16_f32 v40, v16, v17
  v_cvt_pk_bf16_f32 v41, v18, v19
  v_cvt_pk_bf16_f32 v42, v20, v21
  v_cvt_pk_bf16_f32 v43, v22, v23
  ds_write_b64 v86, v[32:33] offset:0
  ds_write_b64 v86, v[34:35] offset:1536
  ds_write_b64 v86, v[36:37] offset:16
  ds_write_b64 v86, v[38:39] offset:1552
  ds_write_b64 v86, v[40:41] offset:32
  ds_write_b64 v86, v[42:43] offset:1568
  s_waitcnt lgkmcnt(0)
  s_barrier
  s_branch L_kg_f_end
L_kg_g2:
  buffer_load_dword v91, v81, s[40:43], s72 offen sc1
  v_add_u32 v89, s60, v95
  s_add_u32 s60, s60, 1024
  s_cmp_eq_u32 s60, 8192
  s_cselect_b32 s60, 0, s60
  buffer_load_dwordx4 v[32:35], v89, s[44:47], s69 offen sc1
  buffer_load_dwordx4 v[36:39], v89, s[44:47], s70 offen sc1
  v_add_u32 v89, s60, v95
  s_add_u32 s60, s60, 1024
  s_cmp_eq_u32 s60, 8192
  s_cselect_b32 s60, 0, s60
  buffer_load_dwordx4 v[44:47], v89, s[44:47], s69 offen sc1
  buffer_load_dwordx4 v[48:51], v89, s[44:47], s70 offen sc1
  v_add_u32 v89, s60, v95
  s_add_u32 s60, s60, 1024
  s_cmp_eq_u32 s60, 8192
  s_cselect_b32 s60, 0, s60
  buffer_load_dwordx4 v[56:59], v89, s[44:47], s69 offen sc1
  buffer_load_dwordx4 v[60:63], v89, s[44:47], s70 offen sc1
  v_add_u32 v89, s60, v95
  s_add_u32 s60, s60, 1024
  s_cmp_eq_u32 s60, 8192
  s_cselect_b32 s60, 0, s60
  buffer_load_dwordx4 v[68:71], v89, s[44:47], s69 offen sc1
  buffer_load_dwordx4 v[72:75], v89, s[44:47], s70 offen sc1
  s_waitcnt vmcnt(8)
  v_cmp_eq_u32 vcc, 0, v91
  s_nop 4
  s_cbranch_vccz L_kg_fast_320
  s_mov_b32 s80, 0x200000
  L_kg_g_33:
  buffer_load_dword v122, v81, s[40:43], s72 offen sc1
  s_waitcnt vmcnt(0)
  v_cmp_gt_u32 vcc, 1, v122
  s_nop 4
  s_cbranch_vccz L_kg_g_33_d
  s_sleep 1
  s_sub_u32 s80, s80, 1
  s_cbranch_scc0 L_kg_g_33
  L_kg_g_33_d:
L_kg_fast_320:
  v_add_u32 v90, s62, v88
  s_add_u32 s62, s62, 1024
  s_cmp_eq_u32 s62, 8192
  s_cselect_b32 s62, 0, s62
  buffer_load_dwordx4 v[0:3], v90, s[48:51], s68 offen sc1
  buffer_load_dwordx4 v[4:7], v90, s[52:55], s68 offen sc1
  v_add_u32 v90, s62, v88
  s_add_u32 s62, s62, 1024
  s_cmp_eq_u32 s62, 8192
  s_cselect_b32 s62, 0, s62
  buffer_load_dwordx4 v[8:11], v90, s[48:51], s68 offen sc1
  buffer_load_dwordx4 v[12:15], v90, s[52:55], s68 offen sc1
  v_add_u32 v90, s62, v88
  s_add_u32 s62, s62, 1024
  s_cmp_eq_u32 s62, 8192
  s_cselect_b32 s62, 0, s62
  buffer_load_dwordx4 v[16:19], v90, s[48:51], s68 offen sc1
  buffer_load_dwordx4 v[20:23], v90, s[52:55], s68 offen sc1
  v_add_u32 v90, s62, v88
  s_add_u32 s62, s62, 1024
  s_cmp_eq_u32 s62, 8192
  s_cselect_b32 s62, 0, s62
  buffer_load_dwordx4 v[24:27], v90, s[48:51], s68 offen sc1
  buffer_load_dwordx4 v[28:31], v90, s[52:55], s68 offen sc1
  s_waitcnt vmcnt(6)
  v_mfma_f32_32x32x16_bf16 a[0:15], v[32:35], v[0:3], 0
  v_mfma_f32_32x32x16_bf16 a[16:31], v[32:35], v[4:7], 0
  v_mfma_f32_32x32x16_bf16 a[32:47], v[36:39], v[0:3], 0
  v_mfma_f32_32x32x16_bf16 a[48:63], v[36:39], v[4:7], 0
  v_add_u32 v90, s62, v88
  s_add_u32 s62, s62, 1024
  s_cmp_eq_u32 s62, 8192
  s_cselect_b32 s62, 0, s62
  buffer_load_dwordx4 v[0:3], v90, s[48:51], s68 offen sc1
  buffer_load_dwordx4 v[4:7], v90, s[52:55], s68 offen sc1
  v_add_u32 v89, s60, v95
  s_add_u32 s60, s60, 1024
  s_cmp_eq_u32 s60, 8192
  s_cselect_b32 s60, 0, s60
  buffer_load_dwordx4 v[96:99], v89, s[44:47], s69 offen sc1
  buffer_load_dwordx4 v[100:103], v89, s[44:47], s70 offen sc1
  s_waitcnt vmcnt(8)
  v_mfma_f32_32x32x16_bf16 a[0:15], v[44:47], v[8:11], a[0:15]
  v_mfma_f32_32x32x16_bf16 a[16:31], v[44:47], v[12:15], a[16:31]
  v_mfma_f32_32x32x16_bf16 a[32:47], v[48:51], v[8:11], a[32:47]
  v_mfma_f32_32x32x16_bf16 a[48:63], v[48:51], v[12:15], a[48:63]
  v_add_u32 v90, s62, v88
  s_add_u32 s62, s62, 1024
  s_cmp_eq_u32 s62, 8192
  s_cselect_b32 s62, 0, s62
  buffer_load_dwordx4 v[8:11], v90, s[48:51], s68 offen sc1
  buffer_load_dwordx4 v[12:15], v90, s[52:55], s68 offen sc1
  v_add_u32 v89, s60, v95
  s_add_u32 s60, s60, 1024
  s_cmp_eq_u32 s60, 8192
  s_cselect_b32 s60, 0, s60
  buffer_load_dwordx4 v[108:111], v89, s[44:47], s69 offen sc1
  buffer_load_dwordx4 v[112:115], v89, s[44:47], s70 offen sc1
  s_waitcnt vmcnt(10)
  v_mfma_f32_32x32x16_bf16 a[0:15], v[56:59], v[16:19], a[0:15]
  v_mfma_f32_32x32x16_bf16 a[16:31], v[56:59], v[20:23], a[16:31]
  v_mfma_f32_32x32x16_bf16 a[32:47], v[60:63], v[16:19], a[32:47]
  v_mfma_f32_32x32x16_bf16 a[48:63], v[60:63], v[20:23], a[48:63]
  buffer_load_dword v91, v87, s[40:43], s72 offen sc1
  v_add_u32 v90, s62, v88
  s_add_u32 s62, s62, 1024
  s_cmp_eq_u32 s62, 8192
  s_cselect_b32 s62, 0, s62
  buffer_load_dwordx4 v[16:19], v90, s[48:51], s68 offen sc1
  buffer_load_dwordx4 v[20:23], v90, s[52:55], s68 offen sc1
  v_add_u32 v89, s60, v95
  s_add_u32 s60, s60, 1024
  s_cmp_eq_u32 s60, 8192
  s_cselect_b32 s60, 0, s60
  buffer_load_dwordx4 a[96:99], v89, s[44:47], s69 offen sc1
  buffer_load_dwordx4 a[100:103], v89, s[44:47], s70 offen sc1
  s_waitcnt vmcnt(13)
  v_mfma_f32_32x32x16_bf16 a[0:15], v[68:71], v[24:27], a[0:15]
  v_mfma_f32_32x32x16_bf16 a[16:31], v[68:71], v[28:31], a[16:31]
  v_mfma_f32_32x32x16_bf16 a[32:47], v[72:75], v[24:27], a[32:47]
  v_mfma_f32_32x32x16_bf16 a[48:63], v[72:75], v[28:31], a[48:63]
  v_add_u32 v90, s62, v88
  s_add_u32 s62, s62, 1024
  s_cmp_eq_u32 s62, 8192
  s_cselect_b32 s62, 0, s62
  buffer_load_dwordx4 v[24:27], v90, s[48:51], s68 offen sc1
  buffer_load_dwordx4 v[28:31], v90, s[52:55], s68 offen sc1
  v_add_u32 v89, s60, v95
  s_add_u32 s60, s60, 1024
  s_cmp_eq_u32 s60, 8192
  s_cselect_b32 s60, 0, s60
  buffer_load_dwordx4 a[108:111], v89, s[44:47], s69 offen sc1
  buffer_load_dwordx4 a[112:115], v89, s[44:47], s70 offen sc1
  s_waitcnt vmcnt(8)
  v_cmp_eq_u32 vcc, 0, v91
  s_nop 4
  s_cbranch_vccz L_kg_fast_32
  v_mfma_f32_32x32x16_bf16 a[0:15], v[96:99], v[0:3], a[0:15]
  v_mfma_f32_32x32x16_bf16 a[16:31], v[96:99], v[4:7], a[16:31]
  v_mfma_f32_32x32x16_bf16 a[32:47], v[100:103], v[0:3], a[32:47]
  v_mfma_f32_32x32x16_bf16 a[48:63], v[100:103], v[4:7], a[48:63]
  s_sub_u32 s69, s69, s64
  s_sub_u32 s70, s70, s64
  v_add_u32 v89, s61, v95
  s_add_u32 s61, s61, 1024
  s_cmp_eq_u32 s61, 6144
  s_cselect_b32 s61, 0, s61
  buffer_load_dwordx4 v[32:35], v89, s[44:47], s69 offen sc1
  buffer_load_dwordx4 v[36:39], v89, s[44:47], s70 offen sc1
  v_mfma_f32_32x32x16_bf16 a[0:15], v[108:111], v[8:11], a[0:15]
  v_mfma_f32_32x32x16_bf16 a[16:31], v[108:111], v[12:15], a[16:31]
  v_mfma_f32_32x32x16_bf16 a[32:47], v[112:115], v[8:11], a[32:47]
  v_mfma_f32_32x32x16_bf16 a[48:63], v[112:115], v[12:15], a[48:63]
  v_add_u32 v89, s61, v95
  s_add_u32 s61, s61, 1024
  s_cmp_eq_u32 s61, 6144
  s_cselect_b32 s61, 0, s61
  buffer_load_dwordx4 v[44:47], v89, s[44:47], s69 offen sc1
  buffer_load_dwordx4 v[48:51], v89, s[44:47], s70 offen sc1
  s_waitcnt vmcnt(8)
  v_mfma_f32_32x32x16_bf16 a[0:15], a[96:99], v[16:19], a[0:15]
  v_mfma_f32_32x32x16_bf16 a[16:31], a[96:99], v[20:23], a[16:31]
  v_mfma_f32_32x32x16_bf16 a[32:47], a[100:103], v[16:19], a[32:47]
  v_mfma_f32_32x32x16_bf16 a[48:63], a[100:103], v[20:23], a[48:63]
  v_add_u32 v89, s61, v95
  s_add_u32 s61, s61, 1024
  s_cmp_eq_u32 s61, 6144
  s_cselect_b32 s61, 0, s61
  buffer_load_dwordx4 v[56:59], v89, s[44:47], s69 offen sc1
  buffer_load_dwordx4 v[60:63], v89, s[44:47], s70 offen sc1
  s_waitcnt vmcnt(6)
  v_mfma_f32_32x32x16_bf16 a[0:15], a[108:111], v[24:27], a[0:15]
  v_mfma_f32_32x32x16_bf16 a[16:31], a[108:111], v[28:31], a[16:31]
  v_mfma_f32_32x32x16_bf16 a[32:47], a[112:115], v[24:27], a[32:47]
  v_mfma_f32_32x32x16_bf16 a[48:63], a[112:115], v[28:31], a[48:63]
  v_add_u32 v89, s61, v95
  s_add_u32 s61, s61, 1024
  s_cmp_eq_u32 s61, 6144
  s_cselect_b32 s61, 0, s61
  buffer_load_dwordx4 v[68:71], v89, s[44:47], s69 offen sc1
  buffer_load_dwordx4 v[72:75], v89, s[44:47], s70 offen sc1
  s_mov_b32 s80, 0x200000
  L_kg_g_34:
  buffer_load_dword v122, v87, s[40:43], s72 offen sc1
  s_waitcnt vmcnt(0)
  v_cmp_gt_u32 vcc, 1, v122
  s_nop 4
  s_cbranch_vccz L_kg_g_34_d
  s_sleep 1
  s_sub_u32 s80, s80, 1
  s_cbranch_scc0 L_kg_g_34
  L_kg_g_34_d:
  s_sub_u32 s68, s68, s64
  v_add_u32 v90, s63, v88
  s_add_u32 s63, s63, 1024
  s_cmp_eq_u32 s63, 6144
  s_cselect_b32 s63, 0, s63
  buffer_load_dwordx4 v[0:3], v90, s[48:51], s68 offen sc1
  buffer_load_dwordx4 v[4:7], v90, s[52:55], s68 offen sc1
  v_add_u32 v90, s63, v88
  s_add_u32 s63, s63, 1024
  s_cmp_eq_u32 s63, 6144
  s_cselect_b32 s63, 0, s63
  buffer_load_dwordx4 v[8:11], v90, s[48:51], s68 offen sc1
  buffer_load_dwordx4 v[12:15], v90, s[52:55], s68 offen sc1
  v_add_u32 v90, s63, v88
  s_add_u32 s63, s63, 1024
  s_cmp_eq_u32 s63, 6144
  s_cselect_b32 s63, 0, s63
  buffer_load_dwordx4 v[16:19], v90, s[48:51], s68 offen sc1
  buffer_load_dwordx4 v[20:23], v90, s[52:55], s68 offen sc1
  v_add_u32 v90, s63, v88
  s_add_u32 s63, s63, 1024
  s_cmp_eq_u32 s63, 6144
  s_cselect_b32 s63, 0, s63
  buffer_load_dwordx4 v[24:27], v90, s[48:51], s68 offen sc1
  buffer_load_dwordx4 v[28:31], v90, s[52:55], s68 offen sc1
  s_waitcnt vmcnt(6)
  v_mfma_f32_32x32x16_bf16 a[0:15], v[32:35], v[0:3], a[0:15]
  v_mfma_f32_32x32x16_bf16 a[16:31], v[32:35], v[4:7], a[16:31]
  v_mfma_f32_32x32x16_bf16 a[32:47], v[36:39], v[0:3], a[32:47]
  v_mfma_f32_32x32x16_bf16 a[48:63], v[36:39], v[4:7], a[48:63]
  v_add_u32 v90, s63, v88
  s_add_u32 s63, s63, 1024
  s_cmp_eq_u32 s63, 6144
  s_cselect_b32 s63, 0, s63
  buffer_load_dwordx4 v[0:3], v90, s[48:51], s68 offen sc1
  buffer_load_dwordx4 v[4:7], v90, s[52:55], s68 offen sc1
  v_add_u32 v89, s61, v95
  s_add_u32 s61, s61, 1024
  s_cmp_eq_u32 s61, 6144
  s_cselect_b32 s61, 0, s61
  buffer_load_dwordx4 v[96:99], v89, s[44:47], s69 offen sc1
  buffer_load_dwordx4 v[100:103], v89, s[44:47], s70 offen sc1
  s_waitcnt vmcnt(8)
  v_mfma_f32_32x32x16_bf16 a[0:15], v[44:47], v[8:11], a[0:15]
  v_mfma_f32_32x32x16_bf16 a[16:31], v[44:47], v[12:15], a[16:31]
  v_mfma_f32_32x32x16_bf16 a[32:47], v[48:51], v[8:11], a[32:47]
  v_mfma_f32_32x32x16_bf16 a[48:63], v[48:51], v[12:15], a[48:63]
  v_add_u32 v90, s63, v88
  s_add_u32 s63, s63, 1024
  s_cmp_eq_u32 s63, 6144
  s_cselect_b32 s63, 0, s63
  buffer_load_dwordx4 v[8:11], v90, s[48:51], s68 offen sc1
  buffer_load_dwordx4 v[12:15], v90, s[52:55], s68 offen sc1
  v_add_u32 v89, s61, v95
  s_add_u32 s61, s61, 1024
  s_cmp_eq_u32 s61, 6144
  s_cselect_b32 s61, 0, s61
  buffer_load_dwordx4 v[108:111], v89, s[44:47], s69 offen sc1
  buffer_load_dwordx4 v[112:115], v89, s[44:47], s70 offen sc1
  s_waitcnt vmcnt(10)
  v_mfma_f32_32x32x16_bf16 a[0:15], v[56:59], v[16:19], a[0:15]
  v_mfma_f32_32x32x16_bf16 a[16:31], v[56:59], v[20:23], a[16:31]
  v_mfma_f32_32x32x16_bf16 a[32:47], v[60:63], v[16:19], a[32:47]
  v_mfma_f32_32x32x16_bf16 a[48:63], v[60:63], v[20:23], a[48:63]
  s_waitcnt vmcnt(8)
  v_mfma_f32_32x32x16_bf16 a[0:15], v[68:71], v[24:27], a[0:15]
  v_mfma_f32_32x32x16_bf16 a[16:31], v[68:71], v[28:31], a[16:31]
  v_mfma_f32_32x32x16_bf16 a[32:47], v[72:75], v[24:27], a[32:47]
  v_mfma_f32_32x32x16_bf16 a[48:63], v[72:75], v[28:31], a[48:63]
  s_waitcnt vmcnt(4)
  v_mfma_f32_32x32x16_bf16 a[0:15], v[96:99], v[0:3], a[0:15]
  v_mfma_f32_32x32x16_bf16 a[16:31], v[96:99], v[4:7], a[16:31]
  v_mfma_f32_32x32x16_bf16 a[32:47], v[100:103], v[0:3], a[32:47]
  v_mfma_f32_32x32x16_bf16 a[48:63], v[100:103], v[4:7], a[48:63]
  s_waitcnt vmcnt(0)
  v_mfma_f32_32x32x16_bf16 a[0:15], v[108:111], v[8:11], a[0:15]
  v_mfma_f32_32x32x16_bf16 a[16:31], v[108:111], v[12:15], a[16:31]
  v_mfma_f32_32x32x16_bf16 a[32:47], v[112:115], v[8:11], a[32:47]
  v_mfma_f32_32x32x16_bf16 a[48:63], v[112:115], v[12:15], a[48:63]
  s_branch L_kg_fast_32e
L_kg_fast_32:
  v_mfma_f32_32x32x16_bf16 a[0:15], v[96:99], v[0:3], a[0:15]
  v_mfma_f32_32x32x16_bf16 a[16:31], v[96:99], v[4:7], a[16:31]
  v_mfma_f32_32x32x16_bf16 a[32:47], v[100:103], v[0:3], a[32:47]
  v_mfma_f32_32x32x16_bf16 a[48:63], v[100:103], v[4:7], a[48:63]
  s_sub_u32 s68, s68, s64
  v_add_u32 v90, s63, v88
  s_add_u32 s63, s63, 1024
  s_cmp_eq_u32 s63, 6144
  s_cselect_b32 s63, 0, s63
  buffer_load_dwordx4 v[0:3], v90, s[48:51], s68 offen sc1
  buffer_load_dwordx4 v[4:7], v90, s[52:55], s68 offen sc1
  s_sub_u32 s69, s69, s64
  s_sub_u32 s70, s70, s64
  v_add_u32 v89, s61, v95
  s_add_u32 s61, s61, 1024
  s_cmp_eq_u32 s61, 6144
  s_cselect_b32 s61, 0, s61
  buffer_load_dwordx4 v[32:35], v89, s[44:47], s69 offen sc1
  buffer_load_dwordx4 v[36:39], v89, s[44:47], s70 offen sc1
  v_mfma_f32_32x32x16_bf16 a[0:15], v[108:111], v[8:11], a[0:15]
  v_mfma_f32_32x32x16_bf16 a[16:31], v[108:111], v[12:15], a[16:31]
  v_mfma_f32_32x32x16_bf16 a[32:47], v[112:115], v[8:11], a[32:47]
  v_mfma_f32_32x32x16_bf16 a[48:63], v[112:115], v[12:15], a[48:63]
  v_add_u32 v90, s63, v88
  s_add_u32 s63, s63, 1024
  s_cmp_eq_u32 s63, 6144
  s_cselect_b32 s63, 0, s63
  buffer_load_dwordx4 v[8:11], v90, s[48:51], s68 offen sc1
  buffer_load_dwordx4 v[12:15], v90, s[52:55], s68 offen sc1
  v_add_u32 v89, s61, v95
  s_add_u32 s61, s61, 1024
  s_cmp_eq_u32 s61, 6144
  s_cselect_b32 s61, 0, s61
  buffer_load_dwordx4 v[44:47], v89, s[44:47], s69 offen sc1
  buffer_load_dwordx4 v[48:51], v89, s[44:47], s70 offen sc1
  s_waitcnt vmcnt(12)
  v_mfma_f32_32x32x16_bf16 a[0:15], a[96:99], v[16:19], a[0:15]
  v_mfma_f32_32x32x16_bf16 a[16:31], a[96:99], v[20:23], a[16:31]
  v_mfma_f32_32x32x16_bf16 a[32:47], a[100:103], v[16:19], a[32:47]
  v_mfma_f32_32x32x16_bf16 a[48:63], a[100:103], v[20:23], a[48:63]
  v_add_u32 v90, s63, v88
  s_add_u32 s63, s63, 1024
  s_cmp_eq_u32 s63, 6144
  s_cselect_b32 s63, 0, s63
  buffer_load_dwordx4 v[16:19], v90, s[48:51], s68 offen sc1
  buffer_load_dwordx4 v[20:23], v90, s[52:55], s68 offen sc1
  v_add_u32 v89, s61, v95
  s_add_u32 s61, s61, 1024
  s_cmp_eq_u32 s61, 6144
  s_cselect_b32 s61, 0, s61
  buffer_load_dwordx4 v[56:59], v89, s[44:47], s69 offen sc1
  buffer_load_dwordx4 v[60:63], v89, s[44:47], s70 offen sc1
  s_waitcnt vmcnt(12)
  v_mfma_f32_32x32x16_bf16 a[0:15], a[108:111], v[24:27], a[0:15]
  v_mfma_f32_32x32x16_bf16 a[16:31], a[108:111], v[28:31], a[16:31]
  v_mfma_f32_32x32x16_bf16 a[32:47], a[112:115], v[24:27], a[32:47]
  v_mfma_f32_32x32x16_bf16 a[48:63], a[112:115], v[28:31], a[48:63]
  v_add_u32 v90, s63, v88
  s_add_u32 s63, s63, 1024
  s_cmp_eq_u32 s63, 6144
  s_cselect_b32 s63, 0, s63
  buffer_load_dwordx4 v[24:27], v90, s[48:51], s68 offen sc1
  buffer_load_dwordx4 v[28:31], v90, s[52:55], s68 offen sc1
  v_add_u32 v89, s61, v95
  s_add_u32 s61, s61, 1024
  s_cmp_eq_u32 s61, 6144
  s_cselect_b32 s61, 0, s61
  buffer_load_dwordx4 v[68:71], v89, s[44:47], s69 offen sc1
  buffer_load_dwordx4 v[72:75], v89, s[44:47], s70 offen sc1
  s_waitcnt vmcnt(12)
  v_mfma_f32_32x32x16_bf16 a[0:15], v[32:35], v[0:3], a[0:15]
  v_mfma_f32_32x32x16_bf16 a[16:31], v[32:35], v[4:7], a[16:31]
  v_mfma_f32_32x32x16_bf16 a[32:47], v[36:39], v[0:3], a[32:47]
  v_mfma_f32_32x32x16_bf16 a[48:63], v[36:39], v[4:7], a[48:63]
  v_add_u32 v90, s63, v88
  s_add_u32 s63, s63, 1024
  s_cmp_eq_u32 s63, 6144
  s_cselect_b32 s63, 0, s63
  buffer_load_dwordx4 v[0:3], v90, s[48:51], s68 offen sc1
  buffer_load_dwordx4 v[4:7], v90, s[52:55], s68 offen sc1
  v_add_u32 v89, s61, v95
  s_add_u32 s61, s61, 1024
  s_cmp_eq_u32 s61, 6144
  s_cselect_b32 s61, 0, s61
  buffer_load_dwordx4 v[96:99], v89, s[44:47], s69 offen sc1
  buffer_load_dwordx4 v[100:103], v89, s[44:47], s70 offen sc1
  s_waitcnt vmcnt(12)
  v_mfma_f32_32x32x16_bf16 a[0:15], v[44:47], v[8:11], a[0:15]
  v_mfma_f32_32x32x16_bf16 a[16:31], v[44:47], v[12:15], a[16:31]
  v_mfma_f32_32x32x16_bf16 a[32:47], v[48:51], v[8:11], a[32:47]
  v_mfma_f32_32x32x16_bf16 a[48:63], v[48:51], v[12:15], a[48:63]
  v_add_u32 v90, s63, v88
  s_add_u32 s63, s63, 1024
  s_cmp_eq_u32 s63, 6144
  s_cselect_b32 s63, 0, s63
  buffer_load_dwordx4 v[8:11], v90, s[48:51], s68 offen sc1
  buffer_load_dwordx4 v[12:15], v90, s[52:55], s68 offen sc1
  v_add_u32 v89, s61, v95
  s_add_u32 s61, s61, 1024
  s_cmp_eq_u32 s61, 6144
  s_cselect_b32 s61, 0, s61
  buffer_load_dwordx4 v[108:111], v89, s[44:47], s69 offen sc1
  buffer_load_dwordx4 v[112:115], v89, s[44:47], s70 offen sc1
  s_waitcnt vmcnt(12)
  v_mfma_f32_32x32x16_bf16 a[0:15], v[56:59], v[16:19], a[0:15]
  v_mfma_f32_32x32x16_bf16 a[16:31], v[56:59], v[20:23], a[16:31]
  v_mfma_f32_32x32x16_bf16 a[32:47], v[60:63], v[16:19], a[32:47]
  v_mfma_f32_32x32x16_bf16 a[48:63], v[60:63], v[20:23], a[48:63]
  s_waitcnt vmcnt(8)
  v_mfma_f32_32x32x16_bf16 a[0:15], v[68:71], v[24:27], a[0:15]
  v_mfma_f32_32x32x16_bf16 a[16:31], v[68:71], v[28:31], a[16:31]
  v_mfma_f32_32x32x16_bf16 a[32:47], v[72:75], v[24:27], a[32:47]
  v_mfma_f32_32x32x16_bf16 a[48:63], v[72:75], v[28:31], a[48:63]
  s_waitcnt vmcnt(4)
  v_mfma_f32_32x32x16_bf16 a[0:15], v[96:99], v[0:3], a[0:15]
  v_mfma_f32_32x32x16_bf16 a[16:31], v[96:99], v[4:7], a[16:31]
  v_mfma_f32_32x32x16_bf16 a[32:47], v[100:103], v[0:3], a[32:47]
  v_mfma_f32_32x32x16_bf16 a[48:63], v[100:103], v[4:7], a[48:63]
  s_waitcnt vmcnt(0)
  v_mfma_f32_32x32x16_bf16 a[0:15], v[108:111], v[8:11], a[0:15]
  v_mfma_f32_32x32x16_bf16 a[16:31], v[108:111], v[12:15], a[16:31]
  v_mfma_f32_32x32x16_bf16 a[32:47], v[112:115], v[8:11], a[32:47]
  v_mfma_f32_32x32x16_bf16 a[48:63], v[112:115], v[12:15], a[48:63]
L_kg_fast_32e:
  s_mov_b32 s80, 0x8000000
L_kg_w_35:
  ds_read_b32 v122, v120 offset:12
  s_waitcnt lgkmcnt(0)
  v_readfirstlane_b32 s57, v122
  s_nop 0
  s_cmp_ge_u32 s57, 4
  s_cbranch_scc1 L_kg_w_35_d
  s_sleep 1
  s_sub_u32 s80, s80, 1
  s_cbranch_scc0 L_kg_w_35
L_kg_w_35_d:
  s_nop 1
  ds_write_b128 v82, a[4:7] offset:0
  ds_write_b128 v82, a[20:23] offset:1024
  ds_write_b128 v82, a[36:39] offset:2048
  ds_write_b128 v82, a[52:55] offset:3072
  ds_write_b128 v83, a[8:11] offset:0
  ds_write_b128 v83, a[24:27] offset:1024
  ds_write_b128 v83, a[40:43] offset:2048
  ds_write_b128 v83, a[56:59] offset:3072
  ds_write_b128 v84, a[12:15] offset:0
  ds_write_b128 v84, a[28:31] offset:1024
  ds_write_b128 v84, a[44:47] offset:2048
  ds_write_b128 v84, a[60:63] offset:3072
  s_mov_b64 exec, 1
  v_mov_b32 v121, 1
  ds_add_u32 v120, v121 offset:28
  s_mov_b64 exec, -1
  v_accvgpr_read_b32 v96, a0
  v_accvgpr_read_b32 v97, a1
  v_accvgpr_read_b32 v98, a2
  v_accvgpr_read_b32 v99, a3
  v_accvgpr_read_b32 v100, a16
  v_accvgpr_read_b32 v101, a17
  v_accvgpr_read_b32 v102, a18
  v_accvgpr_read_b32 v103, a19
  v_accvgpr_read_b32 v104, a32
  v_accvgpr_read_b32 v105, a33
  v_accvgpr_read_b32 v106, a34
  v_accvgpr_read_b32 v107, a35
  v_accvgpr_read_b32 v108, a48
  v_accvgpr_read_b32 v109, a49
  v_accvgpr_read_b32 v110, a50
  v_accvgpr_read_b32 v111, a51
  s_mov_b32 s80, 0x8000000
L_kg_w_36:
  ds_read_b32 v122, v120 offset:28
  s_waitcnt lgkmcnt(0)
  v_readfirstlane_b32 s57, v122
  s_nop 0
  s_cmp_ge_u32 s57, 4
  s_cbranch_scc1 L_kg_w_36_d
  s_sleep 1
  s_sub_u32 s80, s80, 1
  s_cbranch_scc0 L_kg_w_36
L_kg_w_36_d:
  ds_read_b128 v[0:3], v85 offset:0
  ds_read_b128 v[4:7], v85 offset:1024
  ds_read_b128 v[8:11], v85 offset:2048
  ds_read_b128 v[12:15], v85 offset:3072
  ds_read_b128 v[24:27], v85 offset:6144
  ds_read_b128 v[28:31], v85 offset:7168
  ds_read_b128 v[32:35], v85 offset:8192
  ds_read_b128 v[36:39], v85 offset:9216
  ds_read_b128 v[48:51], v85 offset:12288
  ds_read_b128 v[52:55], v85 offset:13312
  ds_read_b128 v[56:59], v85 offset:14336
  ds_read_b128 v[60:63], v85 offset:15360
  s_waitcnt lgkmcnt(8)
  v_pk_add_f32 v[96:97], v[96:97], v[0:1]
  v_pk_add_f32 v[98:99], v[98:99], v[2:3]
  v_pk_add_f32 v[100:101], v[100:101], v[4:5]
  v_pk_add_f32 v[102:103], v[102:103], v[6:7]
  v_pk_add_f32 v[104:105], v[104:105], v[8:9]
  v_pk_add_f32 v[106:107], v[106:107], v[10:11]
  v_pk_add_f32 v[108:109], v[108:109], v[12:13]
  v_pk_add_f32 v[110:111], v[110:111], v[14:15]
  s_waitcnt lgkmcnt(4)
  v_pk_add_f32 v[96:97], v[96:97], v[24:25]
  v_pk_add_f32 v[98:99], v[98:99], v[26:27]
  v_pk_add_f32 v[100:101], v[100:101], v[28:29]
  v_pk_add_f32 v[102:103], v[102:103], v[30:31]
  v_pk_add_f32 v[104:105], v[104:105], v[32:33]
  v_pk_add_f32 v[106:107], v[106:107], v[34:35]
  v_pk_add_f32 v[108:109], v[108:109], v[36:37]
  v_pk_add_f32 v[110:111], v[110:111], v[38:39]
  s_waitcnt lgkmcnt(0)
  v_pk_add_f32 v[96:97], v[96:97], v[48:49]
  v_pk_add_f32 v[98:99], v[98:99], v[50:51]
  v_pk_add_f32 v[100:101], v[100:101], v[52:53]
  v_pk_add_f32 v[102:103], v[102:103], v[54:55]
  v_pk_add_f32 v[104:105], v[104:105], v[56:57]
  v_pk_add_f32 v[106:107], v[106:107], v[58:59]
  v_pk_add_f32 v[108:109], v[108:109], v[60:61]
  v_pk_add_f32 v[110:111], v[110:111], v[62:63]
  v_mov_b32 v72, 0xbfb8aa3b
  v_mov_b32 v74, 1.0
  v_pk_mul_f32 v[0:1], v[96:97], v[72:73] op_sel_hi:[1,0]
  v_pk_mul_f32 v[2:3], v[98:99], v[72:73] op_sel_hi:[1,0]
  v_pk_mul_f32 v[4:5], v[100:101], v[72:73] op_sel_hi:[1,0]
  v_pk_mul_f32 v[6:7], v[102:103], v[72:73] op_sel_hi:[1,0]
  v_pk_mul_f32 v[8:9], v[104:105], v[72:73] op_sel_hi:[1,0]
  v_pk_mul_f32 v[10:11], v[106:107], v[72:73] op_sel_hi:[1,0]
  v_pk_mul_f32 v[12:13], v[108:109], v[72:73] op_sel_hi:[1,0]
  v_pk_mul_f32 v[14:15], v[110:111], v[72:73] op_sel_hi:[1,0]
  v_exp_f32 v0, v0
  v_exp_f32 v1, v1
  v_exp_f32 v2, v2
  v_exp_f32 v3, v3
  v_exp_f32 v4, v4
  v_exp_f32 v5, v5
  v_exp_f32 v6, v6
  v_exp_f32 v7, v7
  v_exp_f32 v8, v8
  v_exp_f32 v9, v9
  v_exp_f32 v10, v10
  v_exp_f32 v11, v11
  v_exp_f32 v12, v12
  v_exp_f32 v13, v13
  v_exp_f32 v14, v14
  v_exp_f32 v15, v15
  v_pk_add_f32 v[0:1], v[0:1], v[74:75] op_sel_hi:[1,0]
  v_pk_add_f32 v[2:3], v[2:3], v[74:75] op_sel_hi:[1,0]
  v_pk_add_f32 v[4:5], v[4:5], v[74:75] op_sel_hi:[1,0]
  v_pk_add_f32 v[6:7], v[6:7], v[74:75] op_sel_hi:[1,0]
  v_pk_add_f32 v[8:9], v[8:9], v[74:75] op_sel_hi:[1,0]
  v_pk_add_f32 v[10:11], v[10:11], v[74:75] op_sel_hi:[1,0]
  v_pk_add_f32 v[12:13], v[12:13], v[74:75] op_sel_hi:[1,0]
  v_pk_add_f32 v[14:15], v[14:15], v[74:75] op_sel_hi:[1,0]
  v_rcp_f32 v0, v0
  v_rcp_f32 v1, v1
  v_rcp_f32 v2, v2
  v_rcp_f32 v3, v3
  v_rcp_f32 v4, v4
  v_rcp_f32 v5, v5
  v_rcp_f32 v6, v6
  v_rcp_f32 v7, v7
  v_rcp_f32 v8, v8
  v_rcp_f32 v9, v9
  v_rcp_f32 v10, v10
  v_rcp_f32 v11, v11
  v_rcp_f32 v12, v12
  v_rcp_f32 v13, v13
  v_rcp_f32 v14, v14
  v_rcp_f32 v15, v15
  v_pk_mul_f32 v[0:1], v[0:1], v[96:97]
  v_pk_mul_f32 v[2:3], v[2:3], v[98:99]
  v_pk_mul_f32 v[4:5], v[4:5], v[100:101]
  v_pk_mul_f32 v[6:7], v[6:7], v[102:103]
  v_pk_mul_f32 v[8:9], v[8:9], v[104:105]
  v_pk_mul_f32 v[10:11], v[10:11], v[106:107]
  v_pk_mul_f32 v[12:13], v[12:13], v[108:109]
  v_pk_mul_f32 v[14:15], v[14:15], v[110:111]
  v_cvt_pk_bf16_f32 v32, v0, v1
  v_cvt_pk_bf16_f32 v33, v2, v3
  v_cvt_pk_bf16_f32 v34, v4, v5
  v_cvt_pk_bf16_f32 v35, v6, v7
  v_cvt_pk_bf16_f32 v36, v8, v9
  v_cvt_pk_bf16_f32 v37, v10, v11
  v_cvt_pk_bf16_f32 v38, v12, v13
  v_cvt_pk_bf16_f32 v39, v14, v15
  ds_write_b64 v86, v[32:33] offset:0
  ds_write_b64 v86, v[34:35] offset:1536
  ds_write_b64 v86, v[36:37] offset:16
  ds_write_b64 v86, v[38:39] offset:1552
  s_waitcnt lgkmcnt(0)
  s_barrier
L_kg_f_end:
  s_endpgm
L_kg_fallback:
  s_mov_b32 s60, s63
  s_mov_b32 s61, 0
  s_waitcnt vmcnt(0)
  v_mov_b32 v54, 0xff800000
  v_mov_b32 v55, 0xff800000
  v_mov_b32 v56, 0xff800000
  v_mov_b32 v57, 0xff800000
  v_mov_b32 v58, 0xff800000
  v_mov_b32 v59, 0xff800000
  v_mov_b32 v60, 0xff800000
  v_mov_b32 v61, 0xff800000
L_kg_fb_loop:
  buffer_load_dwordx4 v[48:51], v76, s[40:43], s60 offen sc1
  buffer_load_dwordx2 v[52:53], v77, s[40:43], s60 offen offset:3072 sc1
  s_add_u32 s60, s60, 3584
  s_waitcnt vmcnt(0)
  v_mfma_f32_32x32x16_bf16 v[80:95], v[48:51], v[0:3], 0
  v_mfma_f32_32x32x8_bf16 v[80:95], v[52:53], v[4:5], v[80:95]
  s_nop 11
  v_max3_f32 v54, v54, v80, v81
  v_max3_f32 v54, v54, v82, v83
  v_max3_f32 v54, v54, v84, v85
  v_max3_f32 v54, v54, v86, v87
  v_max3_f32 v54, v54, v88, v89
  v_max3_f32 v54, v54, v90, v91
  v_max3_f32 v54, v54, v92, v93
  v_max3_f32 v54, v54, v94, v95
  v_mfma_f32_32x32x16_bf16 v[80:95], v[48:51], v[6:9], 0
  v_mfma_f32_32x32x8_bf16 v[80:95], v[52:53], v[10:11], v[80:95]
  s_nop 11
  v_max3_f32 v55, v55, v80, v81
  v_max3_f32 v55, v55, v82, v83
  v_max3_f32 v55, v55, v84, v85
  v_max3_f32 v55, v55, v86, v87
  v_max3_f32 v55, v55, v88, v89
  v_max3_f32 v55, v55, v90, v91
  v_max3_f32 v55, v55, v92, v93
  v_max3_f32 v55, v55, v94, v95
  v_mfma_f32_32x32x16_bf16 v[80:95], v[48:51], v[12:15], 0
  v_mfma_f32_32x32x8_bf16 v[80:95], v[52:53], v[16:17], v[80:95]
  s_nop 11
  v_max3_f32 v56, v56, v80, v81
  v_max3_f32 v56, v56, v82, v83
  v_max3_f32 v56, v56, v84, v85
  v_max3_f32 v56, v56, v86, v87
  v_max3_f32 v56, v56, v88, v89
  v_max3_f32 v56, v56, v90, v91
  v_max3_f32 v56, v56, v92, v93
  v_max3_f32 v56, v56, v94, v95
  v_mfma_f32_32x32x16_bf16 v[80:95], v[48:51], v[18:21], 0
  v_mfma_f32_32x32x8_bf16 v[80:95], v[52:53], v[22:23], v[80:95]
  s_nop 11
  v_max3_f32 v57, v57, v80, v81
  v_max3_f32 v57, v57, v82, v83
  v_max3_f32 v57, v57, v84, v85
  v_max3_f32 v57, v57, v86, v87
  v_max3_f32 v57, v57, v88, v89
  v_max3_f32 v57, v57, v90, v91
  v_max3_f32 v57, v57, v92, v93
  v_max3_f32 v57, v57, v94, v95
  v_mfma_f32_32x32x16_bf16 v[80:95], v[48:51], v[24:27], 0
  v_mfma_f32_32x32x8_bf16 v[80:95], v[52:53], v[28:29], v[80:95]
  s_nop 11
  v_max3_f32 v58, v58, v80, v81
  v_max3_f32 v58, v58, v82, v83
  v_max3_f32 v58, v58, v84, v85
  v_max3_f32 v58, v58, v86, v87
  v_max3_f32 v58, v58, v88, v89
  v_max3_f32 v58, v58, v90, v91
  v_max3_f32 v58, v58, v92, v93
  v_max3_f32 v58, v58, v94, v95
  v_mfma_f32_32x32x16_bf16 v[80:95], v[48:51], v[30:33], 0
  v_mfma_f32_32x32x8_bf16 v[80:95], v[52:53], v[34:35], v[80:95]
  s_nop 11
  v_max3_f32 v59, v59, v80, v81
  v_max3_f32 v59, v59, v82, v83
  v_max3_f32 v59, v59, v84, v85
  v_max3_f32 v59, v59, v86, v87
  v_max3_f32 v59, v59, v88, v89
  v_max3_f32 v59, v59, v90, v91
  v_max3_f32 v59, v59, v92, v93
  v_max3_f32 v59, v59, v94, v95
  v_mfma_f32_32x32x16_bf16 v[80:95], v[48:51], v[36:39], 0
  v_mfma_f32_32x32x8_bf16 v[80:95], v[52:53], v[40:41], v[80:95]
  s_nop 11
  v_max3_f32 v60, v60, v80, v81
  v_max3_f32 v60, v60, v82, v83
  v_max3_f32 v60, v60, v84, v85
  v_max3_f32 v60, v60, v86, v87
  v_max3_f32 v60, v60, v88, v89
  v_max3_f32 v60, v60, v90, v91
  v_max3_f32 v60, v60, v92, v93
  v_max3_f32 v60, v60, v94, v95
  v_mfma_f32_32x32x16_bf16 v[80:95], v[48:51], v[42:45], 0
  v_mfma_f32_32x32x8_bf16 v[80:95], v[52:53], v[46:47], v[80:95]
  s_nop 11
  v_max3_f32 v61, v61, v80, v81
  v_max3_f32 v61, v61, v82, v83
  v_max3_f32 v61, v61, v84, v85
  v_max3_f32 v61, v61, v86, v87
  v_max3_f32 v61, v61, v88, v89
  v_max3_f32 v61, v61, v90, v91
  v_max3_f32 v61, v61, v92, v93
  v_max3_f32 v61, v61, v94, v95
  s_add_u32 s61, s61, 1
  s_cmp_lt_u32 s61, 16
  s_cbranch_scc1 L_kg_fb_loop
  s_lshl_b32 s58, s36, 11
  v_lshrrev_b32 v96, 2, v76
  v_add_u32 v96, 73728, v96
  s_add_u32 s57, s36, 0
  s_and_b32 s57, s57, 3
  s_lshl_b32 s57, s57, 9
  v_add_u32 v97, s57, v96
  v_add_u32 v101, s58, v97
  s_add_u32 s57, s36, 1
  s_and_b32 s57, s57, 3
  s_lshl_b32 s57, s57, 9
  v_add_u32 v98, s57, v96
  v_add_u32 v102, s58, v98
  s_add_u32 s57, s36, 2
  s_and_b32 s57, s57, 3
  s_lshl_b32 s57, s57, 9
  v_add_u32 v99, s57, v96
  v_add_u32 v103, s58, v99
  s_add_u32 s57, s36, 3
  s_and_b32 s57, s57, 3
  s_lshl_b32 s57, s57, 9
  v_add_u32 v100, s57, v96
  v_add_u32 v104, s58, v100
  v_mov_b32 v80, v54
  v_mov_b32 v81, v55
  v_mov_b32 v82, v56
  v_mov_b32 v83, v57
  v_mov_b32 v84, v58
  v_mov_b32 v85, v59
  v_mov_b32 v86, v60
  v_mov_b32 v87, v61
  v_permlane32_swap_b32 v80, v54
  v_permlane32_swap_b32 v81, v55
  v_permlane32_swap_b32 v82, v56
  v_permlane32_swap_b32 v83, v57
  v_permlane32_swap_b32 v84, v58
  v_permlane32_swap_b32 v85, v59
  v_permlane32_swap_b32 v86, v60
  v_permlane32_swap_b32 v87, v61
  v_max_f32 v54, v54, v80
  ds_write_b32 v101, v54 offset:0
  v_max_f32 v55, v55, v81
  ds_write_b32 v101, v55 offset:256
  v_max_f32 v56, v56, v82
  ds_write_b32 v102, v56 offset:0
  v_max_f32 v57, v57, v83
  ds_write_b32 v102, v57 offset:256
  v_max_f32 v58, v58, v84
  ds_write_b32 v103, v58 offset:0
  v_max_f32 v59, v59, v85
  ds_write_b32 v103, v59 offset:256
  v_max_f32 v60, v60, v86
  ds_write_b32 v104, v60 offset:0
  v_max_f32 v61, v61, v87
  ds_write_b32 v104, v61 offset:256
  s_mov_b64 exec, 1
  v_mov_b32 v121, 1
  ds_add_u32 v120, v121 offset:20
  s_mov_b64 exec, -1
  s_mov_b32 s80, 0x8000000
L_kg_w_37:
  ds_read_b32 v122, v120 offset:20
  s_waitcnt lgkmcnt(0)
  v_readfirstlane_b32 s57, v122
  s_nop 0
  s_cmp_ge_u32 s57, 4
  s_cbranch_scc1 L_kg_w_37_d
  s_sleep 1
  s_sub_u32 s80, s80, 1
  s_cbranch_scc0 L_kg_w_37
L_kg_w_37_d:
  ds_read_b32 v80, v97 offset:0
  ds_read_b32 v81, v97 offset:2048
  ds_read_b32 v82, v97 offset:4096
  ds_read_b32 v83, v97 offset:6144
  s_waitcnt lgkmcnt(0)
  v_max3_f32 v80, v80, v81, v82
  v_max_f32 v80, v80, v83
  v_sub_f32 v80, 0, v80
  v_and_b32 v81, 0xffff0000, v80
  v_sub_f32 v80, v80, v81
  v_and_b32 v82, 0xffff0000, v80
  v_sub_f32 v80, v80, v82
  v_lshrrev_b32 v81, 16, v81
  s_mov_b32 exec_lo, 0
  v_or_b32 v4, v81, v82
  v_lshrrev_b32 v5, 16, v80
  s_mov_b32 exec_lo, -1
  ds_read_b32 v80, v97 offset:256
  ds_read_b32 v81, v97 offset:2304
  ds_read_b32 v82, v97 offset:4352
  ds_read_b32 v83, v97 offset:6400
  s_waitcnt lgkmcnt(0)
  v_max3_f32 v80, v80, v81, v82
  v_max_f32 v80, v80, v83
  v_sub_f32 v80, 0, v80
  v_and_b32 v81, 0xffff0000, v80
  v_sub_f32 v80, v80, v81
  v_and_b32 v82, 0xffff0000, v80
  v_sub_f32 v80, v80, v82
  v_lshrrev_b32 v81, 16, v81
  s_mov_b32 exec_lo, 0
  v_or_b32 v10, v81, v82
  v_lshrrev_b32 v11, 16, v80
  s_mov_b32 exec_lo, -1
  ds_read_b32 v80, v98 offset:0
  ds_read_b32 v81, v98 offset:2048
  ds_read_b32 v82, v98 offset:4096
  ds_read_b32 v83, v98 offset:6144
  s_waitcnt lgkmcnt(0)
  v_max3_f32 v80, v80, v81, v82
  v_max_f32 v80, v80, v83
  v_sub_f32 v80, 0, v80
  v_and_b32 v81, 0xffff0000, v80
  v_sub_f32 v80, v80, v81
  v_and_b32 v82, 0xffff0000, v80
  v_sub_f32 v80, v80, v82
  v_lshrrev_b32 v81, 16, v81
  s_mov_b32 exec_lo, 0
  v_or_b32 v16, v81, v82
  v_lshrrev_b32 v17, 16, v80
  s_mov_b32 exec_lo, -1
  ds_read_b32 v80, v98 offset:256
  ds_read_b32 v81, v98 offset:2304
  ds_read_b32 v82, v98 offset:4352
  ds_read_b32 v83, v98 offset:6400
  s_waitcnt lgkmcnt(0)
  v_max3_f32 v80, v80, v81, v82
  v_max_f32 v80, v80, v83
  v_sub_f32 v80, 0, v80
  v_and_b32 v81, 0xffff0000, v80
  v_sub_f32 v80, v80, v81
  v_and_b32 v82, 0xffff0000, v80
  v_sub_f32 v80, v80, v82
  v_lshrrev_b32 v81, 16, v81
  s_mov_b32 exec_lo, 0
  v_or_b32 v22, v81, v82
  v_lshrrev_b32 v23, 16, v80
  s_mov_b32 exec_lo, -1
  ds_read_b32 v80, v99 offset:0
  ds_read_b32 v81, v99 offset:2048
  ds_read_b32 v82, v99 offset:4096
  ds_read_b32 v83, v99 offset:6144
  s_waitcnt lgkmcnt(0)
  v_max3_f32 v80, v80, v81, v82
  v_max_f32 v80, v80, v83
  v_sub_f32 v80, 0, v80
  v_and_b32 v81, 0xffff0000, v80
  v_sub_f32 v80, v80, v81
  v_and_b32 v82, 0xffff0000, v80
  v_sub_f32 v80, v80, v82
  v_lshrrev_b32 v81, 16, v81
  s_mov_b32 exec_lo, 0
  v_or_b32 v28, v81, v82
  v_lshrrev_b32 v29, 16, v80
  s_mov_b32 exec_lo, -1
  ds_read_b32 v80, v99 offset:256
  ds_read_b32 v81, v99 offset:2304
  ds_read_b32 v82, v99 offset:4352
  ds_read_b32 v83, v99 offset:6400
  s_waitcnt lgkmcnt(0)
  v_max3_f32 v80, v80, v81, v82
  v_max_f32 v80, v80, v83
  v_sub_f32 v80, 0, v80
  v_and_b32 v81, 0xffff0000, v80
  v_sub_f32 v80, v80, v81
  v_and_b32 v82, 0xffff0000, v80
  v_sub_f32 v80, v80, v82
  v_lshrrev_b32 v81, 16, v81
  s_mov_b32 exec_lo, 0
  v_or_b32 v34, v81, v82
  v_lshrrev_b32 v35, 16, v80
  s_mov_b32 exec_lo, -1
  ds_read_b32 v80, v100 offset:0
  ds_read_b32 v81, v100 offset:2048
  ds_read_b32 v82, v100 offset:4096
  ds_read_b32 v83, v100 offset:6144
  s_waitcnt lgkmcnt(0)
  v_max3_f32 v80, v80, v81, v82
  v_max_f32 v80, v80, v83
  v_sub_f32 v80, 0, v80
  v_and_b32 v81, 0xffff0000, v80
  v_sub_f32 v80, v80, v81
  v_and_b32 v82, 0xffff0000, v80
  v_sub_f32 v80, v80, v82
  v_lshrrev_b32 v81, 16, v81
  s_mov_b32 exec_lo, 0
  v_or_b32 v40, v81, v82
  v_lshrrev_b32 v41, 16, v80
  s_mov_b32 exec_lo, -1
  ds_read_b32 v80, v100 offset:256
  ds_read_b32 v81, v100 offset:2304
  ds_read_b32 v82, v100 offset:4352
  ds_read_b32 v83, v100 offset:6400
  s_waitcnt lgkmcnt(0)
  v_max3_f32 v80, v80, v81, v82
  v_max_f32 v80, v80, v83
  v_sub_f32 v80, 0, v80
  v_and_b32 v81, 0xffff0000, v80
  v_sub_f32 v80, v80, v81
  v_and_b32 v82, 0xffff0000, v80
  v_sub_f32 v80, v80, v82
  v_lshrrev_b32 v81, 16, v81
  s_mov_b32 exec_lo, 0
  v_or_b32 v46, v81, v82
  v_lshrrev_b32 v47, 16, v80
  s_mov_b32 exec_lo, -1
  s_mov_b64 exec, 1
  v_mov_b32 v121, 1
  ds_add_u32 v120, v121 offset:20
  s_mov_b64 exec, -1
  s_mov_b32 s80, 0x8000000
L_kg_w_38:
  ds_read_b32 v122, v120 offset:20
  s_waitcnt lgkmcnt(0)
  v_readfirstlane_b32 s57, v122
  s_nop 0
  s_cmp_ge_u32 s57, 8
  s_cbranch_scc1 L_kg_w_38_d
  s_sleep 1
  s_sub_u32 s80, s80, 1
  s_cbranch_scc0 L_kg_w_38
L_kg_w_38_d:
  s_mov_b32 s62, 1
  s_mov_b32 s60, s67
  buffer_load_dwordx4 v[48:51], v76, s[40:43], s60 offen sc1
  buffer_load_dwordx2 v[52:53], v77, s[40:43], s60 offen offset:3072 sc1
  buffer_load_dwordx4 v[54:57], v76, s[40:43], s60 offen offset:1024 sc1
  buffer_load_dwordx4 v[58:61], v76, s[40:43], s60 offen offset:2048 sc1
  s_add_u32 s60, s60, 3584
  buffer_load_dwordx4 v[62:65], v76, s[40:43], s60 offen sc1
  buffer_load_dwordx2 v[66:67], v77, s[40:43], s60 offen offset:3072 sc1
  v_mov_b32 v68, 0
  v_mov_b32 v96, 0
  v_mov_b32 v69, 0
  v_mov_b32 v97, 0
  v_mov_b32 v70, 0
  v_mov_b32 v98, 0
  v_mov_b32 v71, 0
  v_mov_b32 v99, 0
  v_mov_b32 v72, 0
  v_mov_b32 v100, 0
  v_mov_b32 v73, 0
  v_mov_b32 v101, 0
  v_mov_b32 v74, 0
  v_mov_b32 v102, 0
  v_mov_b32 v75, 0
  v_mov_b32 v103, 0
  v_mfma_f32_32x32x16_bf16 a[0:15], v[96:99], v[96:99], 0
  v_mfma_f32_32x32x16_bf16 a[16:31], v[96:99], v[96:99], 0
  v_mfma_f32_32x32x16_bf16 a[32:47], v[96:99], v[96:99], 0
  v_mfma_f32_32x32x16_bf16 a[48:63], v[96:99], v[96:99], 0
  v_mfma_f32_32x32x16_bf16 a[64:79], v[96:99], v[96:99], 0
  v_mfma_f32_32x32x16_bf16 a[80:95], v[96:99], v[96:99], 0
  v_mfma_f32_32x32x16_bf16 a[96:111], v[96:99], v[96:99], 0
  v_mfma_f32_32x32x16_bf16 a[112:127], v[96:99], v[96:99], 0
  s_mov_b32 s61, 0
  s_waitcnt vmcnt(0)
  s_branch L_kg_at_go
L_kg_end:
  s_endpgm
.section .rodata,"a"
.p2align 6
.amdhsa_kernel kg_kernel
  .amdhsa_next_free_vgpr 256
  .amdhsa_next_free_sgpr 102
  .amdhsa_accum_offset 128
  .amdhsa_group_segment_fixed_size 0
  .amdhsa_kernarg_size 104
  .amdhsa_user_sgpr_count 2
  .amdhsa_user_sgpr_kernarg_segment_ptr 1
  .amdhsa_system_sgpr_workgroup_id_x 1
  .amdhsa_float_denorm_mode_32 3
.end_amdhsa_kernel
```
